```python
import torch

def _softmax(x, axis=-1):
    return torch.softmax(x, dim=axis)
def _gelu(x):
    return torch.nn.functional.gelu(x, approximate="tanh")
def _silu(x):
    return torch.nn.functional.silu(x)
def _sigmoid(x):
    return torch.sigmoid(x)
def _layernorm(x, axis=-1, eps=1e-5):
    m = x.mean(dim=axis, keepdim=True)
    v = x.var(dim=axis, keepdim=True, unbiased=False)
    return (x - m) / torch.sqrt(v + eps)
def _scatter_add(tgt, idx, src, axis=0):
    return tgt.clone().index_add_(axis, idx, src)
def _segment_sum(src, seg, n):
    out = torch.zeros((n,) + src.shape[1:], dtype=src.dtype)
    return out.index_add_(0, seg, src)
def _pad(x, pw):
    flat = tuple(v for pair in reversed(pw) for v in pair)
    return torch.nn.functional.pad(x, flat)

kernel_name = 'interleave_layers__spectral_gfnet__glu_gated_swiglu__prompt'

def setup_inputs():

    _w = (lambda a: (lambda t: t.to(torch.bfloat16) if t.is_floating_point() else t)(torch.as_tensor(a)))
    def _A_setup():
        B, S, D = 1, 2048, 640
        Df = D // 2 + 1
        return {
            "x": _w((lambda *s: torch.randn(*s, dtype=torch.bfloat16) * 0.05)(B, S, D)),
            "w_r": _w((lambda *s: torch.randn(*s, dtype=torch.bfloat16) * 0.4)(S, Df) * 0.02),
            "w_i": _w((lambda *s: torch.randn(*s, dtype=torch.bfloat16) * 0.4)(S, Df) * 0.02),
        }
    _A_in = _A_setup()

    def _B_setup():
        B, S, D, F = 1, 2048, 640, 1728
        return {
            "x": _w((lambda *s: torch.randn(*s, dtype=torch.bfloat16) * 0.05)(B, S, D)),
            "w1": _w((lambda *s: torch.randn(*s, dtype=torch.bfloat16) * 0.2)(D, F) * (2.0 / D) ** 0.5),
            "w3": _w((lambda *s: torch.randn(*s, dtype=torch.bfloat16) * 0.2)(D, F) * (2.0 / D) ** 0.5),
            "w2": _w((lambda *s: torch.randn(*s, dtype=torch.bfloat16) * 0.2)(F, D) * (2.0 / F) ** 0.5),
        }
    _B_in = _B_setup()

    return {
        "A_x": _A_in["x"],
        "A_w_r": _A_in["w_r"],
        "A_w_i": _A_in["w_i"],
        "B_x": _B_in["x"],
        "B_w1": _B_in["w1"],
        "B_w3": _B_in["w3"],
        "B_w2": _B_in["w2"],
    }

def reference(A_x, A_w_r, A_w_i, B_x, B_w1, B_w3, B_w2):
    def _A_ref(x, w_r, w_i):
        B, S, D = x.shape
        X = (lambda x, axes=(-2,-1): torch.fft.rfft2(x.float(), dim=axes))(x, axes=(-2, -1))
        W = w_r + 1j * w_i
        X = X * W
        y = (lambda x, s, axes=(-2,-1): torch.fft.irfft2(x, s=s, dim=axes).to(torch.bfloat16))(X, (S, D), axes=(-2, -1))
        return y

    def _B_ref(x, w1, w3, w2):
        gate = torch.einsum("bsd,df->bsf", x, w1)
        up = torch.einsum("bsd,df->bsf", x, w3)
        h = _silu(gate) * up
        out = torch.einsum("bsf,fd->bsd", h, w2)
        return out

    x = A_x
    x = x + _A_ref(_layernorm(x, axis=-1), A_w_r, A_w_i)
    x = x + _B_ref(_layernorm(x, axis=-1), B_w1, B_w3, B_w2)
    x = x + _A_ref(_layernorm(x, axis=-1), A_w_r, A_w_i)
    x = x + _B_ref(_layernorm(x, axis=-1), B_w1, B_w3, B_w2)
    return x
```

```asm
; @launch kernel=k1a_kernel grid=(256,1,1) block=(320,1,1) lds=40960
; @launch kernel=k2a_kernel grid=(321,1,1) block=(256,1,1) lds=32768
; @launch kernel=k3a_kernel grid=(256,1,1) block=(320,1,1) lds=40960
; @launch kernel=k4a_kernel grid=(256,1,1) block=(512,1,1) lds=98304
; @launch kernel=k5a_kernel grid=(320,1,1) block=(256,1,1) lds=32768
; @launch kernel=k1b_kernel grid=(256,1,1) block=(320,1,1) lds=40960
; @launch kernel=k2b_kernel grid=(321,1,1) block=(256,1,1) lds=32768
; @launch kernel=k3b_kernel grid=(256,1,1) block=(320,1,1) lds=40960
; @launch kernel=k4b_kernel grid=(256,1,1) block=(512,1,1) lds=98304
; @launch kernel=k5b_kernel grid=(320,1,1) block=(256,1,1) lds=32768
.amdgcn_target "amdgcn-amd-amdhsa--gfx950"
.text
.globl k1a_kernel
.p2align 8
.type k1a_kernel,@function
k1a_kernel:
    s_cmp_ge_u32 s2, 256
    s_cbranch_scc1 k1a_kernel_end
    s_load_dwordx2 s[4:5], s[0:1], 0
    s_load_dwordx2 s[6:7], s[0:1], 72
    v_lshrrev_b32 v1, 6, v0
    s_nop 0
    v_readfirstlane_b32 s20, v1
    v_and_b32 v2, 63, v0
    s_waitcnt lgkmcnt(0)
    s_mov_b32 s8, s4
    s_and_b32 s9, s5, 0xffff
    s_mov_b32 s10, 0x280000
    s_mov_b32 s11, 0x00020000
    s_mov_b32 s12, s6
    s_and_b32 s13, s7, 0xffff
    s_mov_b32 s14, 0x504000
    s_mov_b32 s15, 0x00020000
    s_cmp_ge_u32 s20, 4
    s_cbranch_scc1 k1a_kernel_p2
    s_mul_i32 s21, s2, 10240
    s_mul_i32 s22, s20, 2560
    s_add_u32 s21, s21, s22
    v_lshlrev_b32 v3, 1, v2
    buffer_load_ushort v4, v3, s[8:11], s21 offen offset:0
    buffer_load_ushort v14, v3, s[8:11], s21 offen offset:1280
    buffer_load_ushort v5, v3, s[8:11], s21 offen offset:128
    buffer_load_ushort v15, v3, s[8:11], s21 offen offset:1408
    buffer_load_ushort v6, v3, s[8:11], s21 offen offset:256
    buffer_load_ushort v16, v3, s[8:11], s21 offen offset:1536
    buffer_load_ushort v7, v3, s[8:11], s21 offen offset:384
    buffer_load_ushort v17, v3, s[8:11], s21 offen offset:1664
    buffer_load_ushort v8, v3, s[8:11], s21 offen offset:512
    buffer_load_ushort v18, v3, s[8:11], s21 offen offset:1792
    buffer_load_ushort v9, v3, s[8:11], s21 offen offset:640
    buffer_load_ushort v19, v3, s[8:11], s21 offen offset:1920
    buffer_load_ushort v10, v3, s[8:11], s21 offen offset:768
    buffer_load_ushort v20, v3, s[8:11], s21 offen offset:2048
    buffer_load_ushort v11, v3, s[8:11], s21 offen offset:896
    buffer_load_ushort v21, v3, s[8:11], s21 offen offset:2176
    buffer_load_ushort v12, v3, s[8:11], s21 offen offset:1024
    buffer_load_ushort v22, v3, s[8:11], s21 offen offset:2304
    buffer_load_ushort v13, v3, s[8:11], s21 offen offset:1152
    buffer_load_ushort v23, v3, s[8:11], s21 offen offset:2432
    s_waitcnt vmcnt(0)
    v_lshlrev_b32 v4, 16, v4
    v_lshlrev_b32 v5, 16, v5
    v_lshlrev_b32 v6, 16, v6
    v_lshlrev_b32 v7, 16, v7
    v_lshlrev_b32 v8, 16, v8
    v_lshlrev_b32 v9, 16, v9
    v_lshlrev_b32 v10, 16, v10
    v_lshlrev_b32 v11, 16, v11
    v_lshlrev_b32 v12, 16, v12
    v_lshlrev_b32 v13, 16, v13
    v_lshlrev_b32 v14, 16, v14
    v_lshlrev_b32 v15, 16, v15
    v_lshlrev_b32 v16, 16, v16
    v_lshlrev_b32 v17, 16, v17
    v_lshlrev_b32 v18, 16, v18
    v_lshlrev_b32 v19, 16, v19
    v_lshlrev_b32 v20, 16, v20
    v_lshlrev_b32 v21, 16, v21
    v_lshlrev_b32 v22, 16, v22
    v_lshlrev_b32 v23, 16, v23
    v_add_f32 v24, v4, v5
    v_add_f32 v24, v24, v6
    v_add_f32 v24, v24, v7
    v_add_f32 v24, v24, v8
    v_add_f32 v24, v24, v9
    v_add_f32 v24, v24, v10
    v_add_f32 v24, v24, v11
    v_add_f32 v24, v24, v12
    v_add_f32 v24, v24, v13
    v_add_f32 v25, v14, v15
    v_add_f32 v25, v25, v16
    v_add_f32 v25, v25, v17
    v_add_f32 v25, v25, v18
    v_add_f32 v25, v25, v19
    v_add_f32 v25, v25, v20
    v_add_f32 v25, v25, v21
    v_add_f32 v25, v25, v22
    v_add_f32 v25, v25, v23
    v_add_f32_dpp v24, v24, v24 quad_perm:[1,0,3,2] row_mask:0xf bank_mask:0xf
    s_nop 0
    v_add_f32_dpp v25, v25, v25 quad_perm:[1,0,3,2] row_mask:0xf bank_mask:0xf
    v_add_f32_dpp v24, v24, v24 quad_perm:[2,3,0,1] row_mask:0xf bank_mask:0xf
    s_nop 0
    v_add_f32_dpp v25, v25, v25 quad_perm:[2,3,0,1] row_mask:0xf bank_mask:0xf
    v_add_f32_dpp v24, v24, v24 row_ror:4 row_mask:0xf bank_mask:0xf
    s_nop 0
    v_add_f32_dpp v25, v25, v25 row_ror:4 row_mask:0xf bank_mask:0xf
    v_add_f32_dpp v24, v24, v24 row_ror:8 row_mask:0xf bank_mask:0xf
    s_nop 0
    v_add_f32_dpp v25, v25, v25 row_ror:8 row_mask:0xf bank_mask:0xf
    v_mov_b32 v26, v24
    v_mov_b32 v27, v25
    s_nop 0
    v_permlane16_swap_b32 v26, v24
    v_permlane16_swap_b32 v27, v25
    v_add_f32 v24, v24, v26
    v_add_f32 v25, v25, v27
    v_mov_b32 v26, v24
    v_mov_b32 v27, v25
    s_nop 0
    v_permlane32_swap_b32 v26, v24
    v_permlane32_swap_b32 v27, v25
    v_add_f32 v24, v24, v26
    v_add_f32 v25, v25, v27
    v_mul_f32 v24, 0x3acccccd, v24
    v_sub_f32 v30, v4, v24
    v_mul_f32 v28, v30, v30
    v_sub_f32 v30, v5, v24
    v_fmac_f32 v28, v30, v30
    v_sub_f32 v30, v6, v24
    v_fmac_f32 v28, v30, v30
    v_sub_f32 v30, v7, v24
    v_fmac_f32 v28, v30, v30
    v_sub_f32 v30, v8, v24
    v_fmac_f32 v28, v30, v30
    v_sub_f32 v30, v9, v24
    v_fmac_f32 v28, v30, v30
    v_sub_f32 v30, v10, v24
    v_fmac_f32 v28, v30, v30
    v_sub_f32 v30, v11, v24
    v_fmac_f32 v28, v30, v30
    v_sub_f32 v30, v12, v24
    v_fmac_f32 v28, v30, v30
    v_sub_f32 v30, v13, v24
    v_fmac_f32 v28, v30, v30
    v_mul_f32 v25, 0x3acccccd, v25
    v_sub_f32 v30, v14, v25
    v_mul_f32 v29, v30, v30
    v_sub_f32 v30, v15, v25
    v_fmac_f32 v29, v30, v30
    v_sub_f32 v30, v16, v25
    v_fmac_f32 v29, v30, v30
    v_sub_f32 v30, v17, v25
    v_fmac_f32 v29, v30, v30
    v_sub_f32 v30, v18, v25
    v_fmac_f32 v29, v30, v30
    v_sub_f32 v30, v19, v25
    v_fmac_f32 v29, v30, v30
    v_sub_f32 v30, v20, v25
    v_fmac_f32 v29, v30, v30
    v_sub_f32 v30, v21, v25
    v_fmac_f32 v29, v30, v30
    v_sub_f32 v30, v22, v25
    v_fmac_f32 v29, v30, v30
    v_sub_f32 v30, v23, v25
    v_fmac_f32 v29, v30, v30
    v_add_f32_dpp v28, v28, v28 quad_perm:[1,0,3,2] row_mask:0xf bank_mask:0xf
    s_nop 0
    v_add_f32_dpp v29, v29, v29 quad_perm:[1,0,3,2] row_mask:0xf bank_mask:0xf
    v_add_f32_dpp v28, v28, v28 quad_perm:[2,3,0,1] row_mask:0xf bank_mask:0xf
    s_nop 0
    v_add_f32_dpp v29, v29, v29 quad_perm:[2,3,0,1] row_mask:0xf bank_mask:0xf
    v_add_f32_dpp v28, v28, v28 row_ror:4 row_mask:0xf bank_mask:0xf
    s_nop 0
    v_add_f32_dpp v29, v29, v29 row_ror:4 row_mask:0xf bank_mask:0xf
    v_add_f32_dpp v28, v28, v28 row_ror:8 row_mask:0xf bank_mask:0xf
    s_nop 0
    v_add_f32_dpp v29, v29, v29 row_ror:8 row_mask:0xf bank_mask:0xf
    v_mov_b32 v26, v28
    v_mov_b32 v27, v29
    s_nop 0
    v_permlane16_swap_b32 v26, v28
    v_permlane16_swap_b32 v27, v29
    v_add_f32 v28, v28, v26
    v_add_f32 v29, v29, v27
    v_mov_b32 v26, v28
    v_mov_b32 v27, v29
    s_nop 0
    v_permlane32_swap_b32 v26, v28
    v_permlane32_swap_b32 v27, v29
    v_add_f32 v28, v28, v26
    v_add_f32 v29, v29, v27
    v_mul_f32 v28, 0x3acccccd, v28
    v_cvt_pk_bf16_f32 v30, v28, v28
    v_lshlrev_b32 v28, 16, v30
    v_add_f32 v28, 0x3727c5ac, v28
    v_cvt_pk_bf16_f32 v30, v28, v28
    v_lshlrev_b32 v28, 16, v30
    v_sqrt_f32 v28, v28
    s_nop 0
    v_cvt_pk_bf16_f32 v30, v28, v28
    v_lshlrev_b32 v28, 16, v30
    v_rcp_f32 v28, v28
    v_cvt_pk_bf16_f32 v30, v24, v24
    v_lshlrev_b32 v24, 16, v30
    v_sub_f32 v4, v4, v24
    v_cvt_pk_bf16_f32 v30, v4, v4
    v_lshlrev_b32 v4, 16, v30
    v_mul_f32 v4, v4, v28
    v_cvt_pk_bf16_f32 v30, v4, v4
    v_lshlrev_b32 v4, 16, v30
    v_sub_f32 v5, v5, v24
    v_cvt_pk_bf16_f32 v30, v5, v5
    v_lshlrev_b32 v5, 16, v30
    v_mul_f32 v5, v5, v28
    v_cvt_pk_bf16_f32 v30, v5, v5
    v_lshlrev_b32 v5, 16, v30
    v_sub_f32 v6, v6, v24
    v_cvt_pk_bf16_f32 v30, v6, v6
    v_lshlrev_b32 v6, 16, v30
    v_mul_f32 v6, v6, v28
    v_cvt_pk_bf16_f32 v30, v6, v6
    v_lshlrev_b32 v6, 16, v30
    v_sub_f32 v7, v7, v24
    v_cvt_pk_bf16_f32 v30, v7, v7
    v_lshlrev_b32 v7, 16, v30
    v_mul_f32 v7, v7, v28
    v_cvt_pk_bf16_f32 v30, v7, v7
    v_lshlrev_b32 v7, 16, v30
    v_sub_f32 v8, v8, v24
    v_cvt_pk_bf16_f32 v30, v8, v8
    v_lshlrev_b32 v8, 16, v30
    v_mul_f32 v8, v8, v28
    v_cvt_pk_bf16_f32 v30, v8, v8
    v_lshlrev_b32 v8, 16, v30
    v_sub_f32 v9, v9, v24
    v_cvt_pk_bf16_f32 v30, v9, v9
    v_lshlrev_b32 v9, 16, v30
    v_mul_f32 v9, v9, v28
    v_cvt_pk_bf16_f32 v30, v9, v9
    v_lshlrev_b32 v9, 16, v30
    v_sub_f32 v10, v10, v24
    v_cvt_pk_bf16_f32 v30, v10, v10
    v_lshlrev_b32 v10, 16, v30
    v_mul_f32 v10, v10, v28
    v_cvt_pk_bf16_f32 v30, v10, v10
    v_lshlrev_b32 v10, 16, v30
    v_sub_f32 v11, v11, v24
    v_cvt_pk_bf16_f32 v30, v11, v11
    v_lshlrev_b32 v11, 16, v30
    v_mul_f32 v11, v11, v28
    v_cvt_pk_bf16_f32 v30, v11, v11
    v_lshlrev_b32 v11, 16, v30
    v_sub_f32 v12, v12, v24
    v_cvt_pk_bf16_f32 v30, v12, v12
    v_lshlrev_b32 v12, 16, v30
    v_mul_f32 v12, v12, v28
    v_cvt_pk_bf16_f32 v30, v12, v12
    v_lshlrev_b32 v12, 16, v30
    v_sub_f32 v13, v13, v24
    v_cvt_pk_bf16_f32 v30, v13, v13
    v_lshlrev_b32 v13, 16, v30
    v_mul_f32 v13, v13, v28
    v_cvt_pk_bf16_f32 v30, v13, v13
    v_lshlrev_b32 v13, 16, v30
    v_mul_f32 v29, 0x3acccccd, v29
    v_cvt_pk_bf16_f32 v30, v29, v29
    v_lshlrev_b32 v29, 16, v30
    v_add_f32 v29, 0x3727c5ac, v29
    v_cvt_pk_bf16_f32 v30, v29, v29
    v_lshlrev_b32 v29, 16, v30
    v_sqrt_f32 v29, v29
    s_nop 0
    v_cvt_pk_bf16_f32 v30, v29, v29
    v_lshlrev_b32 v29, 16, v30
    v_rcp_f32 v29, v29
    v_cvt_pk_bf16_f32 v30, v25, v25
    v_lshlrev_b32 v25, 16, v30
    v_sub_f32 v14, v14, v25
    v_cvt_pk_bf16_f32 v30, v14, v14
    v_lshlrev_b32 v14, 16, v30
    v_mul_f32 v14, v14, v29
    v_cvt_pk_bf16_f32 v30, v14, v14
    v_lshlrev_b32 v14, 16, v30
    v_sub_f32 v15, v15, v25
    v_cvt_pk_bf16_f32 v30, v15, v15
    v_lshlrev_b32 v15, 16, v30
    v_mul_f32 v15, v15, v29
    v_cvt_pk_bf16_f32 v30, v15, v15
    v_lshlrev_b32 v15, 16, v30
    v_sub_f32 v16, v16, v25
    v_cvt_pk_bf16_f32 v30, v16, v16
    v_lshlrev_b32 v16, 16, v30
    v_mul_f32 v16, v16, v29
    v_cvt_pk_bf16_f32 v30, v16, v16
    v_lshlrev_b32 v16, 16, v30
    v_sub_f32 v17, v17, v25
    v_cvt_pk_bf16_f32 v30, v17, v17
    v_lshlrev_b32 v17, 16, v30
    v_mul_f32 v17, v17, v29
    v_cvt_pk_bf16_f32 v30, v17, v17
    v_lshlrev_b32 v17, 16, v30
    v_sub_f32 v18, v18, v25
    v_cvt_pk_bf16_f32 v30, v18, v18
    v_lshlrev_b32 v18, 16, v30
    v_mul_f32 v18, v18, v29
    v_cvt_pk_bf16_f32 v30, v18, v18
    v_lshlrev_b32 v18, 16, v30
    v_sub_f32 v19, v19, v25
    v_cvt_pk_bf16_f32 v30, v19, v19
    v_lshlrev_b32 v19, 16, v30
    v_mul_f32 v19, v19, v29
    v_cvt_pk_bf16_f32 v30, v19, v19
    v_lshlrev_b32 v19, 16, v30
    v_sub_f32 v20, v20, v25
    v_cvt_pk_bf16_f32 v30, v20, v20
    v_lshlrev_b32 v20, 16, v30
    v_mul_f32 v20, v20, v29
    v_cvt_pk_bf16_f32 v30, v20, v20
    v_lshlrev_b32 v20, 16, v30
    v_sub_f32 v21, v21, v25
    v_cvt_pk_bf16_f32 v30, v21, v21
    v_lshlrev_b32 v21, 16, v30
    v_mul_f32 v21, v21, v29
    v_cvt_pk_bf16_f32 v30, v21, v21
    v_lshlrev_b32 v21, 16, v30
    v_sub_f32 v22, v22, v25
    v_cvt_pk_bf16_f32 v30, v22, v22
    v_lshlrev_b32 v22, 16, v30
    v_mul_f32 v22, v22, v29
    v_cvt_pk_bf16_f32 v30, v22, v22
    v_lshlrev_b32 v22, 16, v30
    v_sub_f32 v23, v23, v25
    v_cvt_pk_bf16_f32 v30, v23, v23
    v_lshlrev_b32 v23, 16, v30
    v_mul_f32 v23, v23, v29
    v_cvt_pk_bf16_f32 v30, v23, v23
    v_lshlrev_b32 v23, 16, v30
    v_add_f32 v24, v6, v12
    v_add_f32 v25, v16, v22
    v_add_f32 v26, v6, -v12
    v_add_f32 v27, v16, -v22
    v_add_f32 v28, v8, v10
    v_add_f32 v29, v18, v20
    v_add_f32 v30, v8, -v10
    v_add_f32 v31, v18, -v20
    v_mov_b32 v6, v4
    v_fmac_f32 v6, 0x3e9e377a, v24
    v_fmac_f32 v6, 0xbf4f1bbd, v28
    v_mov_b32 v8, v14
    v_fmac_f32 v8, 0x3e9e377a, v25
    v_fmac_f32 v8, 0xbf4f1bbd, v29
    v_mov_b32 v10, v4
    v_fmac_f32 v10, 0xbf4f1bbd, v24
    v_fmac_f32 v10, 0x3e9e377a, v28
    v_mov_b32 v12, v14
    v_fmac_f32 v12, 0xbf4f1bbd, v25
    v_fmac_f32 v12, 0x3e9e377a, v29
    v_mul_f32 v16, 0x3f737871, v26
    v_fmac_f32 v16, 0x3f167918, v30
    v_mul_f32 v18, 0x3f737871, v27
    v_fmac_f32 v18, 0x3f167918, v31
    v_mul_f32 v20, 0x3f167918, v26
    v_fmac_f32 v20, 0xbf737871, v30
    v_mul_f32 v22, 0x3f167918, v27
    v_fmac_f32 v22, 0xbf737871, v31
    v_add_f32 v32, v24, v28
    v_add_f32 v33, v25, v29
    v_add_f32 v34, v4, v32
    v_add_f32 v35, v14, v33
    v_add_f32 v4, v6, v18
    v_add_f32 v14, v8, -v16
    v_add_f32 v24, v6, -v18
    v_add_f32 v25, v8, v16
    v_add_f32 v26, v10, v22
    v_add_f32 v27, v12, -v20
    v_add_f32 v28, v10, -v22
    v_add_f32 v29, v12, v20
    v_add_f32 v6, v7, v13
    v_add_f32 v8, v17, v23
    v_add_f32 v10, v7, -v13
    v_add_f32 v12, v17, -v23
    v_add_f32 v16, v9, v11
    v_add_f32 v18, v19, v21
    v_add_f32 v20, v9, -v11
    v_add_f32 v22, v19, -v21
    v_mov_b32 v7, v5
    v_fmac_f32 v7, 0x3e9e377a, v6
    v_fmac_f32 v7, 0xbf4f1bbd, v16
    v_mov_b32 v9, v15
    v_fmac_f32 v9, 0x3e9e377a, v8
    v_fmac_f32 v9, 0xbf4f1bbd, v18
    v_mov_b32 v11, v5
    v_fmac_f32 v11, 0xbf4f1bbd, v6
    v_fmac_f32 v11, 0x3e9e377a, v16
    v_mov_b32 v13, v15
    v_fmac_f32 v13, 0xbf4f1bbd, v8
    v_fmac_f32 v13, 0x3e9e377a, v18
    v_mul_f32 v17, 0x3f737871, v10
    v_fmac_f32 v17, 0x3f167918, v20
    v_mul_f32 v19, 0x3f737871, v12
    v_fmac_f32 v19, 0x3f167918, v22
    v_mul_f32 v21, 0x3f167918, v10
    v_fmac_f32 v21, 0xbf737871, v20
    v_mul_f32 v23, 0x3f167918, v12
    v_fmac_f32 v23, 0xbf737871, v22
    v_add_f32 v30, v6, v16
    v_add_f32 v31, v8, v18
    v_add_f32 v32, v5, v30
    v_add_f32 v33, v15, v31
    v_add_f32 v5, v7, v19
    v_add_f32 v6, v9, -v17
    v_add_f32 v8, v7, -v19
    v_add_f32 v10, v9, v17
    v_add_f32 v12, v11, v23
    v_add_f32 v15, v13, -v21
    v_add_f32 v16, v11, -v23
    v_add_f32 v18, v13, v21
    v_add_f32 v7, v34, -v32
    v_add_f32 v9, v35, -v33
    v_add_f32 v34, v34, v32
    v_add_f32 v35, v35, v33
    v_mul_f32 v11, 0x3f4f1bbd, v5
    v_mul_f32 v13, 0xbf167918, v5
    v_fmac_f32 v11, 0x3f167918, v6
    v_fmac_f32 v13, 0x3f4f1bbd, v6
    v_add_f32 v5, v4, -v11
    v_add_f32 v6, v14, -v13
    v_add_f32 v4, v4, v11
    v_add_f32 v14, v14, v13
    v_mul_f32 v11, 0x3e9e377a, v12
    v_mul_f32 v13, 0xbf737871, v12
    v_fmac_f32 v11, 0x3f737871, v15
    v_fmac_f32 v13, 0x3e9e377a, v15
    v_add_f32 v12, v26, -v11
    v_add_f32 v15, v27, -v13
    v_add_f32 v26, v26, v11
    v_add_f32 v27, v27, v13
    v_mul_f32 v11, 0xbe9e377a, v16
    v_mul_f32 v13, 0xbf737871, v16
    v_fmac_f32 v11, 0x3f737871, v18
    v_fmac_f32 v13, 0xbe9e377a, v18
    v_add_f32 v16, v28, -v11
    v_add_f32 v17, v29, -v13
    v_add_f32 v28, v28, v11
    v_add_f32 v29, v29, v13
    v_mul_f32 v11, 0xbf4f1bbd, v8
    v_mul_f32 v13, 0xbf167918, v8
    v_fmac_f32 v11, 0x3f167918, v10
    v_fmac_f32 v13, 0xbf4f1bbd, v10
    v_add_f32 v8, v24, -v11
    v_add_f32 v10, v25, -v13
    v_add_f32 v24, v24, v11
    v_add_f32 v25, v25, v13
    v_mul_u32_u24 v11, 80, v2
    s_mul_i32 s22, s20, 5120
    v_add_u32 v11, s22, v11
    ds_write_b64 v11, v[34:35] offset:0
    v_mov_b32 v18, v4
    v_mov_b32 v19, v14
    ds_write_b64 v11, v[18:19] offset:8
    ds_write_b64 v11, v[26:27] offset:16
    ds_write_b64 v11, v[28:29] offset:24
    ds_write_b64 v11, v[24:25] offset:32
    v_mov_b32 v18, v7
    v_mov_b32 v19, v9
    ds_write_b64 v11, v[18:19] offset:40
    v_mov_b32 v18, v5
    v_mov_b32 v19, v6
    ds_write_b64 v11, v[18:19] offset:48
    v_mov_b32 v4, v12
    v_mov_b32 v5, v15
    ds_write_b64 v11, v[4:5] offset:56
    ds_write_b64 v11, v[16:17] offset:64
    v_mov_b32 v4, v8
    v_mov_b32 v5, v10
    ds_write_b64 v11, v[4:5] offset:72
k1a_kernel_p2:
    v_mul_u32_u24 v4, 205, v0
    v_lshrrev_b32 v4, 14, v4
    v_mul_u32_u24 v5, 80, v4
    v_sub_u32 v5, v0, v5
    v_mul_u32_u24 v6, 205, v5
    v_lshrrev_b32 v6, 11, v6
    v_mul_u32_u24 v7, 10, v6
    v_sub_u32 v7, v5, v7
    v_mul_u32_u24 v4, 5120, v4
    v_lshlrev_b32 v8, 3, v5
    v_add_u32 v8, v8, v4
    v_mul_u32_u24 v9, 80, v6
    v_add_u32 v9, v9, v7
    v_lshlrev_b32 v9, 3, v9
    v_add_u32 v9, v9, v4
    v_cvt_f32_u32 v11, v7
    v_cvt_f32_u32 v12, v5
    s_waitcnt lgkmcnt(0)
    s_barrier
    ds_read_b64 v[14:15], v8 offset:0
    ds_read_b64 v[16:17], v8 offset:640
    ds_read_b64 v[18:19], v8 offset:1280
    ds_read_b64 v[20:21], v8 offset:1920
    ds_read_b64 v[22:23], v8 offset:2560
    ds_read_b64 v[24:25], v8 offset:3200
    ds_read_b64 v[26:27], v8 offset:3840
    ds_read_b64 v[28:29], v8 offset:4480
    s_waitcnt lgkmcnt(0)
    v_mul_f32 v13, 0xbc4ccccd, v11
    v_cos_f32 v30, v13
    v_sin_f32 v31, v13
    v_mul_f32 v13, v16, v30
    v_mul_f32 v32, v16, v31
    v_fma_f32 v13, -v17, v31, v13
    v_fma_f32 v32, v17, v30, v32
    v_mul_f32 v16, 0xbccccccd, v11
    v_cos_f32 v17, v16
    v_sin_f32 v30, v16
    v_mul_f32 v16, v18, v17
    v_mul_f32 v31, v18, v30
    v_fma_f32 v16, -v19, v30, v16
    v_fma_f32 v31, v19, v17, v31
    v_mul_f32 v17, 0xbd19999a, v11
    v_cos_f32 v18, v17
    v_sin_f32 v19, v17
    v_mul_f32 v17, v20, v18
    v_mul_f32 v30, v20, v19
    v_fma_f32 v17, -v21, v19, v17
    v_fma_f32 v30, v21, v18, v30
    v_mul_f32 v18, 0xbd4ccccd, v11
    v_cos_f32 v19, v18
    v_sin_f32 v20, v18
    v_mul_f32 v18, v22, v19
    v_mul_f32 v21, v22, v20
    v_fma_f32 v18, -v23, v20, v18
    v_fma_f32 v21, v23, v19, v21
    v_mul_f32 v19, 0xbd800000, v11
    v_cos_f32 v20, v19
    v_sin_f32 v22, v19
    v_mul_f32 v19, v24, v20
    v_mul_f32 v23, v24, v22
    v_fma_f32 v19, -v25, v22, v19
    v_fma_f32 v23, v25, v20, v23
    v_mul_f32 v20, 0xbd99999a, v11
    v_cos_f32 v22, v20
    v_sin_f32 v24, v20
    v_mul_f32 v20, v26, v22
    v_mul_f32 v25, v26, v24
    v_fma_f32 v20, -v27, v24, v20
    v_fma_f32 v25, v27, v22, v25
    v_mul_f32 v22, 0xbdb33333, v11
    v_cos_f32 v24, v22
    v_sin_f32 v26, v22
    v_mul_f32 v22, v28, v24
    v_mul_f32 v27, v28, v26
    v_fma_f32 v22, -v29, v26, v22
    v_fma_f32 v27, v29, v24, v27
    v_add_f32 v24, v14, -v18
    v_add_f32 v26, v15, -v21
    v_add_f32 v14, v14, v18
    v_add_f32 v15, v15, v21
    v_add_f32 v18, v16, -v20
    v_add_f32 v21, v31, -v25
    v_add_f32 v16, v16, v20
    v_add_f32 v31, v31, v25
    v_add_f32 v20, v14, -v16
    v_add_f32 v25, v15, -v31
    v_add_f32 v14, v14, v16
    v_add_f32 v15, v15, v31
    v_add_f32 v16, v24, -v21
    v_add_f32 v28, v26, v18
    v_add_f32 v24, v24, v21
    v_add_f32 v26, v26, -v18
    v_add_f32 v18, v13, -v19
    v_add_f32 v21, v32, -v23
    v_add_f32 v13, v13, v19
    v_add_f32 v32, v32, v23
    v_add_f32 v19, v17, -v22
    v_add_f32 v23, v30, -v27
    v_add_f32 v17, v17, v22
    v_add_f32 v30, v30, v27
    v_add_f32 v22, v13, -v17
    v_add_f32 v27, v32, -v30
    v_add_f32 v13, v13, v17
    v_add_f32 v32, v32, v30
    v_add_f32 v17, v18, -v23
    v_add_f32 v29, v21, v19
    v_add_f32 v18, v18, v23
    v_add_f32 v21, v21, -v19
    v_add_f32 v19, v14, -v13
    v_add_f32 v23, v15, -v32
    v_add_f32 v14, v14, v13
    v_add_f32 v15, v15, v32
    v_mul_f32 v13, 0x3f3504f3, v18
    v_mul_f32 v30, 0xbf3504f3, v18
    v_fmac_f32 v13, 0x3f3504f3, v21
    v_fmac_f32 v30, 0x3f3504f3, v21
    v_add_f32 v18, v24, -v13
    v_add_f32 v21, v26, -v30
    v_add_f32 v24, v24, v13
    v_add_f32 v26, v26, v30
    v_add_f32 v13, v20, -v27
    v_add_f32 v30, v25, v22
    v_add_f32 v20, v20, v27
    v_add_f32 v25, v25, -v22
    v_mul_f32 v22, 0xbf3504f3, v17
    v_mul_f32 v27, 0xbf3504f3, v17
    v_fmac_f32 v22, 0x3f3504f3, v29
    v_fmac_f32 v27, 0xbf3504f3, v29
    v_add_f32 v17, v16, -v22
    v_add_f32 v29, v28, -v27
    v_add_f32 v16, v16, v22
    v_add_f32 v28, v28, v27
    ds_write_b64 v9, v[14:15] offset:20480
    v_mov_b32 v14, v24
    v_mov_b32 v15, v26
    ds_write_b64 v9, v[14:15] offset:20560
    v_mov_b32 v14, v20
    v_mov_b32 v15, v25
    ds_write_b64 v9, v[14:15] offset:20640
    v_mov_b32 v14, v16
    v_mov_b32 v15, v28
    ds_write_b64 v9, v[14:15] offset:20720
    v_mov_b32 v14, v19
    v_mov_b32 v15, v23
    ds_write_b64 v9, v[14:15] offset:20800
    v_mov_b32 v14, v18
    v_mov_b32 v15, v21
    ds_write_b64 v9, v[14:15] offset:20880
    v_mov_b32 v14, v13
    v_mov_b32 v15, v30
    ds_write_b64 v9, v[14:15] offset:20960
    v_mov_b32 v14, v17
    v_mov_b32 v15, v29
    ds_write_b64 v9, v[14:15] offset:21040
    s_waitcnt lgkmcnt(0)
    s_barrier
    ds_read_b64 v[14:15], v8 offset:20480
    ds_read_b64 v[16:17], v8 offset:21120
    ds_read_b64 v[18:19], v8 offset:21760
    ds_read_b64 v[20:21], v8 offset:22400
    ds_read_b64 v[22:23], v8 offset:23040
    ds_read_b64 v[24:25], v8 offset:23680
    ds_read_b64 v[26:27], v8 offset:24320
    ds_read_b64 v[28:29], v8 offset:24960
    s_waitcnt lgkmcnt(0)
    v_mul_f32 v13, 0xbacccccd, v12
    v_cos_f32 v30, v13
    v_sin_f32 v31, v13
    v_mul_f32 v13, v16, v30
    v_mul_f32 v32, v16, v31
    v_fma_f32 v13, -v17, v31, v13
    v_fma_f32 v32, v17, v30, v32
    v_mul_f32 v16, 0xbb4ccccd, v12
    v_cos_f32 v17, v16
    v_sin_f32 v30, v16
    v_mul_f32 v16, v18, v17
    v_mul_f32 v31, v18, v30
    v_fma_f32 v16, -v19, v30, v16
    v_fma_f32 v31, v19, v17, v31
    v_mul_f32 v17, 0xbb99999a, v12
    v_cos_f32 v18, v17
    v_sin_f32 v19, v17
    v_mul_f32 v17, v20, v18
    v_mul_f32 v30, v20, v19
    v_fma_f32 v17, -v21, v19, v17
    v_fma_f32 v30, v21, v18, v30
    v_mul_f32 v18, 0xbbcccccd, v12
    v_cos_f32 v19, v18
    v_sin_f32 v20, v18
    v_mul_f32 v18, v22, v19
    v_mul_f32 v21, v22, v20
    v_fma_f32 v18, -v23, v20, v18
    v_fma_f32 v21, v23, v19, v21
    v_mul_f32 v19, 0xbc000000, v12
    v_cos_f32 v20, v19
    v_sin_f32 v22, v19
    v_mul_f32 v19, v24, v20
    v_mul_f32 v23, v24, v22
    v_fma_f32 v19, -v25, v22, v19
    v_fma_f32 v23, v25, v20, v23
    v_mul_f32 v20, 0xbc19999a, v12
    v_cos_f32 v22, v20
    v_sin_f32 v24, v20
    v_mul_f32 v20, v26, v22
    v_mul_f32 v25, v26, v24
    v_fma_f32 v20, -v27, v24, v20
    v_fma_f32 v25, v27, v22, v25
    v_mul_f32 v22, 0xbc333333, v12
    v_cos_f32 v24, v22
    v_sin_f32 v26, v22
    v_mul_f32 v22, v28, v24
    v_mul_f32 v27, v28, v26
    v_fma_f32 v22, -v29, v26, v22
    v_fma_f32 v27, v29, v24, v27
    v_add_f32 v24, v14, -v18
    v_add_f32 v26, v15, -v21
    v_add_f32 v14, v14, v18
    v_add_f32 v15, v15, v21
    v_add_f32 v18, v16, -v20
    v_add_f32 v21, v31, -v25
    v_add_f32 v16, v16, v20
    v_add_f32 v31, v31, v25
    v_add_f32 v20, v14, -v16
    v_add_f32 v25, v15, -v31
    v_add_f32 v14, v14, v16
    v_add_f32 v15, v15, v31
    v_add_f32 v16, v24, -v21
    v_add_f32 v28, v26, v18
    v_add_f32 v24, v24, v21
    v_add_f32 v26, v26, -v18
    v_add_f32 v18, v13, -v19
    v_add_f32 v21, v32, -v23
    v_add_f32 v13, v13, v19
    v_add_f32 v32, v32, v23
    v_add_f32 v19, v17, -v22
    v_add_f32 v23, v30, -v27
    v_add_f32 v17, v17, v22
    v_add_f32 v30, v30, v27
    v_add_f32 v22, v13, -v17
    v_add_f32 v27, v32, -v30
    v_add_f32 v13, v13, v17
    v_add_f32 v32, v32, v30
    v_add_f32 v17, v18, -v23
    v_add_f32 v29, v21, v19
    v_add_f32 v18, v18, v23
    v_add_f32 v21, v21, -v19
    v_add_f32 v19, v14, -v13
    v_add_f32 v23, v15, -v32
    v_add_f32 v14, v14, v13
    v_add_f32 v15, v15, v32
    v_mul_f32 v13, 0x3f3504f3, v18
    v_mul_f32 v30, 0xbf3504f3, v18
    v_fmac_f32 v13, 0x3f3504f3, v21
    v_fmac_f32 v30, 0x3f3504f3, v21
    v_add_f32 v18, v24, -v13
    v_add_f32 v21, v26, -v30
    v_add_f32 v24, v24, v13
    v_add_f32 v26, v26, v30
    v_add_f32 v13, v20, -v27
    v_add_f32 v30, v25, v22
    v_add_f32 v20, v20, v27
    v_add_f32 v25, v25, -v22
    v_mul_f32 v22, 0xbf3504f3, v17
    v_mul_f32 v27, 0xbf3504f3, v17
    v_fmac_f32 v22, 0x3f3504f3, v29
    v_fmac_f32 v27, 0xbf3504f3, v29
    v_add_f32 v17, v16, -v22
    v_add_f32 v29, v28, -v27
    v_add_f32 v16, v16, v22
    v_add_f32 v28, v28, v27
    ds_write_b64 v8, v[14:15] offset:0
    v_mov_b32 v14, v24
    v_mov_b32 v15, v26
    ds_write_b64 v8, v[14:15] offset:640
    v_mov_b32 v14, v20
    v_mov_b32 v15, v25
    ds_write_b64 v8, v[14:15] offset:1280
    v_mov_b32 v14, v16
    v_mov_b32 v15, v28
    ds_write_b64 v8, v[14:15] offset:1920
    v_mov_b32 v14, v19
    v_mov_b32 v15, v23
    ds_write_b64 v8, v[14:15] offset:2560
    v_mov_b32 v14, v18
    v_mov_b32 v15, v21
    ds_write_b64 v8, v[14:15] offset:3200
    v_mov_b32 v14, v13
    v_mov_b32 v15, v30
    ds_write_b64 v8, v[14:15] offset:3840
    v_mov_b32 v14, v17
    v_mov_b32 v15, v29
    ds_write_b64 v8, v[14:15] offset:4480
    s_waitcnt lgkmcnt(0)
    s_barrier
    v_lshlrev_b32 v4, 3, v0
    v_sub_u32 v5, 640, v0
    v_cmp_eq_u32 vcc, 0, v0
    s_nop 1
    v_cndmask_b32 v5, v5, 0, vcc
    v_lshlrev_b32 v5, 3, v5
    ds_read_b64 v[6:7], v4 offset:0
    ds_read_b64 v[24:25], v5 offset:0
    ds_read_b64 v[26:27], v4 offset:5120
    ds_read_b64 v[28:29], v5 offset:5120
    ds_read_b64 v[30:31], v4 offset:10240
    ds_read_b64 v[32:33], v5 offset:10240
    ds_read_b64 v[34:35], v4 offset:15360
    ds_read_b64 v[36:37], v5 offset:15360
    s_waitcnt lgkmcnt(0)
    v_add_f32 v8, v6, v24
    v_sub_f32 v9, v7, v25
    v_add_f32 v10, v7, v25
    v_sub_f32 v11, v24, v6
    v_add_f32 v12, v26, v28
    v_sub_f32 v13, v27, v29
    v_add_f32 v14, v27, v29
    v_sub_f32 v15, v28, v26
    v_add_f32 v16, v30, v32
    v_sub_f32 v17, v31, v33
    v_add_f32 v18, v31, v33
    v_sub_f32 v19, v32, v30
    v_add_f32 v20, v34, v36
    v_sub_f32 v21, v35, v37
    v_add_f32 v22, v35, v37
    v_sub_f32 v23, v36, v34
    v_lshlrev_b32 v4, 14, v0
    s_lshl_b32 s22, s2, 6
    buffer_store_dwordx4 v[8:11], v4, s[12:15], s22 offen offset:0
    buffer_store_dwordx4 v[12:15], v4, s[12:15], s22 offen offset:16
    buffer_store_dwordx4 v[16:19], v4, s[12:15], s22 offen offset:32
    buffer_store_dwordx4 v[20:23], v4, s[12:15], s22 offen offset:48
    v_cmp_eq_u32 vcc, 0, v0
    s_and_saveexec_b64 s[24:25], vcc
    s_cbranch_execz k1a_kernel_end
    v_mov_b32 v4, 320
    v_lshlrev_b32 v5, 3, v4
    v_sub_u32 v6, 640, v4
    v_cmp_eq_u32 vcc, 0, v4
    s_nop 1
    v_cndmask_b32 v6, v6, 0, vcc
    v_lshlrev_b32 v6, 3, v6
    ds_read_b64 v[24:25], v5 offset:0
    ds_read_b64 v[26:27], v6 offset:0
    ds_read_b64 v[28:29], v5 offset:5120
    ds_read_b64 v[30:31], v6 offset:5120
    ds_read_b64 v[32:33], v5 offset:10240
    ds_read_b64 v[34:35], v6 offset:10240
    ds_read_b64 v[36:37], v5 offset:15360
    ds_read_b64 v[38:39], v6 offset:15360
    s_waitcnt lgkmcnt(0)
    v_add_f32 v8, v24, v26
    v_sub_f32 v9, v25, v27
    v_add_f32 v10, v25, v27
    v_sub_f32 v11, v26, v24
    v_add_f32 v12, v28, v30
    v_sub_f32 v13, v29, v31
    v_add_f32 v14, v29, v31
    v_sub_f32 v15, v30, v28
    v_add_f32 v16, v32, v34
    v_sub_f32 v17, v33, v35
    v_add_f32 v18, v33, v35
    v_sub_f32 v19, v34, v32
    v_add_f32 v20, v36, v38
    v_sub_f32 v21, v37, v39
    v_add_f32 v22, v37, v39
    v_sub_f32 v23, v38, v36
    v_lshlrev_b32 v5, 14, v4
    s_lshl_b32 s22, s2, 6
    buffer_store_dwordx4 v[8:11], v5, s[12:15], s22 offen offset:0
    buffer_store_dwordx4 v[12:15], v5, s[12:15], s22 offen offset:16
    buffer_store_dwordx4 v[16:19], v5, s[12:15], s22 offen offset:32
    buffer_store_dwordx4 v[20:23], v5, s[12:15], s22 offen offset:48
k1a_kernel_end:
    s_endpgm
.globl k2a_kernel
.p2align 8
.type k2a_kernel,@function
k2a_kernel:
    s_cmp_ge_u32 s2, 321
    s_cbranch_scc1 k2a_kernel_end
    s_load_dwordx4 s[4:7], s[0:1], 8
    s_load_dwordx2 s[16:17], s[0:1], 72
    s_waitcnt lgkmcnt(0)
    s_mov_b32 s8, s16
    s_and_b32 s9, s17, 0xffff
    s_mov_b32 s10, 0x504000
    s_mov_b32 s11, 0x00020000
    s_mov_b32 s12, s4
    s_and_b32 s13, s5, 0xffff
    s_mov_b32 s14, 0x141000
    s_mov_b32 s15, 0x00020000
    s_mov_b32 s20, s6
    s_and_b32 s21, s7, 0xffff
    s_mov_b32 s22, 0x141000
    s_mov_b32 s23, 0x00020000
    s_lshl_b32 s24, s2, 14
    s_add_u32 s32, s24, 0
    s_add_u32 s33, s24, 2048
    s_add_u32 s34, s24, 4096
    s_add_u32 s35, s24, 6144
    s_add_u32 s36, s24, 8192
    s_add_u32 s37, s24, 10240
    s_add_u32 s38, s24, 12288
    s_add_u32 s39, s24, 14336
    s_lshl_b32 s25, s2, 1
    s_add_u32 s40, s25, 0
    s_add_u32 s41, s25, 164352
    s_add_u32 s42, s25, 328704
    s_add_u32 s43, s25, 493056
    s_add_u32 s44, s25, 657408
    s_add_u32 s45, s25, 821760
    s_add_u32 s46, s25, 986112
    s_add_u32 s47, s25, 1150464
    v_lshlrev_b32 v2, 3, v0
    v_mul_u32_u24 v3, 642, v0
    buffer_load_dwordx2 v[4:5], v2, s[8:11], s32 offen
    buffer_load_dwordx2 v[6:7], v2, s[8:11], s33 offen
    buffer_load_dwordx2 v[8:9], v2, s[8:11], s34 offen
    buffer_load_dwordx2 v[10:11], v2, s[8:11], s35 offen
    buffer_load_dwordx2 v[12:13], v2, s[8:11], s36 offen
    buffer_load_dwordx2 v[14:15], v2, s[8:11], s37 offen
    buffer_load_dwordx2 v[16:17], v2, s[8:11], s38 offen
    buffer_load_dwordx2 v[18:19], v2, s[8:11], s39 offen
    buffer_load_ushort v20, v3, s[12:15], s40 offen
    buffer_load_ushort v21, v3, s[20:23], s40 offen
    buffer_load_ushort v22, v3, s[12:15], s41 offen
    buffer_load_ushort v23, v3, s[20:23], s41 offen
    buffer_load_ushort v24, v3, s[12:15], s42 offen
    buffer_load_ushort v25, v3, s[20:23], s42 offen
    buffer_load_ushort v26, v3, s[12:15], s43 offen
    buffer_load_ushort v27, v3, s[20:23], s43 offen
    buffer_load_ushort v28, v3, s[12:15], s44 offen
    buffer_load_ushort v29, v3, s[20:23], s44 offen
    buffer_load_ushort v30, v3, s[12:15], s45 offen
    buffer_load_ushort v31, v3, s[20:23], s45 offen
    buffer_load_ushort v32, v3, s[12:15], s46 offen
    buffer_load_ushort v33, v3, s[20:23], s46 offen
    buffer_load_ushort v34, v3, s[12:15], s47 offen
    buffer_load_ushort v35, v3, s[20:23], s47 offen
    v_lshlrev_b32 v3, 6, v0
    v_and_b32 v42, 7, v0
    v_cvt_f32_u32 v38, v42
    v_lshrrev_b32 v36, 3, v0
    v_lshlrev_b32 v36, 6, v36
    v_add_u32 v36, v36, v42
    v_lshlrev_b32 v36, 3, v36
    v_and_b32 v42, 63, v0
    v_cvt_f32_u32 v39, v42
    v_lshrrev_b32 v37, 6, v0
    v_lshlrev_b32 v37, 9, v37
    v_add_u32 v37, v37, v42
    v_lshlrev_b32 v37, 3, v37
    v_cvt_f32_u32 v40, v0
    v_add_f32 v41, 0x43800000, v40
    s_waitcnt vmcnt(16)
    v_add_f32 v42, v4, -v12
    v_add_f32 v43, v5, -v13
    v_add_f32 v4, v4, v12
    v_add_f32 v5, v5, v13
    v_add_f32 v12, v8, -v16
    v_add_f32 v13, v9, -v17
    v_add_f32 v8, v8, v16
    v_add_f32 v9, v9, v17
    v_add_f32 v16, v4, -v8
    v_add_f32 v17, v5, -v9
    v_add_f32 v4, v4, v8
    v_add_f32 v5, v5, v9
    v_add_f32 v8, v42, -v13
    v_add_f32 v9, v43, v12
    v_add_f32 v42, v42, v13
    v_add_f32 v43, v43, -v12
    v_add_f32 v12, v6, -v14
    v_add_f32 v13, v7, -v15
    v_add_f32 v6, v6, v14
    v_add_f32 v7, v7, v15
    v_add_f32 v14, v10, -v18
    v_add_f32 v15, v11, -v19
    v_add_f32 v10, v10, v18
    v_add_f32 v11, v11, v19
    v_add_f32 v18, v6, -v10
    v_add_f32 v19, v7, -v11
    v_add_f32 v6, v6, v10
    v_add_f32 v7, v7, v11
    v_add_f32 v10, v12, -v15
    v_add_f32 v11, v13, v14
    v_add_f32 v12, v12, v15
    v_add_f32 v13, v13, -v14
    v_add_f32 v14, v4, -v6
    v_add_f32 v15, v5, -v7
    v_add_f32 v4, v4, v6
    v_add_f32 v5, v5, v7
    v_mul_f32 v6, 0x3f3504f3, v12
    v_mul_f32 v7, 0xbf3504f3, v12
    v_fmac_f32 v6, 0x3f3504f3, v13
    v_fmac_f32 v7, 0x3f3504f3, v13
    v_add_f32 v12, v42, -v6
    v_add_f32 v13, v43, -v7
    v_add_f32 v42, v42, v6
    v_add_f32 v43, v43, v7
    v_add_f32 v6, v16, -v19
    v_add_f32 v7, v17, v18
    v_add_f32 v16, v16, v19
    v_add_f32 v17, v17, -v18
    v_mul_f32 v18, 0xbf3504f3, v10
    v_mul_f32 v19, 0xbf3504f3, v10
    v_fmac_f32 v18, 0x3f3504f3, v11
    v_fmac_f32 v19, 0xbf3504f3, v11
    v_add_f32 v10, v8, -v18
    v_add_f32 v11, v9, -v19
    v_add_f32 v8, v8, v18
    v_add_f32 v9, v9, v19
    ds_write_b64 v3, v[4:5] offset:0
    ds_write_b64 v3, v[42:43] offset:8
    ds_write_b64 v3, v[16:17] offset:16
    ds_write_b64 v3, v[8:9] offset:24
    ds_write_b64 v3, v[14:15] offset:32
    ds_write_b64 v3, v[12:13] offset:40
    ds_write_b64 v3, v[6:7] offset:48
    ds_write_b64 v3, v[10:11] offset:56
    s_waitcnt lgkmcnt(0)
    s_barrier
    ds_read_b64 v[4:5], v2 offset:0
    ds_read_b64 v[6:7], v2 offset:2048
    ds_read_b64 v[8:9], v2 offset:4096
    ds_read_b64 v[10:11], v2 offset:6144
    ds_read_b64 v[12:13], v2 offset:8192
    ds_read_b64 v[14:15], v2 offset:10240
    ds_read_b64 v[16:17], v2 offset:12288
    ds_read_b64 v[18:19], v2 offset:14336
    s_waitcnt lgkmcnt(0)
    v_mul_f32 v42, 0xbc800000, v38
    v_cos_f32 v43, v42
    v_sin_f32 v44, v42
    v_mul_f32 v42, v6, v43
    v_mul_f32 v45, v6, v44
    v_fma_f32 v42, -v7, v44, v42
    v_fma_f32 v45, v7, v43, v45
    v_mul_f32 v6, 0xbd000000, v38
    v_cos_f32 v7, v6
    v_sin_f32 v43, v6
    v_mul_f32 v6, v8, v7
    v_mul_f32 v44, v8, v43
    v_fma_f32 v6, -v9, v43, v6
    v_fma_f32 v44, v9, v7, v44
    v_mul_f32 v7, 0xbd400000, v38
    v_cos_f32 v8, v7
    v_sin_f32 v9, v7
    v_mul_f32 v7, v10, v8
    v_mul_f32 v43, v10, v9
    v_fma_f32 v7, -v11, v9, v7
    v_fma_f32 v43, v11, v8, v43
    v_mul_f32 v8, 0xbd800000, v38
    v_cos_f32 v9, v8
    v_sin_f32 v10, v8
    v_mul_f32 v8, v12, v9
    v_mul_f32 v11, v12, v10
    v_fma_f32 v8, -v13, v10, v8
    v_fma_f32 v11, v13, v9, v11
    v_mul_f32 v9, 0xbda00000, v38
    v_cos_f32 v10, v9
    v_sin_f32 v12, v9
    v_mul_f32 v9, v14, v10
    v_mul_f32 v13, v14, v12
    v_fma_f32 v9, -v15, v12, v9
    v_fma_f32 v13, v15, v10, v13
    v_mul_f32 v10, 0xbdc00000, v38
    v_cos_f32 v12, v10
    v_sin_f32 v14, v10
    v_mul_f32 v10, v16, v12
    v_mul_f32 v15, v16, v14
    v_fma_f32 v10, -v17, v14, v10
    v_fma_f32 v15, v17, v12, v15
    v_mul_f32 v12, 0xbde00000, v38
    v_cos_f32 v14, v12
    v_sin_f32 v16, v12
    v_mul_f32 v12, v18, v14
    v_mul_f32 v17, v18, v16
    v_fma_f32 v12, -v19, v16, v12
    v_fma_f32 v17, v19, v14, v17
    v_add_f32 v14, v4, -v8
    v_add_f32 v16, v5, -v11
    v_add_f32 v4, v4, v8
    v_add_f32 v5, v5, v11
    v_add_f32 v8, v6, -v10
    v_add_f32 v11, v44, -v15
    v_add_f32 v6, v6, v10
    v_add_f32 v44, v44, v15
    v_add_f32 v10, v4, -v6
    v_add_f32 v15, v5, -v44
    v_add_f32 v4, v4, v6
    v_add_f32 v5, v5, v44
    v_add_f32 v6, v14, -v11
    v_add_f32 v18, v16, v8
    v_add_f32 v14, v14, v11
    v_add_f32 v16, v16, -v8
    v_add_f32 v8, v42, -v9
    v_add_f32 v11, v45, -v13
    v_add_f32 v42, v42, v9
    v_add_f32 v45, v45, v13
    v_add_f32 v9, v7, -v12
    v_add_f32 v13, v43, -v17
    v_add_f32 v7, v7, v12
    v_add_f32 v43, v43, v17
    v_add_f32 v12, v42, -v7
    v_add_f32 v17, v45, -v43
    v_add_f32 v42, v42, v7
    v_add_f32 v45, v45, v43
    v_add_f32 v7, v8, -v13
    v_add_f32 v19, v11, v9
    v_add_f32 v8, v8, v13
    v_add_f32 v11, v11, -v9
    v_add_f32 v9, v4, -v42
    v_add_f32 v13, v5, -v45
    v_add_f32 v4, v4, v42
    v_add_f32 v5, v5, v45
    v_mul_f32 v42, 0x3f3504f3, v8
    v_mul_f32 v43, 0xbf3504f3, v8
    v_fmac_f32 v42, 0x3f3504f3, v11
    v_fmac_f32 v43, 0x3f3504f3, v11
    v_add_f32 v8, v14, -v42
    v_add_f32 v11, v16, -v43
    v_add_f32 v14, v14, v42
    v_add_f32 v16, v16, v43
    v_add_f32 v42, v10, -v17
    v_add_f32 v43, v15, v12
    v_add_f32 v10, v10, v17
    v_add_f32 v15, v15, -v12
    v_mul_f32 v12, 0xbf3504f3, v7
    v_mul_f32 v17, 0xbf3504f3, v7
    v_fmac_f32 v12, 0x3f3504f3, v19
    v_fmac_f32 v17, 0xbf3504f3, v19
    v_add_f32 v7, v6, -v12
    v_add_f32 v19, v18, -v17
    v_add_f32 v6, v6, v12
    v_add_f32 v18, v18, v17
    ds_write_b64 v36, v[4:5] offset:16384
    v_mov_b32 v4, v14
    v_mov_b32 v5, v16
    ds_write_b64 v36, v[4:5] offset:16448
    v_mov_b32 v4, v10
    v_mov_b32 v5, v15
    ds_write_b64 v36, v[4:5] offset:16512
    v_mov_b32 v4, v6
    v_mov_b32 v5, v18
    ds_write_b64 v36, v[4:5] offset:16576
    v_mov_b32 v4, v9
    v_mov_b32 v5, v13
    ds_write_b64 v36, v[4:5] offset:16640
    v_mov_b32 v4, v8
    v_mov_b32 v5, v11
    ds_write_b64 v36, v[4:5] offset:16704
    ds_write_b64 v36, v[42:43] offset:16768
    v_mov_b32 v4, v7
    v_mov_b32 v5, v19
    ds_write_b64 v36, v[4:5] offset:16832
    s_waitcnt lgkmcnt(0)
    s_barrier
    ds_read_b64 v[4:5], v2 offset:16384
    ds_read_b64 v[6:7], v2 offset:18432
    ds_read_b64 v[8:9], v2 offset:20480
    ds_read_b64 v[10:11], v2 offset:22528
    ds_read_b64 v[12:13], v2 offset:24576
    ds_read_b64 v[14:15], v2 offset:26624
    ds_read_b64 v[16:17], v2 offset:28672
    ds_read_b64 v[18:19], v2 offset:30720
    s_waitcnt lgkmcnt(0)
    v_mul_f32 v42, 0xbb000000, v39
    v_cos_f32 v43, v42
    v_sin_f32 v44, v42
    v_mul_f32 v42, v6, v43
    v_mul_f32 v45, v6, v44
    v_fma_f32 v42, -v7, v44, v42
    v_fma_f32 v45, v7, v43, v45
    v_mul_f32 v6, 0xbb800000, v39
    v_cos_f32 v7, v6
    v_sin_f32 v43, v6
    v_mul_f32 v6, v8, v7
    v_mul_f32 v44, v8, v43
    v_fma_f32 v6, -v9, v43, v6
    v_fma_f32 v44, v9, v7, v44
    v_mul_f32 v7, 0xbbc00000, v39
    v_cos_f32 v8, v7
    v_sin_f32 v9, v7
    v_mul_f32 v7, v10, v8
    v_mul_f32 v43, v10, v9
    v_fma_f32 v7, -v11, v9, v7
    v_fma_f32 v43, v11, v8, v43
    v_mul_f32 v8, 0xbc000000, v39
    v_cos_f32 v9, v8
    v_sin_f32 v10, v8
    v_mul_f32 v8, v12, v9
    v_mul_f32 v11, v12, v10
    v_fma_f32 v8, -v13, v10, v8
    v_fma_f32 v11, v13, v9, v11
    v_mul_f32 v9, 0xbc200000, v39
    v_cos_f32 v10, v9
    v_sin_f32 v12, v9
    v_mul_f32 v9, v14, v10
    v_mul_f32 v13, v14, v12
    v_fma_f32 v9, -v15, v12, v9
    v_fma_f32 v13, v15, v10, v13
    v_mul_f32 v10, 0xbc400000, v39
    v_cos_f32 v12, v10
    v_sin_f32 v14, v10
    v_mul_f32 v10, v16, v12
    v_mul_f32 v15, v16, v14
    v_fma_f32 v10, -v17, v14, v10
    v_fma_f32 v15, v17, v12, v15
    v_mul_f32 v12, 0xbc600000, v39
    v_cos_f32 v14, v12
    v_sin_f32 v16, v12
    v_mul_f32 v12, v18, v14
    v_mul_f32 v17, v18, v16
    v_fma_f32 v12, -v19, v16, v12
    v_fma_f32 v17, v19, v14, v17
    v_add_f32 v14, v4, -v8
    v_add_f32 v16, v5, -v11
    v_add_f32 v4, v4, v8
    v_add_f32 v5, v5, v11
    v_add_f32 v8, v6, -v10
    v_add_f32 v11, v44, -v15
    v_add_f32 v6, v6, v10
    v_add_f32 v44, v44, v15
    v_add_f32 v10, v4, -v6
    v_add_f32 v15, v5, -v44
    v_add_f32 v4, v4, v6
    v_add_f32 v5, v5, v44
    v_add_f32 v6, v14, -v11
    v_add_f32 v18, v16, v8
    v_add_f32 v14, v14, v11
    v_add_f32 v16, v16, -v8
    v_add_f32 v8, v42, -v9
    v_add_f32 v11, v45, -v13
    v_add_f32 v42, v42, v9
    v_add_f32 v45, v45, v13
    v_add_f32 v9, v7, -v12
    v_add_f32 v13, v43, -v17
    v_add_f32 v7, v7, v12
    v_add_f32 v43, v43, v17
    v_add_f32 v12, v42, -v7
    v_add_f32 v17, v45, -v43
    v_add_f32 v42, v42, v7
    v_add_f32 v45, v45, v43
    v_add_f32 v7, v8, -v13
    v_add_f32 v19, v11, v9
    v_add_f32 v8, v8, v13
    v_add_f32 v11, v11, -v9
    v_add_f32 v9, v4, -v42
    v_add_f32 v13, v5, -v45
    v_add_f32 v4, v4, v42
    v_add_f32 v5, v5, v45
    v_mul_f32 v42, 0x3f3504f3, v8
    v_mul_f32 v43, 0xbf3504f3, v8
    v_fmac_f32 v42, 0x3f3504f3, v11
    v_fmac_f32 v43, 0x3f3504f3, v11
    v_add_f32 v8, v14, -v42
    v_add_f32 v11, v16, -v43
    v_add_f32 v14, v14, v42
    v_add_f32 v16, v16, v43
    v_add_f32 v42, v10, -v17
    v_add_f32 v43, v15, v12
    v_add_f32 v10, v10, v17
    v_add_f32 v15, v15, -v12
    v_mul_f32 v12, 0xbf3504f3, v7
    v_mul_f32 v17, 0xbf3504f3, v7
    v_fmac_f32 v12, 0x3f3504f3, v19
    v_fmac_f32 v17, 0xbf3504f3, v19
    v_add_f32 v7, v6, -v12
    v_add_f32 v19, v18, -v17
    v_add_f32 v6, v6, v12
    v_add_f32 v18, v18, v17
    ds_write_b64 v37, v[4:5] offset:0
    v_mov_b32 v4, v14
    v_mov_b32 v5, v16
    ds_write_b64 v37, v[4:5] offset:512
    v_mov_b32 v4, v10
    v_mov_b32 v5, v15
    ds_write_b64 v37, v[4:5] offset:1024
    v_mov_b32 v4, v6
    v_mov_b32 v5, v18
    ds_write_b64 v37, v[4:5] offset:1536
    v_mov_b32 v4, v9
    v_mov_b32 v5, v13
    ds_write_b64 v37, v[4:5] offset:2048
    v_mov_b32 v4, v8
    v_mov_b32 v5, v11
    ds_write_b64 v37, v[4:5] offset:2560
    ds_write_b64 v37, v[42:43] offset:3072
    v_mov_b32 v4, v7
    v_mov_b32 v5, v19
    ds_write_b64 v37, v[4:5] offset:3584
    s_waitcnt lgkmcnt(0)
    s_barrier
    ds_read_b64 v[4:5], v2 offset:0
    ds_read_b64 v[6:7], v2 offset:2048
    ds_read_b64 v[8:9], v2 offset:4096
    ds_read_b64 v[10:11], v2 offset:6144
    ds_read_b64 v[12:13], v2 offset:8192
    ds_read_b64 v[14:15], v2 offset:10240
    ds_read_b64 v[16:17], v2 offset:12288
    ds_read_b64 v[18:19], v2 offset:14336
    s_waitcnt lgkmcnt(0)
    v_mul_f32 v42, 0xba000000, v40
    v_cos_f32 v43, v42
    v_sin_f32 v44, v42
    v_mul_f32 v42, v8, v43
    v_mul_f32 v45, v8, v44
    v_fma_f32 v42, -v9, v44, v42
    v_fma_f32 v45, v9, v43, v45
    v_mul_f32 v8, 0xba800000, v40
    v_cos_f32 v9, v8
    v_sin_f32 v43, v8
    v_mul_f32 v8, v12, v9
    v_mul_f32 v44, v12, v43
    v_fma_f32 v8, -v13, v43, v8
    v_fma_f32 v44, v13, v9, v44
    v_mul_f32 v9, 0xbac00000, v40
    v_cos_f32 v12, v9
    v_sin_f32 v13, v9
    v_mul_f32 v9, v16, v12
    v_mul_f32 v43, v16, v13
    v_fma_f32 v9, -v17, v13, v9
    v_fma_f32 v43, v17, v12, v43
    v_add_f32 v12, v4, -v8
    v_add_f32 v13, v5, -v44
    v_add_f32 v4, v4, v8
    v_add_f32 v5, v5, v44
    v_add_f32 v8, v42, -v9
    v_add_f32 v16, v45, -v43
    v_add_f32 v42, v42, v9
    v_add_f32 v45, v45, v43
    v_add_f32 v9, v4, -v42
    v_add_f32 v17, v5, -v45
    v_add_f32 v4, v4, v42
    v_add_f32 v5, v5, v45
    v_add_f32 v42, v12, -v16
    v_add_f32 v43, v13, v8
    v_add_f32 v12, v12, v16
    v_add_f32 v13, v13, -v8
    v_mul_f32 v8, 0xba000000, v41
    v_cos_f32 v16, v8
    v_sin_f32 v44, v8
    v_mul_f32 v8, v10, v16
    v_mul_f32 v45, v10, v44
    v_fma_f32 v8, -v11, v44, v8
    v_fma_f32 v45, v11, v16, v45
    v_mul_f32 v10, 0xba800000, v41
    v_cos_f32 v11, v10
    v_sin_f32 v16, v10
    v_mul_f32 v10, v14, v11
    v_mul_f32 v44, v14, v16
    v_fma_f32 v10, -v15, v16, v10
    v_fma_f32 v44, v15, v11, v44
    v_mul_f32 v11, 0xbac00000, v41
    v_cos_f32 v14, v11
    v_sin_f32 v15, v11
    v_mul_f32 v11, v18, v14
    v_mul_f32 v16, v18, v15
    v_fma_f32 v11, -v19, v15, v11
    v_fma_f32 v16, v19, v14, v16
    v_add_f32 v14, v6, -v10
    v_add_f32 v15, v7, -v44
    v_add_f32 v6, v6, v10
    v_add_f32 v7, v7, v44
    v_add_f32 v10, v8, -v11
    v_add_f32 v18, v45, -v16
    v_add_f32 v8, v8, v11
    v_add_f32 v45, v45, v16
    v_add_f32 v11, v6, -v8
    v_add_f32 v16, v7, -v45
    v_add_f32 v6, v6, v8
    v_add_f32 v7, v7, v45
    v_add_f32 v8, v14, -v18
    v_add_f32 v19, v15, v10
    v_add_f32 v14, v14, v18
    v_add_f32 v15, v15, -v10
    s_waitcnt vmcnt(0)
    v_lshlrev_b32 v20, 16, v20
    v_lshlrev_b32 v21, 16, v21
    v_mul_f32 v20, 0x34cccccd, v20
    v_mul_f32 v21, 0x34cccccd, v21
    v_mul_f32 v10, v4, v20
    v_mul_f32 v18, v4, v21
    v_fma_f32 v10, -v5, v21, v10
    v_fma_f32 v18, v5, v20, v18
    v_lshlrev_b32 v22, 16, v22
    v_lshlrev_b32 v23, 16, v23
    v_mul_f32 v22, 0x34cccccd, v22
    v_mul_f32 v23, 0x34cccccd, v23
    v_mul_f32 v4, v6, v22
    v_mul_f32 v5, v6, v23
    v_fma_f32 v4, -v7, v23, v4
    v_fma_f32 v5, v7, v22, v5
    v_lshlrev_b32 v24, 16, v24
    v_lshlrev_b32 v25, 16, v25
    v_mul_f32 v24, 0x34cccccd, v24
    v_mul_f32 v25, 0x34cccccd, v25
    v_mul_f32 v6, v12, v24
    v_mul_f32 v7, v12, v25
    v_fma_f32 v6, -v13, v25, v6
    v_fma_f32 v7, v13, v24, v7
    v_lshlrev_b32 v26, 16, v26
    v_lshlrev_b32 v27, 16, v27
    v_mul_f32 v26, 0x34cccccd, v26
    v_mul_f32 v27, 0x34cccccd, v27
    v_mul_f32 v12, v14, v26
    v_mul_f32 v13, v14, v27
    v_fma_f32 v12, -v15, v27, v12
    v_fma_f32 v13, v15, v26, v13
    v_lshlrev_b32 v28, 16, v28
    v_lshlrev_b32 v29, 16, v29
    v_mul_f32 v28, 0x34cccccd, v28
    v_mul_f32 v29, 0x34cccccd, v29
    v_mul_f32 v14, v9, v28
    v_mul_f32 v15, v9, v29
    v_fma_f32 v14, -v17, v29, v14
    v_fma_f32 v15, v17, v28, v15
    v_lshlrev_b32 v30, 16, v30
    v_lshlrev_b32 v31, 16, v31
    v_mul_f32 v30, 0x34cccccd, v30
    v_mul_f32 v31, 0x34cccccd, v31
    v_mul_f32 v9, v11, v30
    v_mul_f32 v17, v11, v31
    v_fma_f32 v9, -v16, v31, v9
    v_fma_f32 v17, v16, v30, v17
    v_lshlrev_b32 v32, 16, v32
    v_lshlrev_b32 v33, 16, v33
    v_mul_f32 v32, 0x34cccccd, v32
    v_mul_f32 v33, 0x34cccccd, v33
    v_mul_f32 v11, v42, v32
    v_mul_f32 v16, v42, v33
    v_fma_f32 v11, -v43, v33, v11
    v_fma_f32 v16, v43, v32, v16
    v_lshlrev_b32 v34, 16, v34
    v_lshlrev_b32 v35, 16, v35
    v_mul_f32 v34, 0x34cccccd, v34
    v_mul_f32 v35, 0x34cccccd, v35
    v_mul_f32 v20, v8, v34
    v_mul_f32 v21, v8, v35
    v_fma_f32 v20, -v19, v35, v20
    v_fma_f32 v21, v19, v34, v21
    v_add_f32 v8, v10, -v14
    v_add_f32 v19, v18, -v15
    v_add_f32 v10, v10, v14
    v_add_f32 v18, v18, v15
    v_add_f32 v14, v6, -v11
    v_add_f32 v15, v7, -v16
    v_add_f32 v6, v6, v11
    v_add_f32 v7, v7, v16
    v_add_f32 v11, v10, -v6
    v_add_f32 v16, v18, -v7
    v_add_f32 v10, v10, v6
    v_add_f32 v18, v18, v7
    v_add_f32 v6, v8, v15
    v_add_f32 v7, v19, -v14
    v_add_f32 v8, v8, -v15
    v_add_f32 v19, v19, v14
    v_add_f32 v14, v4, -v9
    v_add_f32 v15, v5, -v17
    v_add_f32 v4, v4, v9
    v_add_f32 v5, v5, v17
    v_add_f32 v9, v12, -v20
    v_add_f32 v17, v13, -v21
    v_add_f32 v12, v12, v20
    v_add_f32 v13, v13, v21
    v_add_f32 v20, v4, -v12
    v_add_f32 v21, v5, -v13
    v_add_f32 v4, v4, v12
    v_add_f32 v5, v5, v13
    v_add_f32 v12, v14, v17
    v_add_f32 v13, v15, -v9
    v_add_f32 v14, v14, -v17
    v_add_f32 v15, v15, v9
    v_add_f32 v9, v10, -v4
    v_add_f32 v17, v18, -v5
    v_add_f32 v10, v10, v4
    v_add_f32 v18, v18, v5
    v_mul_f32 v4, 0x3f3504f3, v14
    v_mul_f32 v5, 0x3f3504f3, v14
    v_fmac_f32 v4, 0xbf3504f3, v15
    v_fmac_f32 v5, 0x3f3504f3, v15
    v_add_f32 v14, v8, -v4
    v_add_f32 v15, v19, -v5
    v_add_f32 v8, v8, v4
    v_add_f32 v19, v19, v5
    v_add_f32 v4, v11, v21
    v_add_f32 v5, v16, -v20
    v_add_f32 v11, v11, -v21
    v_add_f32 v16, v16, v20
    v_mul_f32 v20, 0xbf3504f3, v12
    v_mul_f32 v21, 0x3f3504f3, v12
    v_fmac_f32 v20, 0xbf3504f3, v13
    v_fmac_f32 v21, 0xbf3504f3, v13
    v_add_f32 v12, v6, -v20
    v_add_f32 v13, v7, -v21
    v_add_f32 v6, v6, v20
    v_add_f32 v7, v7, v21
    v_mov_b32 v20, v10
    v_mov_b32 v21, v18
    ds_write_b64 v3, v[20:21] offset:16384
    v_mov_b32 v20, v8
    v_mov_b32 v21, v19
    ds_write_b64 v3, v[20:21] offset:16392
    v_mov_b32 v18, v11
    v_mov_b32 v19, v16
    ds_write_b64 v3, v[18:19] offset:16400
    ds_write_b64 v3, v[6:7] offset:16408
    v_mov_b32 v6, v9
    v_mov_b32 v7, v17
    ds_write_b64 v3, v[6:7] offset:16416
    ds_write_b64 v3, v[14:15] offset:16424
    ds_write_b64 v3, v[4:5] offset:16432
    ds_write_b64 v3, v[12:13] offset:16440
    s_waitcnt lgkmcnt(0)
    s_barrier
    ds_read_b64 v[4:5], v2 offset:16384
    ds_read_b64 v[6:7], v2 offset:18432
    ds_read_b64 v[8:9], v2 offset:20480
    ds_read_b64 v[10:11], v2 offset:22528
    ds_read_b64 v[12:13], v2 offset:24576
    ds_read_b64 v[14:15], v2 offset:26624
    ds_read_b64 v[16:17], v2 offset:28672
    ds_read_b64 v[18:19], v2 offset:30720
    s_waitcnt lgkmcnt(0)
    v_mul_f32 v20, 0x3c800000, v38
    v_cos_f32 v21, v20
    v_sin_f32 v22, v20
    v_mul_f32 v20, v6, v21
    v_mul_f32 v23, v6, v22
    v_fma_f32 v20, -v7, v22, v20
    v_fma_f32 v23, v7, v21, v23
    v_mul_f32 v6, 0x3d000000, v38
    v_cos_f32 v7, v6
    v_sin_f32 v21, v6
    v_mul_f32 v6, v8, v7
    v_mul_f32 v22, v8, v21
    v_fma_f32 v6, -v9, v21, v6
    v_fma_f32 v22, v9, v7, v22
    v_mul_f32 v7, 0x3d400000, v38
    v_cos_f32 v8, v7
    v_sin_f32 v9, v7
    v_mul_f32 v7, v10, v8
    v_mul_f32 v21, v10, v9
    v_fma_f32 v7, -v11, v9, v7
    v_fma_f32 v21, v11, v8, v21
    v_mul_f32 v8, 0x3d800000, v38
    v_cos_f32 v9, v8
    v_sin_f32 v10, v8
    v_mul_f32 v8, v12, v9
    v_mul_f32 v11, v12, v10
    v_fma_f32 v8, -v13, v10, v8
    v_fma_f32 v11, v13, v9, v11
    v_mul_f32 v9, 0x3da00000, v38
    v_cos_f32 v10, v9
    v_sin_f32 v12, v9
    v_mul_f32 v9, v14, v10
    v_mul_f32 v13, v14, v12
    v_fma_f32 v9, -v15, v12, v9
    v_fma_f32 v13, v15, v10, v13
    v_mul_f32 v10, 0x3dc00000, v38
    v_cos_f32 v12, v10
    v_sin_f32 v14, v10
    v_mul_f32 v10, v16, v12
    v_mul_f32 v15, v16, v14
    v_fma_f32 v10, -v17, v14, v10
    v_fma_f32 v15, v17, v12, v15
    v_mul_f32 v12, 0x3de00000, v38
    v_cos_f32 v14, v12
    v_sin_f32 v16, v12
    v_mul_f32 v12, v18, v14
    v_mul_f32 v17, v18, v16
    v_fma_f32 v12, -v19, v16, v12
    v_fma_f32 v17, v19, v14, v17
    v_add_f32 v14, v4, -v8
    v_add_f32 v16, v5, -v11
    v_add_f32 v4, v4, v8
    v_add_f32 v5, v5, v11
    v_add_f32 v8, v6, -v10
    v_add_f32 v11, v22, -v15
    v_add_f32 v6, v6, v10
    v_add_f32 v22, v22, v15
    v_add_f32 v10, v4, -v6
    v_add_f32 v15, v5, -v22
    v_add_f32 v4, v4, v6
    v_add_f32 v5, v5, v22
    v_add_f32 v6, v14, v11
    v_add_f32 v18, v16, -v8
    v_add_f32 v14, v14, -v11
    v_add_f32 v16, v16, v8
    v_add_f32 v8, v20, -v9
    v_add_f32 v11, v23, -v13
    v_add_f32 v20, v20, v9
    v_add_f32 v23, v23, v13
    v_add_f32 v9, v7, -v12
    v_add_f32 v13, v21, -v17
    v_add_f32 v7, v7, v12
    v_add_f32 v21, v21, v17
    v_add_f32 v12, v20, -v7
    v_add_f32 v17, v23, -v21
    v_add_f32 v20, v20, v7
    v_add_f32 v23, v23, v21
    v_add_f32 v7, v8, v13
    v_add_f32 v19, v11, -v9
    v_add_f32 v8, v8, -v13
    v_add_f32 v11, v11, v9
    v_add_f32 v9, v4, -v20
    v_add_f32 v13, v5, -v23
    v_add_f32 v4, v4, v20
    v_add_f32 v5, v5, v23
    v_mul_f32 v20, 0x3f3504f3, v8
    v_mul_f32 v21, 0x3f3504f3, v8
    v_fmac_f32 v20, 0xbf3504f3, v11
    v_fmac_f32 v21, 0x3f3504f3, v11
    v_add_f32 v8, v14, -v20
    v_add_f32 v11, v16, -v21
    v_add_f32 v14, v14, v20
    v_add_f32 v16, v16, v21
    v_add_f32 v20, v10, v17
    v_add_f32 v21, v15, -v12
    v_add_f32 v10, v10, -v17
    v_add_f32 v15, v15, v12
    v_mul_f32 v12, 0xbf3504f3, v7
    v_mul_f32 v17, 0x3f3504f3, v7
    v_fmac_f32 v12, 0xbf3504f3, v19
    v_fmac_f32 v17, 0xbf3504f3, v19
    v_add_f32 v7, v6, -v12
    v_add_f32 v19, v18, -v17
    v_add_f32 v6, v6, v12
    v_add_f32 v18, v18, v17
    ds_write_b64 v36, v[4:5] offset:0
    v_mov_b32 v4, v14
    v_mov_b32 v5, v16
    ds_write_b64 v36, v[4:5] offset:64
    v_mov_b32 v4, v10
    v_mov_b32 v5, v15
    ds_write_b64 v36, v[4:5] offset:128
    v_mov_b32 v4, v6
    v_mov_b32 v5, v18
    ds_write_b64 v36, v[4:5] offset:192
    v_mov_b32 v4, v9
    v_mov_b32 v5, v13
    ds_write_b64 v36, v[4:5] offset:256
    v_mov_b32 v4, v8
    v_mov_b32 v5, v11
    ds_write_b64 v36, v[4:5] offset:320
    ds_write_b64 v36, v[20:21] offset:384
    v_mov_b32 v4, v7
    v_mov_b32 v5, v19
    ds_write_b64 v36, v[4:5] offset:448
    s_waitcnt lgkmcnt(0)
    s_barrier
    ds_read_b64 v[4:5], v2 offset:0
    ds_read_b64 v[6:7], v2 offset:2048
    ds_read_b64 v[8:9], v2 offset:4096
    ds_read_b64 v[10:11], v2 offset:6144
    ds_read_b64 v[12:13], v2 offset:8192
    ds_read_b64 v[14:15], v2 offset:10240
    ds_read_b64 v[16:17], v2 offset:12288
    ds_read_b64 v[18:19], v2 offset:14336
    s_waitcnt lgkmcnt(0)
    v_mul_f32 v20, 0x3b000000, v39
    v_cos_f32 v21, v20
    v_sin_f32 v22, v20
    v_mul_f32 v20, v6, v21
    v_mul_f32 v23, v6, v22
    v_fma_f32 v20, -v7, v22, v20
    v_fma_f32 v23, v7, v21, v23
    v_mul_f32 v6, 0x3b800000, v39
    v_cos_f32 v7, v6
    v_sin_f32 v21, v6
    v_mul_f32 v6, v8, v7
    v_mul_f32 v22, v8, v21
    v_fma_f32 v6, -v9, v21, v6
    v_fma_f32 v22, v9, v7, v22
    v_mul_f32 v7, 0x3bc00000, v39
    v_cos_f32 v8, v7
    v_sin_f32 v9, v7
    v_mul_f32 v7, v10, v8
    v_mul_f32 v21, v10, v9
    v_fma_f32 v7, -v11, v9, v7
    v_fma_f32 v21, v11, v8, v21
    v_mul_f32 v8, 0x3c000000, v39
    v_cos_f32 v9, v8
    v_sin_f32 v10, v8
    v_mul_f32 v8, v12, v9
    v_mul_f32 v11, v12, v10
    v_fma_f32 v8, -v13, v10, v8
    v_fma_f32 v11, v13, v9, v11
    v_mul_f32 v9, 0x3c200000, v39
    v_cos_f32 v10, v9
    v_sin_f32 v12, v9
    v_mul_f32 v9, v14, v10
    v_mul_f32 v13, v14, v12
    v_fma_f32 v9, -v15, v12, v9
    v_fma_f32 v13, v15, v10, v13
    v_mul_f32 v10, 0x3c400000, v39
    v_cos_f32 v12, v10
    v_sin_f32 v14, v10
    v_mul_f32 v10, v16, v12
    v_mul_f32 v15, v16, v14
    v_fma_f32 v10, -v17, v14, v10
    v_fma_f32 v15, v17, v12, v15
    v_mul_f32 v12, 0x3c600000, v39
    v_cos_f32 v14, v12
    v_sin_f32 v16, v12
    v_mul_f32 v12, v18, v14
    v_mul_f32 v17, v18, v16
    v_fma_f32 v12, -v19, v16, v12
    v_fma_f32 v17, v19, v14, v17
    v_add_f32 v14, v4, -v8
    v_add_f32 v16, v5, -v11
    v_add_f32 v4, v4, v8
    v_add_f32 v5, v5, v11
    v_add_f32 v8, v6, -v10
    v_add_f32 v11, v22, -v15
    v_add_f32 v6, v6, v10
    v_add_f32 v22, v22, v15
    v_add_f32 v10, v4, -v6
    v_add_f32 v15, v5, -v22
    v_add_f32 v4, v4, v6
    v_add_f32 v5, v5, v22
    v_add_f32 v6, v14, v11
    v_add_f32 v18, v16, -v8
    v_add_f32 v14, v14, -v11
    v_add_f32 v16, v16, v8
    v_add_f32 v8, v20, -v9
    v_add_f32 v11, v23, -v13
    v_add_f32 v20, v20, v9
    v_add_f32 v23, v23, v13
    v_add_f32 v9, v7, -v12
    v_add_f32 v13, v21, -v17
    v_add_f32 v7, v7, v12
    v_add_f32 v21, v21, v17
    v_add_f32 v12, v20, -v7
    v_add_f32 v17, v23, -v21
    v_add_f32 v20, v20, v7
    v_add_f32 v23, v23, v21
    v_add_f32 v7, v8, v13
    v_add_f32 v19, v11, -v9
    v_add_f32 v8, v8, -v13
    v_add_f32 v11, v11, v9
    v_add_f32 v9, v4, -v20
    v_add_f32 v13, v5, -v23
    v_add_f32 v4, v4, v20
    v_add_f32 v5, v5, v23
    v_mul_f32 v20, 0x3f3504f3, v8
    v_mul_f32 v21, 0x3f3504f3, v8
    v_fmac_f32 v20, 0xbf3504f3, v11
    v_fmac_f32 v21, 0x3f3504f3, v11
    v_add_f32 v8, v14, -v20
    v_add_f32 v11, v16, -v21
    v_add_f32 v14, v14, v20
    v_add_f32 v16, v16, v21
    v_add_f32 v20, v10, v17
    v_add_f32 v21, v15, -v12
    v_add_f32 v10, v10, -v17
    v_add_f32 v15, v15, v12
    v_mul_f32 v12, 0xbf3504f3, v7
    v_mul_f32 v17, 0x3f3504f3, v7
    v_fmac_f32 v12, 0xbf3504f3, v19
    v_fmac_f32 v17, 0xbf3504f3, v19
    v_add_f32 v7, v6, -v12
    v_add_f32 v19, v18, -v17
    v_add_f32 v6, v6, v12
    v_add_f32 v18, v18, v17
    ds_write_b64 v37, v[4:5] offset:16384
    v_mov_b32 v4, v14
    v_mov_b32 v5, v16
    ds_write_b64 v37, v[4:5] offset:16896
    v_mov_b32 v4, v10
    v_mov_b32 v5, v15
    ds_write_b64 v37, v[4:5] offset:17408
    v_mov_b32 v4, v6
    v_mov_b32 v5, v18
    ds_write_b64 v37, v[4:5] offset:17920
    v_mov_b32 v4, v9
    v_mov_b32 v5, v13
    ds_write_b64 v37, v[4:5] offset:18432
    v_mov_b32 v4, v8
    v_mov_b32 v5, v11
    ds_write_b64 v37, v[4:5] offset:18944
    ds_write_b64 v37, v[20:21] offset:19456
    v_mov_b32 v4, v7
    v_mov_b32 v5, v19
    ds_write_b64 v37, v[4:5] offset:19968
    s_waitcnt lgkmcnt(0)
    s_barrier
    ds_read_b64 v[4:5], v2 offset:16384
    ds_read_b64 v[6:7], v2 offset:18432
    ds_read_b64 v[8:9], v2 offset:20480
    ds_read_b64 v[10:11], v2 offset:22528
    ds_read_b64 v[12:13], v2 offset:24576
    ds_read_b64 v[14:15], v2 offset:26624
    ds_read_b64 v[16:17], v2 offset:28672
    ds_read_b64 v[18:19], v2 offset:30720
    s_waitcnt lgkmcnt(0)
    v_mul_f32 v20, 0x3a000000, v40
    v_cos_f32 v21, v20
    v_sin_f32 v22, v20
    v_mul_f32 v20, v8, v21
    v_mul_f32 v23, v8, v22
    v_fma_f32 v20, -v9, v22, v20
    v_fma_f32 v23, v9, v21, v23
    v_mul_f32 v8, 0x3a800000, v40
    v_cos_f32 v9, v8
    v_sin_f32 v21, v8
    v_mul_f32 v8, v12, v9
    v_mul_f32 v22, v12, v21
    v_fma_f32 v8, -v13, v21, v8
    v_fma_f32 v22, v13, v9, v22
    v_mul_f32 v9, 0x3ac00000, v40
    v_cos_f32 v12, v9
    v_sin_f32 v13, v9
    v_mul_f32 v9, v16, v12
    v_mul_f32 v21, v16, v13
    v_fma_f32 v9, -v17, v13, v9
    v_fma_f32 v21, v17, v12, v21
    v_add_f32 v12, v4, -v8
    v_add_f32 v13, v5, -v22
    v_add_f32 v4, v4, v8
    v_add_f32 v5, v5, v22
    v_add_f32 v8, v20, -v9
    v_add_f32 v16, v23, -v21
    v_add_f32 v20, v20, v9
    v_add_f32 v23, v23, v21
    v_add_f32 v9, v4, -v20
    v_add_f32 v17, v5, -v23
    v_add_f32 v4, v4, v20
    v_add_f32 v5, v5, v23
    v_add_f32 v20, v12, v16
    v_add_f32 v21, v13, -v8
    v_add_f32 v12, v12, -v16
    v_add_f32 v13, v13, v8
    v_mul_f32 v8, 0x3a000000, v41
    v_cos_f32 v16, v8
    v_sin_f32 v22, v8
    v_mul_f32 v8, v10, v16
    v_mul_f32 v23, v10, v22
    v_fma_f32 v8, -v11, v22, v8
    v_fma_f32 v23, v11, v16, v23
    v_mul_f32 v10, 0x3a800000, v41
    v_cos_f32 v11, v10
    v_sin_f32 v16, v10
    v_mul_f32 v10, v14, v11
    v_mul_f32 v22, v14, v16
    v_fma_f32 v10, -v15, v16, v10
    v_fma_f32 v22, v15, v11, v22
    v_mul_f32 v11, 0x3ac00000, v41
    v_cos_f32 v14, v11
    v_sin_f32 v15, v11
    v_mul_f32 v11, v18, v14
    v_mul_f32 v16, v18, v15
    v_fma_f32 v11, -v19, v15, v11
    v_fma_f32 v16, v19, v14, v16
    v_add_f32 v14, v6, -v10
    v_add_f32 v15, v7, -v22
    v_add_f32 v6, v6, v10
    v_add_f32 v7, v7, v22
    v_add_f32 v10, v8, -v11
    v_add_f32 v18, v23, -v16
    v_add_f32 v8, v8, v11
    v_add_f32 v23, v23, v16
    v_add_f32 v11, v6, -v8
    v_add_f32 v16, v7, -v23
    v_add_f32 v6, v6, v8
    v_add_f32 v7, v7, v23
    v_add_f32 v8, v14, v18
    v_add_f32 v19, v15, -v10
    v_add_f32 v14, v14, -v18
    v_add_f32 v15, v15, v10
    buffer_store_dwordx2 v[4:5], v2, s[8:11], s32 offen
    buffer_store_dwordx2 v[6:7], v2, s[8:11], s33 offen
    buffer_store_dwordx2 v[12:13], v2, s[8:11], s34 offen
    buffer_store_dwordx2 v[14:15], v2, s[8:11], s35 offen
    v_mov_b32 v4, v9
    v_mov_b32 v5, v17
    buffer_store_dwordx2 v[4:5], v2, s[8:11], s36 offen
    v_mov_b32 v4, v11
    v_mov_b32 v5, v16
    buffer_store_dwordx2 v[4:5], v2, s[8:11], s37 offen
    buffer_store_dwordx2 v[20:21], v2, s[8:11], s38 offen
    v_mov_b32 v4, v8
    v_mov_b32 v5, v19
    buffer_store_dwordx2 v[4:5], v2, s[8:11], s39 offen
k2a_kernel_end:
    s_endpgm
.globl k3a_kernel
.p2align 8
.type k3a_kernel,@function
k3a_kernel:
    s_cmp_ge_u32 s2, 256
    s_cbranch_scc1 k3a_kernel_end
    s_load_dwordx2 s[4:5], s[0:1], 0
    s_load_dwordx2 s[6:7], s[0:1], 72
    v_lshrrev_b32 v1, 6, v0
    s_nop 0
    v_readfirstlane_b32 s20, v1
    v_and_b32 v2, 63, v0
    s_waitcnt lgkmcnt(0)
    s_mov_b32 s8, s4
    s_and_b32 s9, s5, 0xffff
    s_mov_b32 s10, 0x280000
    s_mov_b32 s11, 0x00020000
    s_mov_b32 s28, s6
    s_mov_b32 s29, s7
    s_mov_b32 s12, s6
    s_and_b32 s13, s7, 0xffff
    s_mov_b32 s14, 0x504000
    s_mov_b32 s15, 0x00020000
    s_mov_b32 s6, s28
    s_mov_b32 s7, s29
    s_add_u32 s6, s6, 0x800000
    s_addc_u32 s7, s7, 0
    s_mov_b32 s32, s6
    s_and_b32 s33, s7, 0xffff
    s_mov_b32 s34, 0x280000
    s_mov_b32 s35, 0x00020000
    s_add_u32 s28, s28, 0xc00000
    s_addc_u32 s29, s29, 0
    s_mov_b32 s36, s28
    s_and_b32 s37, s29, 0xffff
    s_mov_b32 s38, 0x280000
    s_mov_b32 s39, 0x00020000
    v_lshlrev_b32 v3, 1, v2
    s_mul_i32 s21, s2, 10240
    s_mul_i32 s22, s20, 2560
    s_add_u32 s21, s21, s22
    s_cmp_ge_u32 s20, 4
    s_cbranch_scc1 k3a_kernel_p0
    buffer_load_ushort v4, v3, s[8:11], s21 offen offset:0
    buffer_load_ushort v14, v3, s[8:11], s21 offen offset:1280
    buffer_load_ushort v5, v3, s[8:11], s21 offen offset:128
    buffer_load_ushort v15, v3, s[8:11], s21 offen offset:1408
    buffer_load_ushort v6, v3, s[8:11], s21 offen offset:256
    buffer_load_ushort v16, v3, s[8:11], s21 offen offset:1536
    buffer_load_ushort v7, v3, s[8:11], s21 offen offset:384
    buffer_load_ushort v17, v3, s[8:11], s21 offen offset:1664
    buffer_load_ushort v8, v3, s[8:11], s21 offen offset:512
    buffer_load_ushort v18, v3, s[8:11], s21 offen offset:1792
    buffer_load_ushort v9, v3, s[8:11], s21 offen offset:640
    buffer_load_ushort v19, v3, s[8:11], s21 offen offset:1920
    buffer_load_ushort v10, v3, s[8:11], s21 offen offset:768
    buffer_load_ushort v20, v3, s[8:11], s21 offen offset:2048
    buffer_load_ushort v11, v3, s[8:11], s21 offen offset:896
    buffer_load_ushort v21, v3, s[8:11], s21 offen offset:2176
    buffer_load_ushort v12, v3, s[8:11], s21 offen offset:1024
    buffer_load_ushort v22, v3, s[8:11], s21 offen offset:2304
    buffer_load_ushort v13, v3, s[8:11], s21 offen offset:1152
    buffer_load_ushort v23, v3, s[8:11], s21 offen offset:2432
k3a_kernel_p0:
    v_lshlrev_b32 v24, 14, v0
    s_lshl_b32 s22, s2, 6
    buffer_load_dwordx4 v[28:31], v24, s[12:15], s22 offen offset:0
    buffer_load_dwordx4 v[32:35], v24, s[12:15], s22 offen offset:16
    buffer_load_dwordx4 v[36:39], v24, s[12:15], s22 offen offset:32
    buffer_load_dwordx4 v[40:43], v24, s[12:15], s22 offen offset:48
    v_lshlrev_b32 v24, 3, v0
    v_sub_u32 v25, 640, v0
    v_cmp_eq_u32 vcc, 0, v0
    s_nop 1
    v_cndmask_b32 v25, v25, 0, vcc
    v_lshlrev_b32 v25, 3, v25
    s_waitcnt vmcnt(0)
    v_cndmask_b32 v29, v29, 0, vcc
    v_cndmask_b32 v31, v31, 0, vcc
    v_sub_f32 v26, v28, v31
    v_add_f32 v27, v29, v30
    v_add_f32 v44, v28, v31
    v_sub_f32 v45, v30, v29
    ds_write_b64 v24, v[26:27] offset:0
    ds_write_b64 v25, v[44:45] offset:0
    v_cndmask_b32 v33, v33, 0, vcc
    v_cndmask_b32 v35, v35, 0, vcc
    v_sub_f32 v26, v32, v35
    v_add_f32 v27, v33, v34
    v_add_f32 v44, v32, v35
    v_sub_f32 v45, v34, v33
    ds_write_b64 v24, v[26:27] offset:5120
    ds_write_b64 v25, v[44:45] offset:5120
    v_cndmask_b32 v37, v37, 0, vcc
    v_cndmask_b32 v39, v39, 0, vcc
    v_sub_f32 v26, v36, v39
    v_add_f32 v27, v37, v38
    v_add_f32 v44, v36, v39
    v_sub_f32 v45, v38, v37
    ds_write_b64 v24, v[26:27] offset:10240
    ds_write_b64 v25, v[44:45] offset:10240
    v_cndmask_b32 v41, v41, 0, vcc
    v_cndmask_b32 v43, v43, 0, vcc
    v_sub_f32 v26, v40, v43
    v_add_f32 v27, v41, v42
    v_add_f32 v44, v40, v43
    v_sub_f32 v45, v42, v41
    ds_write_b64 v24, v[26:27] offset:15360
    ds_write_b64 v25, v[44:45] offset:15360
    v_cmp_eq_u32 vcc, 0, v0
    s_and_saveexec_b64 s[24:25], vcc
    s_cbranch_execz k3a_kernel_skip320
    v_mov_b32 v24, 320
    v_lshlrev_b32 v25, 14, v24
    s_lshl_b32 s22, s2, 6
    buffer_load_dwordx4 v[28:31], v25, s[12:15], s22 offen offset:0
    buffer_load_dwordx4 v[32:35], v25, s[12:15], s22 offen offset:16
    buffer_load_dwordx4 v[36:39], v25, s[12:15], s22 offen offset:32
    buffer_load_dwordx4 v[40:43], v25, s[12:15], s22 offen offset:48
    v_lshlrev_b32 v25, 3, v24
    v_sub_u32 v26, 640, v24
    v_cmp_eq_u32 vcc, 0, v24
    s_nop 1
    v_cndmask_b32 v26, v26, 0, vcc
    v_lshlrev_b32 v26, 3, v26
    v_cmp_eq_u32 vcc, 320, v24
    s_waitcnt vmcnt(0)
    s_nop 0
    v_cndmask_b32 v29, v29, 0, vcc
    v_cndmask_b32 v31, v31, 0, vcc
    v_sub_f32 v44, v28, v31
    v_add_f32 v45, v29, v30
    v_add_f32 v46, v28, v31
    v_sub_f32 v47, v30, v29
    ds_write_b64 v25, v[44:45] offset:0
    ds_write_b64 v26, v[46:47] offset:0
    v_cndmask_b32 v33, v33, 0, vcc
    v_cndmask_b32 v35, v35, 0, vcc
    v_sub_f32 v44, v32, v35
    v_add_f32 v45, v33, v34
    v_add_f32 v46, v32, v35
    v_sub_f32 v47, v34, v33
    ds_write_b64 v25, v[44:45] offset:5120
    ds_write_b64 v26, v[46:47] offset:5120
    v_cndmask_b32 v37, v37, 0, vcc
    v_cndmask_b32 v39, v39, 0, vcc
    v_sub_f32 v44, v36, v39
    v_add_f32 v45, v37, v38
    v_add_f32 v46, v36, v39
    v_sub_f32 v47, v38, v37
    ds_write_b64 v25, v[44:45] offset:10240
    ds_write_b64 v26, v[46:47] offset:10240
    v_cndmask_b32 v41, v41, 0, vcc
    v_cndmask_b32 v43, v43, 0, vcc
    v_sub_f32 v44, v40, v43
    v_add_f32 v45, v41, v42
    v_add_f32 v46, v40, v43
    v_sub_f32 v47, v42, v41
    ds_write_b64 v25, v[44:45] offset:15360
    ds_write_b64 v26, v[46:47] offset:15360
k3a_kernel_skip320:
    s_mov_b64 exec, s[24:25]
    v_mul_u32_u24 v24, 205, v0
    v_lshrrev_b32 v24, 14, v24
    v_mul_u32_u24 v25, 80, v24
    v_sub_u32 v25, v0, v25
    v_mul_u32_u24 v24, 5120, v24
    v_lshlrev_b32 v28, 3, v25
    v_add_u32 v28, v28, v24
    v_lshlrev_b32 v29, 6, v25
    v_add_u32 v29, v29, v24
    v_lshrrev_b32 v26, 3, v25
    v_and_b32 v27, 7, v25
    v_lshlrev_b32 v30, 6, v26
    v_add_u32 v30, v30, v27
    v_lshlrev_b32 v30, 3, v30
    v_add_u32 v30, v30, v24
    v_cvt_f32_u32 v31, v27
    s_waitcnt lgkmcnt(0)
    s_barrier
    ds_read_b64 v[32:33], v28 offset:0
    ds_read_b64 v[34:35], v28 offset:640
    ds_read_b64 v[36:37], v28 offset:1280
    ds_read_b64 v[38:39], v28 offset:1920
    ds_read_b64 v[40:41], v28 offset:2560
    ds_read_b64 v[42:43], v28 offset:3200
    ds_read_b64 v[44:45], v28 offset:3840
    ds_read_b64 v[46:47], v28 offset:4480
    s_waitcnt lgkmcnt(0)
    v_add_f32 v48, v32, -v40
    v_add_f32 v49, v33, -v41
    v_add_f32 v32, v32, v40
    v_add_f32 v33, v33, v41
    v_add_f32 v40, v36, -v44
    v_add_f32 v41, v37, -v45
    v_add_f32 v36, v36, v44
    v_add_f32 v37, v37, v45
    v_add_f32 v44, v32, -v36
    v_add_f32 v45, v33, -v37
    v_add_f32 v32, v32, v36
    v_add_f32 v33, v33, v37
    v_add_f32 v36, v48, v41
    v_add_f32 v37, v49, -v40
    v_add_f32 v48, v48, -v41
    v_add_f32 v49, v49, v40
    v_add_f32 v40, v34, -v42
    v_add_f32 v41, v35, -v43
    v_add_f32 v34, v34, v42
    v_add_f32 v35, v35, v43
    v_add_f32 v42, v38, -v46
    v_add_f32 v43, v39, -v47
    v_add_f32 v38, v38, v46
    v_add_f32 v39, v39, v47
    v_add_f32 v46, v34, -v38
    v_add_f32 v47, v35, -v39
    v_add_f32 v34, v34, v38
    v_add_f32 v35, v35, v39
    v_add_f32 v38, v40, v43
    v_add_f32 v39, v41, -v42
    v_add_f32 v40, v40, -v43
    v_add_f32 v41, v41, v42
    v_add_f32 v42, v32, -v34
    v_add_f32 v43, v33, -v35
    v_add_f32 v32, v32, v34
    v_add_f32 v33, v33, v35
    v_mul_f32 v34, 0x3f3504f3, v40
    v_mul_f32 v35, 0x3f3504f3, v40
    v_fmac_f32 v34, 0xbf3504f3, v41
    v_fmac_f32 v35, 0x3f3504f3, v41
    v_add_f32 v40, v48, -v34
    v_add_f32 v41, v49, -v35
    v_add_f32 v48, v48, v34
    v_add_f32 v49, v49, v35
    v_add_f32 v34, v44, v47
    v_add_f32 v35, v45, -v46
    v_add_f32 v44, v44, -v47
    v_add_f32 v45, v45, v46
    v_mul_f32 v46, 0xbf3504f3, v38
    v_mul_f32 v47, 0x3f3504f3, v38
    v_fmac_f32 v46, 0xbf3504f3, v39
    v_fmac_f32 v47, 0xbf3504f3, v39
    v_add_f32 v38, v36, -v46
    v_add_f32 v39, v37, -v47
    v_add_f32 v36, v36, v46
    v_add_f32 v37, v37, v47
    ds_write_b64 v29, v[32:33] offset:20480
    ds_write_b64 v29, v[48:49] offset:20488
    ds_write_b64 v29, v[44:45] offset:20496
    ds_write_b64 v29, v[36:37] offset:20504
    ds_write_b64 v29, v[42:43] offset:20512
    ds_write_b64 v29, v[40:41] offset:20520
    ds_write_b64 v29, v[34:35] offset:20528
    ds_write_b64 v29, v[38:39] offset:20536
    s_waitcnt lgkmcnt(0)
    s_barrier
    ds_read_b64 v[32:33], v28 offset:20480
    ds_read_b64 v[34:35], v28 offset:21120
    ds_read_b64 v[36:37], v28 offset:21760
    ds_read_b64 v[38:39], v28 offset:22400
    ds_read_b64 v[40:41], v28 offset:23040
    ds_read_b64 v[42:43], v28 offset:23680
    ds_read_b64 v[44:45], v28 offset:24320
    ds_read_b64 v[46:47], v28 offset:24960
    s_waitcnt lgkmcnt(0)
    v_mul_f32 v48, 0x3c800000, v31
    v_cos_f32 v49, v48
    v_sin_f32 v50, v48
    v_mul_f32 v48, v34, v49
    v_mul_f32 v51, v34, v50
    v_fma_f32 v48, -v35, v50, v48
    v_fma_f32 v51, v35, v49, v51
    v_mul_f32 v34, 0x3d000000, v31
    v_cos_f32 v35, v34
    v_sin_f32 v49, v34
    v_mul_f32 v34, v36, v35
    v_mul_f32 v50, v36, v49
    v_fma_f32 v34, -v37, v49, v34
    v_fma_f32 v50, v37, v35, v50
    v_mul_f32 v35, 0x3d400000, v31
    v_cos_f32 v36, v35
    v_sin_f32 v37, v35
    v_mul_f32 v35, v38, v36
    v_mul_f32 v49, v38, v37
    v_fma_f32 v35, -v39, v37, v35
    v_fma_f32 v49, v39, v36, v49
    v_mul_f32 v36, 0x3d800000, v31
    v_cos_f32 v37, v36
    v_sin_f32 v38, v36
    v_mul_f32 v36, v40, v37
    v_mul_f32 v39, v40, v38
    v_fma_f32 v36, -v41, v38, v36
    v_fma_f32 v39, v41, v37, v39
    v_mul_f32 v37, 0x3da00000, v31
    v_cos_f32 v38, v37
    v_sin_f32 v40, v37
    v_mul_f32 v37, v42, v38
    v_mul_f32 v41, v42, v40
    v_fma_f32 v37, -v43, v40, v37
    v_fma_f32 v41, v43, v38, v41
    v_mul_f32 v38, 0x3dc00000, v31
    v_cos_f32 v40, v38
    v_sin_f32 v42, v38
    v_mul_f32 v38, v44, v40
    v_mul_f32 v43, v44, v42
    v_fma_f32 v38, -v45, v42, v38
    v_fma_f32 v43, v45, v40, v43
    v_mul_f32 v40, 0x3de00000, v31
    v_cos_f32 v42, v40
    v_sin_f32 v44, v40
    v_mul_f32 v40, v46, v42
    v_mul_f32 v45, v46, v44
    v_fma_f32 v40, -v47, v44, v40
    v_fma_f32 v45, v47, v42, v45
    v_add_f32 v42, v32, -v36
    v_add_f32 v44, v33, -v39
    v_add_f32 v32, v32, v36
    v_add_f32 v33, v33, v39
    v_add_f32 v36, v34, -v38
    v_add_f32 v39, v50, -v43
    v_add_f32 v34, v34, v38
    v_add_f32 v50, v50, v43
    v_add_f32 v38, v32, -v34
    v_add_f32 v43, v33, -v50
    v_add_f32 v32, v32, v34
    v_add_f32 v33, v33, v50
    v_add_f32 v34, v42, v39
    v_add_f32 v46, v44, -v36
    v_add_f32 v42, v42, -v39
    v_add_f32 v44, v44, v36
    v_add_f32 v36, v48, -v37
    v_add_f32 v39, v51, -v41
    v_add_f32 v48, v48, v37
    v_add_f32 v51, v51, v41
    v_add_f32 v37, v35, -v40
    v_add_f32 v41, v49, -v45
    v_add_f32 v35, v35, v40
    v_add_f32 v49, v49, v45
    v_add_f32 v40, v48, -v35
    v_add_f32 v45, v51, -v49
    v_add_f32 v48, v48, v35
    v_add_f32 v51, v51, v49
    v_add_f32 v35, v36, v41
    v_add_f32 v47, v39, -v37
    v_add_f32 v36, v36, -v41
    v_add_f32 v39, v39, v37
    v_add_f32 v37, v32, -v48
    v_add_f32 v41, v33, -v51
    v_add_f32 v32, v32, v48
    v_add_f32 v33, v33, v51
    v_mul_f32 v48, 0x3f3504f3, v36
    v_mul_f32 v49, 0x3f3504f3, v36
    v_fmac_f32 v48, 0xbf3504f3, v39
    v_fmac_f32 v49, 0x3f3504f3, v39
    v_add_f32 v36, v42, -v48
    v_add_f32 v39, v44, -v49
    v_add_f32 v42, v42, v48
    v_add_f32 v44, v44, v49
    v_add_f32 v48, v38, v45
    v_add_f32 v49, v43, -v40
    v_add_f32 v38, v38, -v45
    v_add_f32 v43, v43, v40
    v_mul_f32 v40, 0xbf3504f3, v35
    v_mul_f32 v45, 0x3f3504f3, v35
    v_fmac_f32 v40, 0xbf3504f3, v47
    v_fmac_f32 v45, 0xbf3504f3, v47
    v_add_f32 v35, v34, -v40
    v_add_f32 v47, v46, -v45
    v_add_f32 v34, v34, v40
    v_add_f32 v46, v46, v45
    ds_write_b64 v30, v[32:33] offset:0
    v_mov_b32 v32, v42
    v_mov_b32 v33, v44
    ds_write_b64 v30, v[32:33] offset:64
    v_mov_b32 v32, v38
    v_mov_b32 v33, v43
    ds_write_b64 v30, v[32:33] offset:128
    v_mov_b32 v32, v34
    v_mov_b32 v33, v46
    ds_write_b64 v30, v[32:33] offset:192
    v_mov_b32 v32, v37
    v_mov_b32 v33, v41
    ds_write_b64 v30, v[32:33] offset:256
    v_mov_b32 v32, v36
    v_mov_b32 v33, v39
    ds_write_b64 v30, v[32:33] offset:320
    ds_write_b64 v30, v[48:49] offset:384
    v_mov_b32 v32, v35
    v_mov_b32 v33, v47
    ds_write_b64 v30, v[32:33] offset:448
    s_waitcnt lgkmcnt(0)
    s_barrier
    s_cmp_ge_u32 s20, 4
    s_cbranch_scc1 k3a_kernel_end
    v_lshlrev_b32 v24, 3, v2
    s_mul_i32 s22, s20, 5120
    v_add_u32 v24, s22, v24
    v_cvt_f32_u32 v25, v2
    ds_read_b64 v[26:27], v24 offset:0
    ds_read_b64 v[28:29], v24 offset:512
    ds_read_b64 v[30:31], v24 offset:1024
    ds_read_b64 v[32:33], v24 offset:1536
    ds_read_b64 v[34:35], v24 offset:2048
    ds_read_b64 v[36:37], v24 offset:2560
    ds_read_b64 v[38:39], v24 offset:3072
    ds_read_b64 v[40:41], v24 offset:3584
    ds_read_b64 v[42:43], v24 offset:4096
    ds_read_b64 v[44:45], v24 offset:4608
    s_waitcnt lgkmcnt(0)
    v_mul_f32 v46, 0x3acccccd, v25
    v_cos_f32 v47, v46
    v_sin_f32 v48, v46
    v_mul_f32 v46, v28, v47
    v_mul_f32 v49, v28, v48
    v_fma_f32 v46, -v29, v48, v46
    v_fma_f32 v49, v29, v47, v49
    v_mul_f32 v28, 0x3b4ccccd, v25
    v_cos_f32 v29, v28
    v_sin_f32 v47, v28
    v_mul_f32 v28, v30, v29
    v_mul_f32 v48, v30, v47
    v_fma_f32 v28, -v31, v47, v28
    v_fma_f32 v48, v31, v29, v48
    v_mul_f32 v29, 0x3b99999a, v25
    v_cos_f32 v30, v29
    v_sin_f32 v31, v29
    v_mul_f32 v29, v32, v30
    v_mul_f32 v47, v32, v31
    v_fma_f32 v29, -v33, v31, v29
    v_fma_f32 v47, v33, v30, v47
    v_mul_f32 v30, 0x3bcccccd, v25
    v_cos_f32 v31, v30
    v_sin_f32 v32, v30
    v_mul_f32 v30, v34, v31
    v_mul_f32 v33, v34, v32
    v_fma_f32 v30, -v35, v32, v30
    v_fma_f32 v33, v35, v31, v33
    v_mul_f32 v31, 0x3c000000, v25
    v_cos_f32 v32, v31
    v_sin_f32 v34, v31
    v_mul_f32 v31, v36, v32
    v_mul_f32 v35, v36, v34
    v_fma_f32 v31, -v37, v34, v31
    v_fma_f32 v35, v37, v32, v35
    v_mul_f32 v32, 0x3c19999a, v25
    v_cos_f32 v34, v32
    v_sin_f32 v36, v32
    v_mul_f32 v32, v38, v34
    v_mul_f32 v37, v38, v36
    v_fma_f32 v32, -v39, v36, v32
    v_fma_f32 v37, v39, v34, v37
    v_mul_f32 v34, 0x3c333333, v25
    v_cos_f32 v36, v34
    v_sin_f32 v38, v34
    v_mul_f32 v34, v40, v36
    v_mul_f32 v39, v40, v38
    v_fma_f32 v34, -v41, v38, v34
    v_fma_f32 v39, v41, v36, v39
    v_mul_f32 v36, 0x3c4ccccd, v25
    v_cos_f32 v38, v36
    v_sin_f32 v40, v36
    v_mul_f32 v36, v42, v38
    v_mul_f32 v41, v42, v40
    v_fma_f32 v36, -v43, v40, v36
    v_fma_f32 v41, v43, v38, v41
    v_mul_f32 v38, 0x3c666666, v25
    v_cos_f32 v40, v38
    v_sin_f32 v42, v38
    v_mul_f32 v38, v44, v40
    v_mul_f32 v43, v44, v42
    v_fma_f32 v38, -v45, v42, v38
    v_fma_f32 v43, v45, v40, v43
    v_add_f32 v40, v28, v36
    v_add_f32 v42, v48, v41
    v_add_f32 v44, v28, -v36
    v_add_f32 v45, v48, -v41
    v_add_f32 v50, v30, v32
    v_add_f32 v51, v33, v37
    v_add_f32 v52, v30, -v32
    v_add_f32 v53, v33, -v37
    v_mov_b32 v28, v26
    v_fmac_f32 v28, 0x3e9e377a, v40
    v_fmac_f32 v28, 0xbf4f1bbd, v50
    v_mov_b32 v30, v27
    v_fmac_f32 v30, 0x3e9e377a, v42
    v_fmac_f32 v30, 0xbf4f1bbd, v51
    v_mov_b32 v32, v26
    v_fmac_f32 v32, 0xbf4f1bbd, v40
    v_fmac_f32 v32, 0x3e9e377a, v50
    v_mov_b32 v33, v27
    v_fmac_f32 v33, 0xbf4f1bbd, v42
    v_fmac_f32 v33, 0x3e9e377a, v51
    v_mul_f32 v36, 0x3f737871, v44
    v_fmac_f32 v36, 0x3f167918, v52
    v_mul_f32 v37, 0x3f737871, v45
    v_fmac_f32 v37, 0x3f167918, v53
    v_mul_f32 v41, 0x3f167918, v44
    v_fmac_f32 v41, 0xbf737871, v52
    v_mul_f32 v48, 0x3f167918, v45
    v_fmac_f32 v48, 0xbf737871, v53
    v_add_f32 v54, v40, v50
    v_add_f32 v55, v42, v51
    v_add_f32 v56, v26, v54
    v_add_f32 v57, v27, v55
    v_add_f32 v26, v28, -v37
    v_add_f32 v27, v30, v36
    v_add_f32 v40, v28, v37
    v_add_f32 v42, v30, -v36
    v_add_f32 v44, v32, -v48
    v_add_f32 v45, v33, v41
    v_add_f32 v50, v32, v48
    v_add_f32 v51, v33, -v41
    v_add_f32 v28, v29, v38
    v_add_f32 v30, v47, v43
    v_add_f32 v32, v29, -v38
    v_add_f32 v33, v47, -v43
    v_add_f32 v36, v31, v34
    v_add_f32 v37, v35, v39
    v_add_f32 v41, v31, -v34
    v_add_f32 v48, v35, -v39
    v_mov_b32 v29, v46
    v_fmac_f32 v29, 0x3e9e377a, v28
    v_fmac_f32 v29, 0xbf4f1bbd, v36
    v_mov_b32 v31, v49
    v_fmac_f32 v31, 0x3e9e377a, v30
    v_fmac_f32 v31, 0xbf4f1bbd, v37
    v_mov_b32 v34, v46
    v_fmac_f32 v34, 0xbf4f1bbd, v28
    v_fmac_f32 v34, 0x3e9e377a, v36
    v_mov_b32 v35, v49
    v_fmac_f32 v35, 0xbf4f1bbd, v30
    v_fmac_f32 v35, 0x3e9e377a, v37
    v_mul_f32 v38, 0x3f737871, v32
    v_fmac_f32 v38, 0x3f167918, v41
    v_mul_f32 v39, 0x3f737871, v33
    v_fmac_f32 v39, 0x3f167918, v48
    v_mul_f32 v43, 0x3f167918, v32
    v_fmac_f32 v43, 0xbf737871, v41
    v_mul_f32 v47, 0x3f167918, v33
    v_fmac_f32 v47, 0xbf737871, v48
    v_add_f32 v52, v28, v36
    v_add_f32 v53, v30, v37
    v_add_f32 v54, v46, v52
    v_add_f32 v55, v49, v53
    v_add_f32 v28, v29, -v39
    v_add_f32 v30, v31, v38
    v_add_f32 v32, v29, v39
    v_add_f32 v33, v31, -v38
    v_add_f32 v36, v34, -v47
    v_add_f32 v37, v35, v43
    v_add_f32 v41, v34, v47
    v_add_f32 v46, v35, -v43
    v_add_f32 v29, v56, -v54
    v_add_f32 v31, v57, -v55
    v_add_f32 v56, v56, v54
    v_add_f32 v57, v57, v55
    v_mul_f32 v34, 0x3f4f1bbd, v28
    v_mul_f32 v35, 0x3f167918, v28
    v_fmac_f32 v34, 0xbf167918, v30
    v_fmac_f32 v35, 0x3f4f1bbd, v30
    v_add_f32 v28, v26, -v34
    v_add_f32 v30, v27, -v35
    v_add_f32 v26, v26, v34
    v_add_f32 v27, v27, v35
    v_mul_f32 v34, 0x3e9e377a, v36
    v_mul_f32 v35, 0x3f737871, v36
    v_fmac_f32 v34, 0xbf737871, v37
    v_fmac_f32 v35, 0x3e9e377a, v37
    v_add_f32 v36, v44, -v34
    v_add_f32 v37, v45, -v35
    v_add_f32 v44, v44, v34
    v_add_f32 v45, v45, v35
    v_mul_f32 v34, 0xbe9e377a, v41
    v_mul_f32 v35, 0x3f737871, v41
    v_fmac_f32 v34, 0xbf737871, v46
    v_fmac_f32 v35, 0xbe9e377a, v46
    v_add_f32 v38, v50, -v34
    v_add_f32 v39, v51, -v35
    v_add_f32 v50, v50, v34
    v_add_f32 v51, v51, v35
    v_mul_f32 v34, 0xbf4f1bbd, v32
    v_mul_f32 v35, 0x3f167918, v32
    v_fmac_f32 v34, 0xbf167918, v33
    v_fmac_f32 v35, 0xbf4f1bbd, v33
    v_add_f32 v32, v40, -v34
    v_add_f32 v33, v42, -v35
    v_add_f32 v40, v40, v34
    v_add_f32 v42, v42, v35
    s_waitcnt vmcnt(0)
    v_cvt_pk_bf16_f32 v24, v56, v56
    v_lshlrev_b32 v56, 16, v24
    v_lshlrev_b32 v4, 16, v4
    v_add_f32 v4, v4, v56
    v_cvt_pk_bf16_f32 v24, v4, v4
    v_lshlrev_b32 v4, 16, v24
    v_cvt_pk_bf16_f32 v24, v57, v57
    v_lshlrev_b32 v57, 16, v24
    v_lshlrev_b32 v14, 16, v14
    v_add_f32 v14, v14, v57
    v_cvt_pk_bf16_f32 v24, v14, v14
    v_lshlrev_b32 v14, 16, v24
    v_cvt_pk_bf16_f32 v24, v26, v26
    v_lshlrev_b32 v26, 16, v24
    v_lshlrev_b32 v5, 16, v5
    v_add_f32 v5, v5, v26
    v_cvt_pk_bf16_f32 v24, v5, v5
    v_lshlrev_b32 v5, 16, v24
    v_cvt_pk_bf16_f32 v24, v27, v27
    v_lshlrev_b32 v27, 16, v24
    v_lshlrev_b32 v15, 16, v15
    v_add_f32 v15, v15, v27
    v_cvt_pk_bf16_f32 v24, v15, v15
    v_lshlrev_b32 v15, 16, v24
    v_cvt_pk_bf16_f32 v24, v44, v44
    v_lshlrev_b32 v44, 16, v24
    v_lshlrev_b32 v6, 16, v6
    v_add_f32 v6, v6, v44
    v_cvt_pk_bf16_f32 v24, v6, v6
    v_lshlrev_b32 v6, 16, v24
    v_cvt_pk_bf16_f32 v24, v45, v45
    v_lshlrev_b32 v45, 16, v24
    v_lshlrev_b32 v16, 16, v16
    v_add_f32 v16, v16, v45
    v_cvt_pk_bf16_f32 v24, v16, v16
    v_lshlrev_b32 v16, 16, v24
    v_cvt_pk_bf16_f32 v24, v50, v50
    v_lshlrev_b32 v50, 16, v24
    v_lshlrev_b32 v7, 16, v7
    v_add_f32 v7, v7, v50
    v_cvt_pk_bf16_f32 v24, v7, v7
    v_lshlrev_b32 v7, 16, v24
    v_cvt_pk_bf16_f32 v24, v51, v51
    v_lshlrev_b32 v51, 16, v24
    v_lshlrev_b32 v17, 16, v17
    v_add_f32 v17, v17, v51
    v_cvt_pk_bf16_f32 v24, v17, v17
    v_lshlrev_b32 v17, 16, v24
    v_cvt_pk_bf16_f32 v24, v40, v40
    v_lshlrev_b32 v40, 16, v24
    v_lshlrev_b32 v8, 16, v8
    v_add_f32 v8, v8, v40
    v_cvt_pk_bf16_f32 v24, v8, v8
    v_lshlrev_b32 v8, 16, v24
    v_cvt_pk_bf16_f32 v24, v42, v42
    v_lshlrev_b32 v42, 16, v24
    v_lshlrev_b32 v18, 16, v18
    v_add_f32 v18, v18, v42
    v_cvt_pk_bf16_f32 v24, v18, v18
    v_lshlrev_b32 v18, 16, v24
    v_cvt_pk_bf16_f32 v24, v29, v29
    v_lshlrev_b32 v29, 16, v24
    v_lshlrev_b32 v9, 16, v9
    v_add_f32 v9, v9, v29
    v_cvt_pk_bf16_f32 v24, v9, v9
    v_lshlrev_b32 v9, 16, v24
    v_cvt_pk_bf16_f32 v24, v31, v31
    v_lshlrev_b32 v31, 16, v24
    v_lshlrev_b32 v19, 16, v19
    v_add_f32 v19, v19, v31
    v_cvt_pk_bf16_f32 v24, v19, v19
    v_lshlrev_b32 v19, 16, v24
    v_cvt_pk_bf16_f32 v24, v28, v28
    v_lshlrev_b32 v28, 16, v24
    v_lshlrev_b32 v10, 16, v10
    v_add_f32 v10, v10, v28
    v_cvt_pk_bf16_f32 v24, v10, v10
    v_lshlrev_b32 v10, 16, v24
    v_cvt_pk_bf16_f32 v24, v30, v30
    v_lshlrev_b32 v30, 16, v24
    v_lshlrev_b32 v20, 16, v20
    v_add_f32 v20, v20, v30
    v_cvt_pk_bf16_f32 v24, v20, v20
    v_lshlrev_b32 v20, 16, v24
    v_cvt_pk_bf16_f32 v24, v36, v36
    v_lshlrev_b32 v36, 16, v24
    v_lshlrev_b32 v11, 16, v11
    v_add_f32 v11, v11, v36
    v_cvt_pk_bf16_f32 v24, v11, v11
    v_lshlrev_b32 v11, 16, v24
    v_cvt_pk_bf16_f32 v24, v37, v37
    v_lshlrev_b32 v37, 16, v24
    v_lshlrev_b32 v21, 16, v21
    v_add_f32 v21, v21, v37
    v_cvt_pk_bf16_f32 v24, v21, v21
    v_lshlrev_b32 v21, 16, v24
    v_cvt_pk_bf16_f32 v24, v38, v38
    v_lshlrev_b32 v38, 16, v24
    v_lshlrev_b32 v12, 16, v12
    v_add_f32 v12, v12, v38
    v_cvt_pk_bf16_f32 v24, v12, v12
    v_lshlrev_b32 v12, 16, v24
    v_cvt_pk_bf16_f32 v24, v39, v39
    v_lshlrev_b32 v39, 16, v24
    v_lshlrev_b32 v22, 16, v22
    v_add_f32 v22, v22, v39
    v_cvt_pk_bf16_f32 v24, v22, v22
    v_lshlrev_b32 v22, 16, v24
    v_cvt_pk_bf16_f32 v24, v32, v32
    v_lshlrev_b32 v32, 16, v24
    v_lshlrev_b32 v13, 16, v13
    v_add_f32 v13, v13, v32
    v_cvt_pk_bf16_f32 v24, v13, v13
    v_lshlrev_b32 v13, 16, v24
    v_cvt_pk_bf16_f32 v24, v33, v33
    v_lshlrev_b32 v33, 16, v24
    v_lshlrev_b32 v23, 16, v23
    v_add_f32 v23, v23, v33
    v_cvt_pk_bf16_f32 v24, v23, v23
    v_lshlrev_b32 v23, 16, v24
    v_lshrrev_b32 v24, 16, v4
    buffer_store_short v24, v3, s[32:35], s21 offen offset:0
    v_lshrrev_b32 v24, 16, v14
    buffer_store_short v24, v3, s[32:35], s21 offen offset:1280
    v_lshrrev_b32 v24, 16, v5
    buffer_store_short v24, v3, s[32:35], s21 offen offset:128
    v_lshrrev_b32 v24, 16, v15
    buffer_store_short v24, v3, s[32:35], s21 offen offset:1408
    v_lshrrev_b32 v24, 16, v6
    buffer_store_short v24, v3, s[32:35], s21 offen offset:256
    v_lshrrev_b32 v24, 16, v16
    buffer_store_short v24, v3, s[32:35], s21 offen offset:1536
    v_lshrrev_b32 v24, 16, v7
    buffer_store_short v24, v3, s[32:35], s21 offen offset:384
    v_lshrrev_b32 v24, 16, v17
    buffer_store_short v24, v3, s[32:35], s21 offen offset:1664
    v_lshrrev_b32 v24, 16, v8
    buffer_store_short v24, v3, s[32:35], s21 offen offset:512
    v_lshrrev_b32 v24, 16, v18
    buffer_store_short v24, v3, s[32:35], s21 offen offset:1792
    v_lshrrev_b32 v24, 16, v9
    buffer_store_short v24, v3, s[32:35], s21 offen offset:640
    v_lshrrev_b32 v24, 16, v19
    buffer_store_short v24, v3, s[32:35], s21 offen offset:1920
    v_lshrrev_b32 v24, 16, v10
    buffer_store_short v24, v3, s[32:35], s21 offen offset:768
    v_lshrrev_b32 v24, 16, v20
    buffer_store_short v24, v3, s[32:35], s21 offen offset:2048
    v_lshrrev_b32 v24, 16, v11
    buffer_store_short v24, v3, s[32:35], s21 offen offset:896
    v_lshrrev_b32 v24, 16, v21
    buffer_store_short v24, v3, s[32:35], s21 offen offset:2176
    v_lshrrev_b32 v24, 16, v12
    buffer_store_short v24, v3, s[32:35], s21 offen offset:1024
    v_lshrrev_b32 v24, 16, v22
    buffer_store_short v24, v3, s[32:35], s21 offen offset:2304
    v_lshrrev_b32 v24, 16, v13
    buffer_store_short v24, v3, s[32:35], s21 offen offset:1152
    v_lshrrev_b32 v24, 16, v23
    buffer_store_short v24, v3, s[32:35], s21 offen offset:2432
    v_add_f32 v25, v4, v5
    v_add_f32 v25, v25, v6
    v_add_f32 v25, v25, v7
    v_add_f32 v25, v25, v8
    v_add_f32 v25, v25, v9
    v_add_f32 v25, v25, v10
    v_add_f32 v25, v25, v11
    v_add_f32 v25, v25, v12
    v_add_f32 v25, v25, v13
    v_add_f32 v26, v14, v15
    v_add_f32 v26, v26, v16
    v_add_f32 v26, v26, v17
    v_add_f32 v26, v26, v18
    v_add_f32 v26, v26, v19
    v_add_f32 v26, v26, v20
    v_add_f32 v26, v26, v21
    v_add_f32 v26, v26, v22
    v_add_f32 v26, v26, v23
    v_add_f32_dpp v25, v25, v25 quad_perm:[1,0,3,2] row_mask:0xf bank_mask:0xf
    s_nop 0
    v_add_f32_dpp v26, v26, v26 quad_perm:[1,0,3,2] row_mask:0xf bank_mask:0xf
    v_add_f32_dpp v25, v25, v25 quad_perm:[2,3,0,1] row_mask:0xf bank_mask:0xf
    s_nop 0
    v_add_f32_dpp v26, v26, v26 quad_perm:[2,3,0,1] row_mask:0xf bank_mask:0xf
    v_add_f32_dpp v25, v25, v25 row_ror:4 row_mask:0xf bank_mask:0xf
    s_nop 0
    v_add_f32_dpp v26, v26, v26 row_ror:4 row_mask:0xf bank_mask:0xf
    v_add_f32_dpp v25, v25, v25 row_ror:8 row_mask:0xf bank_mask:0xf
    s_nop 0
    v_add_f32_dpp v26, v26, v26 row_ror:8 row_mask:0xf bank_mask:0xf
    v_mov_b32 v27, v25
    v_mov_b32 v28, v26
    s_nop 0
    v_permlane16_swap_b32 v27, v25
    v_permlane16_swap_b32 v28, v26
    v_add_f32 v25, v25, v27
    v_add_f32 v26, v26, v28
    v_mov_b32 v27, v25
    v_mov_b32 v28, v26
    s_nop 0
    v_permlane32_swap_b32 v27, v25
    v_permlane32_swap_b32 v28, v26
    v_add_f32 v25, v25, v27
    v_add_f32 v26, v26, v28
    v_mul_f32 v25, 0x3acccccd, v25
    v_sub_f32 v31, v4, v25
    v_mul_f32 v29, v31, v31
    v_sub_f32 v31, v5, v25
    v_fmac_f32 v29, v31, v31
    v_sub_f32 v31, v6, v25
    v_fmac_f32 v29, v31, v31
    v_sub_f32 v31, v7, v25
    v_fmac_f32 v29, v31, v31
    v_sub_f32 v31, v8, v25
    v_fmac_f32 v29, v31, v31
    v_sub_f32 v31, v9, v25
    v_fmac_f32 v29, v31, v31
    v_sub_f32 v31, v10, v25
    v_fmac_f32 v29, v31, v31
    v_sub_f32 v31, v11, v25
    v_fmac_f32 v29, v31, v31
    v_sub_f32 v31, v12, v25
    v_fmac_f32 v29, v31, v31
    v_sub_f32 v31, v13, v25
    v_fmac_f32 v29, v31, v31
    v_mul_f32 v26, 0x3acccccd, v26
    v_sub_f32 v31, v14, v26
    v_mul_f32 v30, v31, v31
    v_sub_f32 v31, v15, v26
    v_fmac_f32 v30, v31, v31
    v_sub_f32 v31, v16, v26
    v_fmac_f32 v30, v31, v31
    v_sub_f32 v31, v17, v26
    v_fmac_f32 v30, v31, v31
    v_sub_f32 v31, v18, v26
    v_fmac_f32 v30, v31, v31
    v_sub_f32 v31, v19, v26
    v_fmac_f32 v30, v31, v31
    v_sub_f32 v31, v20, v26
    v_fmac_f32 v30, v31, v31
    v_sub_f32 v31, v21, v26
    v_fmac_f32 v30, v31, v31
    v_sub_f32 v31, v22, v26
    v_fmac_f32 v30, v31, v31
    v_sub_f32 v31, v23, v26
    v_fmac_f32 v30, v31, v31
    v_add_f32_dpp v29, v29, v29 quad_perm:[1,0,3,2] row_mask:0xf bank_mask:0xf
    s_nop 0
    v_add_f32_dpp v30, v30, v30 quad_perm:[1,0,3,2] row_mask:0xf bank_mask:0xf
    v_add_f32_dpp v29, v29, v29 quad_perm:[2,3,0,1] row_mask:0xf bank_mask:0xf
    s_nop 0
    v_add_f32_dpp v30, v30, v30 quad_perm:[2,3,0,1] row_mask:0xf bank_mask:0xf
    v_add_f32_dpp v29, v29, v29 row_ror:4 row_mask:0xf bank_mask:0xf
    s_nop 0
    v_add_f32_dpp v30, v30, v30 row_ror:4 row_mask:0xf bank_mask:0xf
    v_add_f32_dpp v29, v29, v29 row_ror:8 row_mask:0xf bank_mask:0xf
    s_nop 0
    v_add_f32_dpp v30, v30, v30 row_ror:8 row_mask:0xf bank_mask:0xf
    v_mov_b32 v27, v29
    v_mov_b32 v28, v30
    s_nop 0
    v_permlane16_swap_b32 v27, v29
    v_permlane16_swap_b32 v28, v30
    v_add_f32 v29, v29, v27
    v_add_f32 v30, v30, v28
    v_mov_b32 v27, v29
    v_mov_b32 v28, v30
    s_nop 0
    v_permlane32_swap_b32 v27, v29
    v_permlane32_swap_b32 v28, v30
    v_add_f32 v29, v29, v27
    v_add_f32 v30, v30, v28
    v_mul_f32 v29, 0x3acccccd, v29
    v_cvt_pk_bf16_f32 v31, v29, v29
    v_lshlrev_b32 v29, 16, v31
    v_add_f32 v29, 0x3727c5ac, v29
    v_cvt_pk_bf16_f32 v31, v29, v29
    v_lshlrev_b32 v29, 16, v31
    v_sqrt_f32 v29, v29
    s_nop 0
    v_cvt_pk_bf16_f32 v31, v29, v29
    v_lshlrev_b32 v29, 16, v31
    v_rcp_f32 v29, v29
    v_cvt_pk_bf16_f32 v31, v25, v25
    v_lshlrev_b32 v25, 16, v31
    v_sub_f32 v4, v4, v25
    v_cvt_pk_bf16_f32 v31, v4, v4
    v_lshlrev_b32 v4, 16, v31
    v_mul_f32 v4, v4, v29
    v_cvt_pk_bf16_f32 v31, v4, v4
    v_lshlrev_b32 v4, 16, v31
    v_sub_f32 v5, v5, v25
    v_cvt_pk_bf16_f32 v31, v5, v5
    v_lshlrev_b32 v5, 16, v31
    v_mul_f32 v5, v5, v29
    v_cvt_pk_bf16_f32 v31, v5, v5
    v_lshlrev_b32 v5, 16, v31
    v_sub_f32 v6, v6, v25
    v_cvt_pk_bf16_f32 v31, v6, v6
    v_lshlrev_b32 v6, 16, v31
    v_mul_f32 v6, v6, v29
    v_cvt_pk_bf16_f32 v31, v6, v6
    v_lshlrev_b32 v6, 16, v31
    v_sub_f32 v7, v7, v25
    v_cvt_pk_bf16_f32 v31, v7, v7
    v_lshlrev_b32 v7, 16, v31
    v_mul_f32 v7, v7, v29
    v_cvt_pk_bf16_f32 v31, v7, v7
    v_lshlrev_b32 v7, 16, v31
    v_sub_f32 v8, v8, v25
    v_cvt_pk_bf16_f32 v31, v8, v8
    v_lshlrev_b32 v8, 16, v31
    v_mul_f32 v8, v8, v29
    v_cvt_pk_bf16_f32 v31, v8, v8
    v_lshlrev_b32 v8, 16, v31
    v_sub_f32 v9, v9, v25
    v_cvt_pk_bf16_f32 v31, v9, v9
    v_lshlrev_b32 v9, 16, v31
    v_mul_f32 v9, v9, v29
    v_cvt_pk_bf16_f32 v31, v9, v9
    v_lshlrev_b32 v9, 16, v31
    v_sub_f32 v10, v10, v25
    v_cvt_pk_bf16_f32 v31, v10, v10
    v_lshlrev_b32 v10, 16, v31
    v_mul_f32 v10, v10, v29
    v_cvt_pk_bf16_f32 v31, v10, v10
    v_lshlrev_b32 v10, 16, v31
    v_sub_f32 v11, v11, v25
    v_cvt_pk_bf16_f32 v31, v11, v11
    v_lshlrev_b32 v11, 16, v31
    v_mul_f32 v11, v11, v29
    v_cvt_pk_bf16_f32 v31, v11, v11
    v_lshlrev_b32 v11, 16, v31
    v_sub_f32 v12, v12, v25
    v_cvt_pk_bf16_f32 v31, v12, v12
    v_lshlrev_b32 v12, 16, v31
    v_mul_f32 v12, v12, v29
    v_cvt_pk_bf16_f32 v31, v12, v12
    v_lshlrev_b32 v12, 16, v31
    v_sub_f32 v13, v13, v25
    v_cvt_pk_bf16_f32 v31, v13, v13
    v_lshlrev_b32 v13, 16, v31
    v_mul_f32 v13, v13, v29
    v_cvt_pk_bf16_f32 v31, v13, v13
    v_lshlrev_b32 v13, 16, v31
    v_mul_f32 v30, 0x3acccccd, v30
    v_cvt_pk_bf16_f32 v31, v30, v30
    v_lshlrev_b32 v30, 16, v31
    v_add_f32 v30, 0x3727c5ac, v30
    v_cvt_pk_bf16_f32 v31, v30, v30
    v_lshlrev_b32 v30, 16, v31
    v_sqrt_f32 v30, v30
    s_nop 0
    v_cvt_pk_bf16_f32 v31, v30, v30
    v_lshlrev_b32 v30, 16, v31
    v_rcp_f32 v30, v30
    v_cvt_pk_bf16_f32 v31, v26, v26
    v_lshlrev_b32 v26, 16, v31
    v_sub_f32 v14, v14, v26
    v_cvt_pk_bf16_f32 v31, v14, v14
    v_lshlrev_b32 v14, 16, v31
    v_mul_f32 v14, v14, v30
    v_cvt_pk_bf16_f32 v31, v14, v14
    v_lshlrev_b32 v14, 16, v31
    v_sub_f32 v15, v15, v26
    v_cvt_pk_bf16_f32 v31, v15, v15
    v_lshlrev_b32 v15, 16, v31
    v_mul_f32 v15, v15, v30
    v_cvt_pk_bf16_f32 v31, v15, v15
    v_lshlrev_b32 v15, 16, v31
    v_sub_f32 v16, v16, v26
    v_cvt_pk_bf16_f32 v31, v16, v16
    v_lshlrev_b32 v16, 16, v31
    v_mul_f32 v16, v16, v30
    v_cvt_pk_bf16_f32 v31, v16, v16
    v_lshlrev_b32 v16, 16, v31
    v_sub_f32 v17, v17, v26
    v_cvt_pk_bf16_f32 v31, v17, v17
    v_lshlrev_b32 v17, 16, v31
    v_mul_f32 v17, v17, v30
    v_cvt_pk_bf16_f32 v31, v17, v17
    v_lshlrev_b32 v17, 16, v31
    v_sub_f32 v18, v18, v26
    v_cvt_pk_bf16_f32 v31, v18, v18
    v_lshlrev_b32 v18, 16, v31
    v_mul_f32 v18, v18, v30
    v_cvt_pk_bf16_f32 v31, v18, v18
    v_lshlrev_b32 v18, 16, v31
    v_sub_f32 v19, v19, v26
    v_cvt_pk_bf16_f32 v31, v19, v19
    v_lshlrev_b32 v19, 16, v31
    v_mul_f32 v19, v19, v30
    v_cvt_pk_bf16_f32 v31, v19, v19
    v_lshlrev_b32 v19, 16, v31
    v_sub_f32 v20, v20, v26
    v_cvt_pk_bf16_f32 v31, v20, v20
    v_lshlrev_b32 v20, 16, v31
    v_mul_f32 v20, v20, v30
    v_cvt_pk_bf16_f32 v31, v20, v20
    v_lshlrev_b32 v20, 16, v31
    v_sub_f32 v21, v21, v26
    v_cvt_pk_bf16_f32 v31, v21, v21
    v_lshlrev_b32 v21, 16, v31
    v_mul_f32 v21, v21, v30
    v_cvt_pk_bf16_f32 v31, v21, v21
    v_lshlrev_b32 v21, 16, v31
    v_sub_f32 v22, v22, v26
    v_cvt_pk_bf16_f32 v31, v22, v22
    v_lshlrev_b32 v22, 16, v31
    v_mul_f32 v22, v22, v30
    v_cvt_pk_bf16_f32 v31, v22, v22
    v_lshlrev_b32 v22, 16, v31
    v_sub_f32 v23, v23, v26
    v_cvt_pk_bf16_f32 v31, v23, v23
    v_lshlrev_b32 v23, 16, v31
    v_mul_f32 v23, v23, v30
    v_cvt_pk_bf16_f32 v31, v23, v23
    v_lshlrev_b32 v23, 16, v31
    v_lshrrev_b32 v24, 16, v4
    buffer_store_short v24, v3, s[36:39], s21 offen offset:0
    v_lshrrev_b32 v24, 16, v14
    buffer_store_short v24, v3, s[36:39], s21 offen offset:1280
    v_lshrrev_b32 v24, 16, v5
    buffer_store_short v24, v3, s[36:39], s21 offen offset:128
    v_lshrrev_b32 v24, 16, v15
    buffer_store_short v24, v3, s[36:39], s21 offen offset:1408
    v_lshrrev_b32 v24, 16, v6
    buffer_store_short v24, v3, s[36:39], s21 offen offset:256
    v_lshrrev_b32 v24, 16, v16
    buffer_store_short v24, v3, s[36:39], s21 offen offset:1536
    v_lshrrev_b32 v24, 16, v7
    buffer_store_short v24, v3, s[36:39], s21 offen offset:384
    v_lshrrev_b32 v24, 16, v17
    buffer_store_short v24, v3, s[36:39], s21 offen offset:1664
    v_lshrrev_b32 v24, 16, v8
    buffer_store_short v24, v3, s[36:39], s21 offen offset:512
    v_lshrrev_b32 v24, 16, v18
    buffer_store_short v24, v3, s[36:39], s21 offen offset:1792
    v_lshrrev_b32 v24, 16, v9
    buffer_store_short v24, v3, s[36:39], s21 offen offset:640
    v_lshrrev_b32 v24, 16, v19
    buffer_store_short v24, v3, s[36:39], s21 offen offset:1920
    v_lshrrev_b32 v24, 16, v10
    buffer_store_short v24, v3, s[36:39], s21 offen offset:768
    v_lshrrev_b32 v24, 16, v20
    buffer_store_short v24, v3, s[36:39], s21 offen offset:2048
    v_lshrrev_b32 v24, 16, v11
    buffer_store_short v24, v3, s[36:39], s21 offen offset:896
    v_lshrrev_b32 v24, 16, v21
    buffer_store_short v24, v3, s[36:39], s21 offen offset:2176
    v_lshrrev_b32 v24, 16, v12
    buffer_store_short v24, v3, s[36:39], s21 offen offset:1024
    v_lshrrev_b32 v24, 16, v22
    buffer_store_short v24, v3, s[36:39], s21 offen offset:2304
    v_lshrrev_b32 v24, 16, v13
    buffer_store_short v24, v3, s[36:39], s21 offen offset:1152
    v_lshrrev_b32 v24, 16, v23
    buffer_store_short v24, v3, s[36:39], s21 offen offset:2432
k3a_kernel_end:
    s_endpgm
.globl k4a_kernel
.p2align 8
.type k4a_kernel,@function
k4a_kernel:
    s_cmp_ge_u32 s2, 256
    s_cbranch_scc1 k4a_kernel_end
    s_and_b32 s47, s2, 7
    s_lshr_b32 s48, s2, 3
    s_and_b32 s40, s48, 7
    s_lshr_b32 s41, s48, 3
    s_lshl_b32 s41, s41, 3
    s_add_u32 s41, s41, s47
    s_cmp_ge_u32 s41, 27
    s_cbranch_scc1 k4a_kernel_end
    s_load_dwordx2 s[6:7], s[0:1], 72
    s_load_dwordx4 s[16:19], s[0:1], 32
    v_lshrrev_b32 v1, 6, v0
    s_nop 0
    v_readfirstlane_b32 s20, v1
    v_and_b32 v2, 63, v0
    s_waitcnt lgkmcnt(0)
    s_mov_b32 s4, s6
    s_mov_b32 s5, s7
    s_add_u32 s4, s4, 0xc00000
    s_addc_u32 s5, s5, 0
    s_mov_b32 s8, s4
    s_and_b32 s9, s5, 0xffff
    s_mov_b32 s10, 0x280000
    s_mov_b32 s11, 0x00020000
    s_mov_b32 s12, s16
    s_and_b32 s13, s17, 0xffff
    s_mov_b32 s14, 0x21c000
    s_mov_b32 s15, 0x00020000
    s_mov_b32 s24, s18
    s_and_b32 s25, s19, 0xffff
    s_mov_b32 s26, 0x21c000
    s_mov_b32 s27, 0x00020000
    s_mov_b32 s4, s6
    s_mov_b32 s5, s7
    s_add_u32 s4, s4, 0x1000000
    s_addc_u32 s5, s5, 0
    s_mov_b32 s28, s4
    s_and_b32 s29, s5, 0xffff
    s_mov_b32 s30, 0x6c0000
    s_mov_b32 s31, 0x00020000
    v_lshrrev_b32 v3, 2, v2
    v_and_b32 v5, 3, v2
    s_mul_i32 s21, s20, 32
    s_lshl_b32 s22, s40, 8
    s_add_u32 s21, s21, s22
    v_add_u32 v7, 0, v3
    v_lshrrev_b32 v6, 3, v7
    v_and_b32 v6, 1, v6
    v_lshlrev_b32 v6, 1, v6
    v_xor_b32 v6, v6, v5
    v_lshlrev_b32 v6, 4, v6
    v_add_u32 v7, s21, v7
    v_mul_u32_u24 v7, 1280, v7
    v_add_u32 v10, v6, v7
    v_add_u32 v7, 16, v3
    v_lshrrev_b32 v6, 3, v7
    v_and_b32 v6, 1, v6
    v_lshlrev_b32 v6, 1, v6
    v_xor_b32 v6, v6, v5
    v_lshlrev_b32 v6, 4, v6
    v_add_u32 v7, s21, v7
    v_mul_u32_u24 v7, 1280, v7
    v_add_u32 v11, v6, v7
    v_lshrrev_b32 v3, 3, v2
    v_and_b32 v5, 7, v2
    s_and_b32 s21, s20, 3
    s_lshl_b32 s21, s21, 3
    s_mul_i32 s22, s41, 128
    v_add_u32 v7, s21, v3
    v_lshrrev_b32 v6, 1, v7
    v_and_b32 v6, 1, v6
    v_lshrrev_b32 v8, 3, v7
    v_and_b32 v8, 1, v8
    v_lshlrev_b32 v8, 1, v8
    v_or_b32 v6, v6, v8
    v_lshlrev_b32 v6, 1, v6
    v_xor_b32 v6, v6, v5
    v_lshlrev_b32 v6, 4, v6
    v_mul_u32_u24 v7, 3456, v7
    v_add_u32 v7, v7, v6
    v_add_u32 v14, s22, v7
    v_and_b32 v3, 15, v2
    v_lshrrev_b32 v4, 4, v2
    s_lshr_b32 s21, s20, 1
    s_mul_i32 s21, s21, 4096
    v_lshrrev_b32 v7, 3, v3
    v_lshlrev_b32 v7, 1, v7
    v_xor_b32 v6, v4, v7
    v_lshlrev_b32 v6, 4, v6
    v_lshlrev_b32 v7, 6, v3
    v_add_u32 v6, v6, v7
    v_add_u32 v16, s21, v6
    s_and_b32 s21, s20, 1
    v_lshrrev_b32 v5, 3, v3
    v_and_b32 v6, 1, v4
    v_lshlrev_b32 v6, 1, v6
    v_or_b32 v5, v5, v6
    v_lshlrev_b32 v5, 1, v5
    v_and_b32 v6, 3, v3
    v_lshrrev_b32 v6, 1, v6
    s_lshl_b32 s22, s21, 2
    v_add_u32 v6, s22, v6
    v_lshlrev_b32 v7, 3, v4
    v_lshrrev_b32 v8, 2, v3
    v_add_u32 v7, v7, v8
    v_lshlrev_b32 v7, 7, v7
    v_and_b32 v8, 1, v3
    v_lshlrev_b32 v8, 3, v8
    v_add_u32 v7, v7, v8
    v_add_u32 v7, 16384, v7
    v_add_u32 v8, 0, v6
    v_xor_b32 v8, v8, v5
    v_lshlrev_b32 v8, 4, v8
    v_add_u32 v18, v8, v7
    v_add_u32 v8, 2, v6
    v_xor_b32 v8, v8, v5
    v_lshlrev_b32 v8, 4, v8
    v_add_u32 v19, v8, v7
    v_add_u32 v15, 49152, v16
    v_add_u32 v12, 49152, v18
    v_add_u32 v13, 49152, v19
    v_mov_b32 v64, 0
    v_mov_b32 v65, 0
    v_mov_b32 v66, 0
    v_mov_b32 v67, 0
    v_mov_b32 v68, 0
    v_mov_b32 v69, 0
    v_mov_b32 v70, 0
    v_mov_b32 v71, 0
    v_mov_b32 v72, 0
    v_mov_b32 v73, 0
    v_mov_b32 v74, 0
    v_mov_b32 v75, 0
    v_mov_b32 v76, 0
    v_mov_b32 v77, 0
    v_mov_b32 v78, 0
    v_mov_b32 v79, 0
    v_mov_b32 v80, 0
    v_mov_b32 v81, 0
    v_mov_b32 v82, 0
    v_mov_b32 v83, 0
    v_mov_b32 v84, 0
    v_mov_b32 v85, 0
    v_mov_b32 v86, 0
    v_mov_b32 v87, 0
    v_mov_b32 v88, 0
    v_mov_b32 v89, 0
    v_mov_b32 v90, 0
    v_mov_b32 v91, 0
    v_mov_b32 v92, 0
    v_mov_b32 v93, 0
    v_mov_b32 v94, 0
    v_mov_b32 v95, 0
    v_mov_b32 v96, 0
    v_mov_b32 v97, 0
    v_mov_b32 v98, 0
    v_mov_b32 v99, 0
    v_mov_b32 v100, 0
    v_mov_b32 v101, 0
    v_mov_b32 v102, 0
    v_mov_b32 v103, 0
    v_mov_b32 v104, 0
    v_mov_b32 v105, 0
    v_mov_b32 v106, 0
    v_mov_b32 v107, 0
    v_mov_b32 v108, 0
    v_mov_b32 v109, 0
    v_mov_b32 v110, 0
    v_mov_b32 v111, 0
    v_mov_b32 v112, 0
    v_mov_b32 v113, 0
    v_mov_b32 v114, 0
    v_mov_b32 v115, 0
    v_mov_b32 v116, 0
    v_mov_b32 v117, 0
    v_mov_b32 v118, 0
    v_mov_b32 v119, 0
    v_mov_b32 v120, 0
    v_mov_b32 v121, 0
    v_mov_b32 v122, 0
    v_mov_b32 v123, 0
    v_mov_b32 v124, 0
    v_mov_b32 v125, 0
    v_mov_b32 v126, 0
    v_mov_b32 v127, 0
    s_mul_i32 s42, s20, 2048
    s_lshl_b32 s43, s20, 10
    s_cmp_ge_u32 s20, 4
    s_cselect_b32 s52, s24, s12
    s_cselect_b32 s53, s25, s13
    s_cselect_b32 s54, s26, s14
    s_cselect_b32 s55, s27, s15
    s_mov_b32 s44, 0
    s_mov_b32 s45, 0
    s_add_u32 m0, s42, 0
    s_nop 0
    buffer_load_dwordx4 v10, s[8:11], s44 offen lds
    s_add_u32 m0, s42, 1024
    s_nop 0
    buffer_load_dwordx4 v11, s[8:11], s44 offen lds
    s_add_u32 m0, s43, 16384
    s_nop 0
    buffer_load_dwordx4 v14, s[52:55], s45 offen lds
    s_add_u32 s44, s44, 64
    s_add_u32 s45, s45, 110592
    s_add_u32 m0, s42, 24576
    s_nop 0
    buffer_load_dwordx4 v10, s[8:11], s44 offen lds
    s_add_u32 m0, s42, 25600
    s_nop 0
    buffer_load_dwordx4 v11, s[8:11], s44 offen lds
    s_add_u32 m0, s43, 40960
    s_nop 0
    buffer_load_dwordx4 v14, s[52:55], s45 offen lds
    s_add_u32 s44, s44, 64
    s_add_u32 s45, s45, 110592
    s_add_u32 m0, s42, 49152
    s_nop 0
    buffer_load_dwordx4 v10, s[8:11], s44 offen lds
    s_add_u32 m0, s42, 50176
    s_nop 0
    buffer_load_dwordx4 v11, s[8:11], s44 offen lds
    s_add_u32 m0, s43, 65536
    s_nop 0
    buffer_load_dwordx4 v14, s[52:55], s45 offen lds
    s_add_u32 s44, s44, 64
    s_add_u32 s45, s45, 110592
    s_waitcnt vmcnt(6)
    s_barrier
    s_add_u32 m0, s42, 73728
    s_nop 0
    buffer_load_dwordx4 v10, s[8:11], s44 offen lds
    s_add_u32 m0, s42, 74752
    s_nop 0
    buffer_load_dwordx4 v11, s[8:11], s44 offen lds
    s_add_u32 m0, s43, 90112
    s_nop 0
    buffer_load_dwordx4 v14, s[52:55], s45 offen lds
    s_add_u32 s44, s44, 64
    s_add_u32 s45, s45, 110592
    ds_read_b128 v[20:23], v16 offset:0
    ds_read_b128 v[24:27], v16 offset:1024
    ds_read_b128 v[28:31], v16 offset:2048
    ds_read_b128 v[32:35], v16 offset:3072
    ds_read_b64_tr_b16 v[192:193], v18 offset:0
    ds_read_b64_tr_b16 v[194:195], v18 offset:512
    ds_read_b64_tr_b16 v[196:197], v19 offset:0
    ds_read_b64_tr_b16 v[198:199], v19 offset:512
    ds_read_b64_tr_b16 v[200:201], v18 offset:4096
    ds_read_b64_tr_b16 v[202:203], v18 offset:4608
    ds_read_b64_tr_b16 v[204:205], v19 offset:4096
    ds_read_b64_tr_b16 v[206:207], v19 offset:4608
    s_waitcnt lgkmcnt(0)
    s_waitcnt vmcnt(6)
    s_barrier
    s_add_u32 m0, s42, 0
    s_nop 0
    buffer_load_dwordx4 v10, s[8:11], s44 offen lds
    s_add_u32 m0, s42, 1024
    s_nop 0
    buffer_load_dwordx4 v11, s[8:11], s44 offen lds
    s_add_u32 m0, s43, 16384
    s_nop 0
    buffer_load_dwordx4 v14, s[52:55], s45 offen lds
    s_add_u32 s44, s44, 64
    s_add_u32 s45, s45, 110592
    ds_read_b128 v[36:39], v16 offset:24576
    ds_read_b128 v[40:43], v16 offset:25600
    ds_read_b128 v[44:47], v16 offset:26624
    ds_read_b128 v[48:51], v16 offset:27648
    ds_read_b64_tr_b16 v[208:209], v18 offset:24576
    ds_read_b64_tr_b16 v[210:211], v18 offset:25088
    ds_read_b64_tr_b16 v[212:213], v19 offset:24576
    ds_read_b64_tr_b16 v[214:215], v19 offset:25088
    ds_read_b64_tr_b16 v[216:217], v18 offset:28672
    ds_read_b64_tr_b16 v[218:219], v18 offset:29184
    ds_read_b64_tr_b16 v[220:221], v19 offset:28672
    ds_read_b64_tr_b16 v[222:223], v19 offset:29184
    v_mfma_f32_16x16x32_bf16 v[64:67], v[192:195], v[20:23], v[64:67]
    v_mfma_f32_16x16x32_bf16 v[68:71], v[192:195], v[24:27], v[68:71]
    v_mfma_f32_16x16x32_bf16 v[72:75], v[192:195], v[28:31], v[72:75]
    v_mfma_f32_16x16x32_bf16 v[76:79], v[192:195], v[32:35], v[76:79]
    v_mfma_f32_16x16x32_bf16 v[80:83], v[196:199], v[20:23], v[80:83]
    v_mfma_f32_16x16x32_bf16 v[84:87], v[196:199], v[24:27], v[84:87]
    v_mfma_f32_16x16x32_bf16 v[88:91], v[196:199], v[28:31], v[88:91]
    v_mfma_f32_16x16x32_bf16 v[92:95], v[196:199], v[32:35], v[92:95]
    v_mfma_f32_16x16x32_bf16 v[96:99], v[200:203], v[20:23], v[96:99]
    v_mfma_f32_16x16x32_bf16 v[100:103], v[200:203], v[24:27], v[100:103]
    v_mfma_f32_16x16x32_bf16 v[104:107], v[200:203], v[28:31], v[104:107]
    v_mfma_f32_16x16x32_bf16 v[108:111], v[200:203], v[32:35], v[108:111]
    v_mfma_f32_16x16x32_bf16 v[112:115], v[204:207], v[20:23], v[112:115]
    v_mfma_f32_16x16x32_bf16 v[116:119], v[204:207], v[24:27], v[116:119]
    v_mfma_f32_16x16x32_bf16 v[120:123], v[204:207], v[28:31], v[120:123]
    v_mfma_f32_16x16x32_bf16 v[124:127], v[204:207], v[32:35], v[124:127]
    s_waitcnt lgkmcnt(0)
    s_waitcnt vmcnt(6)
    s_barrier
    s_add_u32 m0, s42, 24576
    s_nop 0
    buffer_load_dwordx4 v10, s[8:11], s44 offen lds
    s_add_u32 m0, s42, 25600
    s_nop 0
    buffer_load_dwordx4 v11, s[8:11], s44 offen lds
    s_add_u32 m0, s43, 40960
    s_nop 0
    buffer_load_dwordx4 v14, s[52:55], s45 offen lds
    s_add_u32 s44, s44, 64
    s_add_u32 s45, s45, 110592
    ds_read_b128 v[20:23], v15 offset:0
    ds_read_b128 v[24:27], v15 offset:1024
    ds_read_b128 v[28:31], v15 offset:2048
    ds_read_b128 v[32:35], v15 offset:3072
    ds_read_b64_tr_b16 v[192:193], v12 offset:0
    ds_read_b64_tr_b16 v[194:195], v12 offset:512
    ds_read_b64_tr_b16 v[196:197], v13 offset:0
    ds_read_b64_tr_b16 v[198:199], v13 offset:512
    ds_read_b64_tr_b16 v[200:201], v12 offset:4096
    ds_read_b64_tr_b16 v[202:203], v12 offset:4608
    ds_read_b64_tr_b16 v[204:205], v13 offset:4096
    ds_read_b64_tr_b16 v[206:207], v13 offset:4608
    v_mfma_f32_16x16x32_bf16 v[64:67], v[208:211], v[36:39], v[64:67]
    v_mfma_f32_16x16x32_bf16 v[68:71], v[208:211], v[40:43], v[68:71]
    v_mfma_f32_16x16x32_bf16 v[72:75], v[208:211], v[44:47], v[72:75]
    v_mfma_f32_16x16x32_bf16 v[76:79], v[208:211], v[48:51], v[76:79]
    v_mfma_f32_16x16x32_bf16 v[80:83], v[212:215], v[36:39], v[80:83]
    v_mfma_f32_16x16x32_bf16 v[84:87], v[212:215], v[40:43], v[84:87]
    v_mfma_f32_16x16x32_bf16 v[88:91], v[212:215], v[44:47], v[88:91]
    v_mfma_f32_16x16x32_bf16 v[92:95], v[212:215], v[48:51], v[92:95]
    v_mfma_f32_16x16x32_bf16 v[96:99], v[216:219], v[36:39], v[96:99]
    v_mfma_f32_16x16x32_bf16 v[100:103], v[216:219], v[40:43], v[100:103]
    v_mfma_f32_16x16x32_bf16 v[104:107], v[216:219], v[44:47], v[104:107]
    v_mfma_f32_16x16x32_bf16 v[108:111], v[216:219], v[48:51], v[108:111]
    v_mfma_f32_16x16x32_bf16 v[112:115], v[220:223], v[36:39], v[112:115]
    v_mfma_f32_16x16x32_bf16 v[116:119], v[220:223], v[40:43], v[116:119]
    v_mfma_f32_16x16x32_bf16 v[120:123], v[220:223], v[44:47], v[120:123]
    v_mfma_f32_16x16x32_bf16 v[124:127], v[220:223], v[48:51], v[124:127]
    s_waitcnt lgkmcnt(0)
    s_waitcnt vmcnt(6)
    s_barrier
    s_add_u32 m0, s42, 49152
    s_nop 0
    buffer_load_dwordx4 v10, s[8:11], s44 offen lds
    s_add_u32 m0, s42, 50176
    s_nop 0
    buffer_load_dwordx4 v11, s[8:11], s44 offen lds
    s_add_u32 m0, s43, 65536
    s_nop 0
    buffer_load_dwordx4 v14, s[52:55], s45 offen lds
    s_add_u32 s44, s44, 64
    s_add_u32 s45, s45, 110592
    ds_read_b128 v[36:39], v15 offset:24576
    ds_read_b128 v[40:43], v15 offset:25600
    ds_read_b128 v[44:47], v15 offset:26624
    ds_read_b128 v[48:51], v15 offset:27648
    ds_read_b64_tr_b16 v[208:209], v12 offset:24576
    ds_read_b64_tr_b16 v[210:211], v12 offset:25088
    ds_read_b64_tr_b16 v[212:213], v13 offset:24576
    ds_read_b64_tr_b16 v[214:215], v13 offset:25088
    ds_read_b64_tr_b16 v[216:217], v12 offset:28672
    ds_read_b64_tr_b16 v[218:219], v12 offset:29184
    ds_read_b64_tr_b16 v[220:221], v13 offset:28672
    ds_read_b64_tr_b16 v[222:223], v13 offset:29184
    v_mfma_f32_16x16x32_bf16 v[64:67], v[192:195], v[20:23], v[64:67]
    v_mfma_f32_16x16x32_bf16 v[68:71], v[192:195], v[24:27], v[68:71]
    v_mfma_f32_16x16x32_bf16 v[72:75], v[192:195], v[28:31], v[72:75]
    v_mfma_f32_16x16x32_bf16 v[76:79], v[192:195], v[32:35], v[76:79]
    v_mfma_f32_16x16x32_bf16 v[80:83], v[196:199], v[20:23], v[80:83]
    v_mfma_f32_16x16x32_bf16 v[84:87], v[196:199], v[24:27], v[84:87]
    v_mfma_f32_16x16x32_bf16 v[88:91], v[196:199], v[28:31], v[88:91]
    v_mfma_f32_16x16x32_bf16 v[92:95], v[196:199], v[32:35], v[92:95]
    v_mfma_f32_16x16x32_bf16 v[96:99], v[200:203], v[20:23], v[96:99]
    v_mfma_f32_16x16x32_bf16 v[100:103], v[200:203], v[24:27], v[100:103]
    v_mfma_f32_16x16x32_bf16 v[104:107], v[200:203], v[28:31], v[104:107]
    v_mfma_f32_16x16x32_bf16 v[108:111], v[200:203], v[32:35], v[108:111]
    v_mfma_f32_16x16x32_bf16 v[112:115], v[204:207], v[20:23], v[112:115]
    v_mfma_f32_16x16x32_bf16 v[116:119], v[204:207], v[24:27], v[116:119]
    v_mfma_f32_16x16x32_bf16 v[120:123], v[204:207], v[28:31], v[120:123]
    v_mfma_f32_16x16x32_bf16 v[124:127], v[204:207], v[32:35], v[124:127]
    s_waitcnt lgkmcnt(0)
    s_mov_b32 s46, 1
k4a_kernel_loop:
    s_waitcnt vmcnt(6)
    s_barrier
    s_add_u32 m0, s42, 73728
    s_nop 0
    buffer_load_dwordx4 v10, s[8:11], s44 offen lds
    s_add_u32 m0, s42, 74752
    s_nop 0
    buffer_load_dwordx4 v11, s[8:11], s44 offen lds
    s_add_u32 m0, s43, 90112
    s_nop 0
    buffer_load_dwordx4 v14, s[52:55], s45 offen lds
    s_add_u32 s44, s44, 64
    s_add_u32 s45, s45, 110592
    ds_read_b128 v[20:23], v16 offset:0
    ds_read_b128 v[24:27], v16 offset:1024
    ds_read_b128 v[28:31], v16 offset:2048
    ds_read_b128 v[32:35], v16 offset:3072
    ds_read_b64_tr_b16 v[192:193], v18 offset:0
    ds_read_b64_tr_b16 v[194:195], v18 offset:512
    ds_read_b64_tr_b16 v[196:197], v19 offset:0
    ds_read_b64_tr_b16 v[198:199], v19 offset:512
    ds_read_b64_tr_b16 v[200:201], v18 offset:4096
    ds_read_b64_tr_b16 v[202:203], v18 offset:4608
    ds_read_b64_tr_b16 v[204:205], v19 offset:4096
    ds_read_b64_tr_b16 v[206:207], v19 offset:4608
    v_mfma_f32_16x16x32_bf16 v[64:67], v[208:211], v[36:39], v[64:67]
    v_mfma_f32_16x16x32_bf16 v[68:71], v[208:211], v[40:43], v[68:71]
    v_mfma_f32_16x16x32_bf16 v[72:75], v[208:211], v[44:47], v[72:75]
    v_mfma_f32_16x16x32_bf16 v[76:79], v[208:211], v[48:51], v[76:79]
    v_mfma_f32_16x16x32_bf16 v[80:83], v[212:215], v[36:39], v[80:83]
    v_mfma_f32_16x16x32_bf16 v[84:87], v[212:215], v[40:43], v[84:87]
    v_mfma_f32_16x16x32_bf16 v[88:91], v[212:215], v[44:47], v[88:91]
    v_mfma_f32_16x16x32_bf16 v[92:95], v[212:215], v[48:51], v[92:95]
    v_mfma_f32_16x16x32_bf16 v[96:99], v[216:219], v[36:39], v[96:99]
    v_mfma_f32_16x16x32_bf16 v[100:103], v[216:219], v[40:43], v[100:103]
    v_mfma_f32_16x16x32_bf16 v[104:107], v[216:219], v[44:47], v[104:107]
    v_mfma_f32_16x16x32_bf16 v[108:111], v[216:219], v[48:51], v[108:111]
    v_mfma_f32_16x16x32_bf16 v[112:115], v[220:223], v[36:39], v[112:115]
    v_mfma_f32_16x16x32_bf16 v[116:119], v[220:223], v[40:43], v[116:119]
    v_mfma_f32_16x16x32_bf16 v[120:123], v[220:223], v[44:47], v[120:123]
    v_mfma_f32_16x16x32_bf16 v[124:127], v[220:223], v[48:51], v[124:127]
    s_waitcnt lgkmcnt(0)
    s_waitcnt vmcnt(6)
    s_barrier
    s_add_u32 m0, s42, 0
    s_nop 0
    buffer_load_dwordx4 v10, s[8:11], s44 offen lds
    s_add_u32 m0, s42, 1024
    s_nop 0
    buffer_load_dwordx4 v11, s[8:11], s44 offen lds
    s_add_u32 m0, s43, 16384
    s_nop 0
    buffer_load_dwordx4 v14, s[52:55], s45 offen lds
    s_add_u32 s44, s44, 64
    s_add_u32 s45, s45, 110592
    ds_read_b128 v[36:39], v16 offset:24576
    ds_read_b128 v[40:43], v16 offset:25600
    ds_read_b128 v[44:47], v16 offset:26624
    ds_read_b128 v[48:51], v16 offset:27648
    ds_read_b64_tr_b16 v[208:209], v18 offset:24576
    ds_read_b64_tr_b16 v[210:211], v18 offset:25088
    ds_read_b64_tr_b16 v[212:213], v19 offset:24576
    ds_read_b64_tr_b16 v[214:215], v19 offset:25088
    ds_read_b64_tr_b16 v[216:217], v18 offset:28672
    ds_read_b64_tr_b16 v[218:219], v18 offset:29184
    ds_read_b64_tr_b16 v[220:221], v19 offset:28672
    ds_read_b64_tr_b16 v[222:223], v19 offset:29184
    v_mfma_f32_16x16x32_bf16 v[64:67], v[192:195], v[20:23], v[64:67]
    v_mfma_f32_16x16x32_bf16 v[68:71], v[192:195], v[24:27], v[68:71]
    v_mfma_f32_16x16x32_bf16 v[72:75], v[192:195], v[28:31], v[72:75]
    v_mfma_f32_16x16x32_bf16 v[76:79], v[192:195], v[32:35], v[76:79]
    v_mfma_f32_16x16x32_bf16 v[80:83], v[196:199], v[20:23], v[80:83]
    v_mfma_f32_16x16x32_bf16 v[84:87], v[196:199], v[24:27], v[84:87]
    v_mfma_f32_16x16x32_bf16 v[88:91], v[196:199], v[28:31], v[88:91]
    v_mfma_f32_16x16x32_bf16 v[92:95], v[196:199], v[32:35], v[92:95]
    v_mfma_f32_16x16x32_bf16 v[96:99], v[200:203], v[20:23], v[96:99]
    v_mfma_f32_16x16x32_bf16 v[100:103], v[200:203], v[24:27], v[100:103]
    v_mfma_f32_16x16x32_bf16 v[104:107], v[200:203], v[28:31], v[104:107]
    v_mfma_f32_16x16x32_bf16 v[108:111], v[200:203], v[32:35], v[108:111]
    v_mfma_f32_16x16x32_bf16 v[112:115], v[204:207], v[20:23], v[112:115]
    v_mfma_f32_16x16x32_bf16 v[116:119], v[204:207], v[24:27], v[116:119]
    v_mfma_f32_16x16x32_bf16 v[120:123], v[204:207], v[28:31], v[120:123]
    v_mfma_f32_16x16x32_bf16 v[124:127], v[204:207], v[32:35], v[124:127]
    s_waitcnt lgkmcnt(0)
    s_waitcnt vmcnt(6)
    s_barrier
    s_add_u32 m0, s42, 24576
    s_nop 0
    buffer_load_dwordx4 v10, s[8:11], s44 offen lds
    s_add_u32 m0, s42, 25600
    s_nop 0
    buffer_load_dwordx4 v11, s[8:11], s44 offen lds
    s_add_u32 m0, s43, 40960
    s_nop 0
    buffer_load_dwordx4 v14, s[52:55], s45 offen lds
    s_add_u32 s44, s44, 64
    s_add_u32 s45, s45, 110592
    ds_read_b128 v[20:23], v15 offset:0
    ds_read_b128 v[24:27], v15 offset:1024
    ds_read_b128 v[28:31], v15 offset:2048
    ds_read_b128 v[32:35], v15 offset:3072
    ds_read_b64_tr_b16 v[192:193], v12 offset:0
    ds_read_b64_tr_b16 v[194:195], v12 offset:512
    ds_read_b64_tr_b16 v[196:197], v13 offset:0
    ds_read_b64_tr_b16 v[198:199], v13 offset:512
    ds_read_b64_tr_b16 v[200:201], v12 offset:4096
    ds_read_b64_tr_b16 v[202:203], v12 offset:4608
    ds_read_b64_tr_b16 v[204:205], v13 offset:4096
    ds_read_b64_tr_b16 v[206:207], v13 offset:4608
    v_mfma_f32_16x16x32_bf16 v[64:67], v[208:211], v[36:39], v[64:67]
    v_mfma_f32_16x16x32_bf16 v[68:71], v[208:211], v[40:43], v[68:71]
    v_mfma_f32_16x16x32_bf16 v[72:75], v[208:211], v[44:47], v[72:75]
    v_mfma_f32_16x16x32_bf16 v[76:79], v[208:211], v[48:51], v[76:79]
    v_mfma_f32_16x16x32_bf16 v[80:83], v[212:215], v[36:39], v[80:83]
    v_mfma_f32_16x16x32_bf16 v[84:87], v[212:215], v[40:43], v[84:87]
    v_mfma_f32_16x16x32_bf16 v[88:91], v[212:215], v[44:47], v[88:91]
    v_mfma_f32_16x16x32_bf16 v[92:95], v[212:215], v[48:51], v[92:95]
    v_mfma_f32_16x16x32_bf16 v[96:99], v[216:219], v[36:39], v[96:99]
    v_mfma_f32_16x16x32_bf16 v[100:103], v[216:219], v[40:43], v[100:103]
    v_mfma_f32_16x16x32_bf16 v[104:107], v[216:219], v[44:47], v[104:107]
    v_mfma_f32_16x16x32_bf16 v[108:111], v[216:219], v[48:51], v[108:111]
    v_mfma_f32_16x16x32_bf16 v[112:115], v[220:223], v[36:39], v[112:115]
    v_mfma_f32_16x16x32_bf16 v[116:119], v[220:223], v[40:43], v[116:119]
    v_mfma_f32_16x16x32_bf16 v[120:123], v[220:223], v[44:47], v[120:123]
    v_mfma_f32_16x16x32_bf16 v[124:127], v[220:223], v[48:51], v[124:127]
    s_waitcnt lgkmcnt(0)
    s_waitcnt vmcnt(6)
    s_barrier
    s_add_u32 m0, s42, 49152
    s_nop 0
    buffer_load_dwordx4 v10, s[8:11], s44 offen lds
    s_add_u32 m0, s42, 50176
    s_nop 0
    buffer_load_dwordx4 v11, s[8:11], s44 offen lds
    s_add_u32 m0, s43, 65536
    s_nop 0
    buffer_load_dwordx4 v14, s[52:55], s45 offen lds
    s_add_u32 s44, s44, 64
    s_add_u32 s45, s45, 110592
    ds_read_b128 v[36:39], v15 offset:24576
    ds_read_b128 v[40:43], v15 offset:25600
    ds_read_b128 v[44:47], v15 offset:26624
    ds_read_b128 v[48:51], v15 offset:27648
    ds_read_b64_tr_b16 v[208:209], v12 offset:24576
    ds_read_b64_tr_b16 v[210:211], v12 offset:25088
    ds_read_b64_tr_b16 v[212:213], v13 offset:24576
    ds_read_b64_tr_b16 v[214:215], v13 offset:25088
    ds_read_b64_tr_b16 v[216:217], v12 offset:28672
    ds_read_b64_tr_b16 v[218:219], v12 offset:29184
    ds_read_b64_tr_b16 v[220:221], v13 offset:28672
    ds_read_b64_tr_b16 v[222:223], v13 offset:29184
    v_mfma_f32_16x16x32_bf16 v[64:67], v[192:195], v[20:23], v[64:67]
    v_mfma_f32_16x16x32_bf16 v[68:71], v[192:195], v[24:27], v[68:71]
    v_mfma_f32_16x16x32_bf16 v[72:75], v[192:195], v[28:31], v[72:75]
    v_mfma_f32_16x16x32_bf16 v[76:79], v[192:195], v[32:35], v[76:79]
    v_mfma_f32_16x16x32_bf16 v[80:83], v[196:199], v[20:23], v[80:83]
    v_mfma_f32_16x16x32_bf16 v[84:87], v[196:199], v[24:27], v[84:87]
    v_mfma_f32_16x16x32_bf16 v[88:91], v[196:199], v[28:31], v[88:91]
    v_mfma_f32_16x16x32_bf16 v[92:95], v[196:199], v[32:35], v[92:95]
    v_mfma_f32_16x16x32_bf16 v[96:99], v[200:203], v[20:23], v[96:99]
    v_mfma_f32_16x16x32_bf16 v[100:103], v[200:203], v[24:27], v[100:103]
    v_mfma_f32_16x16x32_bf16 v[104:107], v[200:203], v[28:31], v[104:107]
    v_mfma_f32_16x16x32_bf16 v[108:111], v[200:203], v[32:35], v[108:111]
    v_mfma_f32_16x16x32_bf16 v[112:115], v[204:207], v[20:23], v[112:115]
    v_mfma_f32_16x16x32_bf16 v[116:119], v[204:207], v[24:27], v[116:119]
    v_mfma_f32_16x16x32_bf16 v[120:123], v[204:207], v[28:31], v[120:123]
    v_mfma_f32_16x16x32_bf16 v[124:127], v[204:207], v[32:35], v[124:127]
    s_waitcnt lgkmcnt(0)
    s_add_u32 s46, s46, 1
    s_cmp_lt_u32 s46, 4
    s_cbranch_scc1 k4a_kernel_loop
    s_waitcnt vmcnt(6)
    s_barrier
    s_add_u32 m0, s42, 73728
    s_nop 0
    buffer_load_dwordx4 v10, s[8:11], s44 offen lds
    s_add_u32 m0, s42, 74752
    s_nop 0
    buffer_load_dwordx4 v11, s[8:11], s44 offen lds
    s_add_u32 m0, s43, 90112
    s_nop 0
    buffer_load_dwordx4 v14, s[52:55], s45 offen lds
    s_add_u32 s44, s44, 64
    s_add_u32 s45, s45, 110592
    ds_read_b128 v[20:23], v16 offset:0
    ds_read_b128 v[24:27], v16 offset:1024
    ds_read_b128 v[28:31], v16 offset:2048
    ds_read_b128 v[32:35], v16 offset:3072
    ds_read_b64_tr_b16 v[192:193], v18 offset:0
    ds_read_b64_tr_b16 v[194:195], v18 offset:512
    ds_read_b64_tr_b16 v[196:197], v19 offset:0
    ds_read_b64_tr_b16 v[198:199], v19 offset:512
    ds_read_b64_tr_b16 v[200:201], v18 offset:4096
    ds_read_b64_tr_b16 v[202:203], v18 offset:4608
    ds_read_b64_tr_b16 v[204:205], v19 offset:4096
    ds_read_b64_tr_b16 v[206:207], v19 offset:4608
    v_mfma_f32_16x16x32_bf16 v[64:67], v[208:211], v[36:39], v[64:67]
    v_mfma_f32_16x16x32_bf16 v[68:71], v[208:211], v[40:43], v[68:71]
    v_mfma_f32_16x16x32_bf16 v[72:75], v[208:211], v[44:47], v[72:75]
    v_mfma_f32_16x16x32_bf16 v[76:79], v[208:211], v[48:51], v[76:79]
    v_mfma_f32_16x16x32_bf16 v[80:83], v[212:215], v[36:39], v[80:83]
    v_mfma_f32_16x16x32_bf16 v[84:87], v[212:215], v[40:43], v[84:87]
    v_mfma_f32_16x16x32_bf16 v[88:91], v[212:215], v[44:47], v[88:91]
    v_mfma_f32_16x16x32_bf16 v[92:95], v[212:215], v[48:51], v[92:95]
    v_mfma_f32_16x16x32_bf16 v[96:99], v[216:219], v[36:39], v[96:99]
    v_mfma_f32_16x16x32_bf16 v[100:103], v[216:219], v[40:43], v[100:103]
    v_mfma_f32_16x16x32_bf16 v[104:107], v[216:219], v[44:47], v[104:107]
    v_mfma_f32_16x16x32_bf16 v[108:111], v[216:219], v[48:51], v[108:111]
    v_mfma_f32_16x16x32_bf16 v[112:115], v[220:223], v[36:39], v[112:115]
    v_mfma_f32_16x16x32_bf16 v[116:119], v[220:223], v[40:43], v[116:119]
    v_mfma_f32_16x16x32_bf16 v[120:123], v[220:223], v[44:47], v[120:123]
    v_mfma_f32_16x16x32_bf16 v[124:127], v[220:223], v[48:51], v[124:127]
    s_waitcnt lgkmcnt(0)
    s_waitcnt vmcnt(6)
    s_barrier
    ds_read_b128 v[36:39], v16 offset:24576
    ds_read_b128 v[40:43], v16 offset:25600
    ds_read_b128 v[44:47], v16 offset:26624
    ds_read_b128 v[48:51], v16 offset:27648
    ds_read_b64_tr_b16 v[208:209], v18 offset:24576
    ds_read_b64_tr_b16 v[210:211], v18 offset:25088
    ds_read_b64_tr_b16 v[212:213], v19 offset:24576
    ds_read_b64_tr_b16 v[214:215], v19 offset:25088
    ds_read_b64_tr_b16 v[216:217], v18 offset:28672
    ds_read_b64_tr_b16 v[218:219], v18 offset:29184
    ds_read_b64_tr_b16 v[220:221], v19 offset:28672
    ds_read_b64_tr_b16 v[222:223], v19 offset:29184
    v_mfma_f32_16x16x32_bf16 v[64:67], v[192:195], v[20:23], v[64:67]
    v_mfma_f32_16x16x32_bf16 v[68:71], v[192:195], v[24:27], v[68:71]
    v_mfma_f32_16x16x32_bf16 v[72:75], v[192:195], v[28:31], v[72:75]
    v_mfma_f32_16x16x32_bf16 v[76:79], v[192:195], v[32:35], v[76:79]
    v_mfma_f32_16x16x32_bf16 v[80:83], v[196:199], v[20:23], v[80:83]
    v_mfma_f32_16x16x32_bf16 v[84:87], v[196:199], v[24:27], v[84:87]
    v_mfma_f32_16x16x32_bf16 v[88:91], v[196:199], v[28:31], v[88:91]
    v_mfma_f32_16x16x32_bf16 v[92:95], v[196:199], v[32:35], v[92:95]
    v_mfma_f32_16x16x32_bf16 v[96:99], v[200:203], v[20:23], v[96:99]
    v_mfma_f32_16x16x32_bf16 v[100:103], v[200:203], v[24:27], v[100:103]
    v_mfma_f32_16x16x32_bf16 v[104:107], v[200:203], v[28:31], v[104:107]
    v_mfma_f32_16x16x32_bf16 v[108:111], v[200:203], v[32:35], v[108:111]
    v_mfma_f32_16x16x32_bf16 v[112:115], v[204:207], v[20:23], v[112:115]
    v_mfma_f32_16x16x32_bf16 v[116:119], v[204:207], v[24:27], v[116:119]
    v_mfma_f32_16x16x32_bf16 v[120:123], v[204:207], v[28:31], v[120:123]
    v_mfma_f32_16x16x32_bf16 v[124:127], v[204:207], v[32:35], v[124:127]
    s_waitcnt lgkmcnt(0)
    s_waitcnt vmcnt(3)
    s_barrier
    ds_read_b128 v[20:23], v15 offset:0
    ds_read_b128 v[24:27], v15 offset:1024
    ds_read_b128 v[28:31], v15 offset:2048
    ds_read_b128 v[32:35], v15 offset:3072
    ds_read_b64_tr_b16 v[192:193], v12 offset:0
    ds_read_b64_tr_b16 v[194:195], v12 offset:512
    ds_read_b64_tr_b16 v[196:197], v13 offset:0
    ds_read_b64_tr_b16 v[198:199], v13 offset:512
    ds_read_b64_tr_b16 v[200:201], v12 offset:4096
    ds_read_b64_tr_b16 v[202:203], v12 offset:4608
    ds_read_b64_tr_b16 v[204:205], v13 offset:4096
    ds_read_b64_tr_b16 v[206:207], v13 offset:4608
    v_mfma_f32_16x16x32_bf16 v[64:67], v[208:211], v[36:39], v[64:67]
    v_mfma_f32_16x16x32_bf16 v[68:71], v[208:211], v[40:43], v[68:71]
    v_mfma_f32_16x16x32_bf16 v[72:75], v[208:211], v[44:47], v[72:75]
    v_mfma_f32_16x16x32_bf16 v[76:79], v[208:211], v[48:51], v[76:79]
    v_mfma_f32_16x16x32_bf16 v[80:83], v[212:215], v[36:39], v[80:83]
    v_mfma_f32_16x16x32_bf16 v[84:87], v[212:215], v[40:43], v[84:87]
    v_mfma_f32_16x16x32_bf16 v[88:91], v[212:215], v[44:47], v[88:91]
    v_mfma_f32_16x16x32_bf16 v[92:95], v[212:215], v[48:51], v[92:95]
    v_mfma_f32_16x16x32_bf16 v[96:99], v[216:219], v[36:39], v[96:99]
    v_mfma_f32_16x16x32_bf16 v[100:103], v[216:219], v[40:43], v[100:103]
    v_mfma_f32_16x16x32_bf16 v[104:107], v[216:219], v[44:47], v[104:107]
    v_mfma_f32_16x16x32_bf16 v[108:111], v[216:219], v[48:51], v[108:111]
    v_mfma_f32_16x16x32_bf16 v[112:115], v[220:223], v[36:39], v[112:115]
    v_mfma_f32_16x16x32_bf16 v[116:119], v[220:223], v[40:43], v[116:119]
    v_mfma_f32_16x16x32_bf16 v[120:123], v[220:223], v[44:47], v[120:123]
    v_mfma_f32_16x16x32_bf16 v[124:127], v[220:223], v[48:51], v[124:127]
    s_waitcnt lgkmcnt(0)
    s_waitcnt vmcnt(0)
    s_barrier
    ds_read_b128 v[36:39], v15 offset:24576
    ds_read_b128 v[40:43], v15 offset:25600
    ds_read_b128 v[44:47], v15 offset:26624
    ds_read_b128 v[48:51], v15 offset:27648
    ds_read_b64_tr_b16 v[208:209], v12 offset:24576
    ds_read_b64_tr_b16 v[210:211], v12 offset:25088
    ds_read_b64_tr_b16 v[212:213], v13 offset:24576
    ds_read_b64_tr_b16 v[214:215], v13 offset:25088
    ds_read_b64_tr_b16 v[216:217], v12 offset:28672
    ds_read_b64_tr_b16 v[218:219], v12 offset:29184
    ds_read_b64_tr_b16 v[220:221], v13 offset:28672
    ds_read_b64_tr_b16 v[222:223], v13 offset:29184
    v_mfma_f32_16x16x32_bf16 v[64:67], v[192:195], v[20:23], v[64:67]
    v_mfma_f32_16x16x32_bf16 v[68:71], v[192:195], v[24:27], v[68:71]
    v_mfma_f32_16x16x32_bf16 v[72:75], v[192:195], v[28:31], v[72:75]
    v_mfma_f32_16x16x32_bf16 v[76:79], v[192:195], v[32:35], v[76:79]
    v_mfma_f32_16x16x32_bf16 v[80:83], v[196:199], v[20:23], v[80:83]
    v_mfma_f32_16x16x32_bf16 v[84:87], v[196:199], v[24:27], v[84:87]
    v_mfma_f32_16x16x32_bf16 v[88:91], v[196:199], v[28:31], v[88:91]
    v_mfma_f32_16x16x32_bf16 v[92:95], v[196:199], v[32:35], v[92:95]
    v_mfma_f32_16x16x32_bf16 v[96:99], v[200:203], v[20:23], v[96:99]
    v_mfma_f32_16x16x32_bf16 v[100:103], v[200:203], v[24:27], v[100:103]
    v_mfma_f32_16x16x32_bf16 v[104:107], v[200:203], v[28:31], v[104:107]
    v_mfma_f32_16x16x32_bf16 v[108:111], v[200:203], v[32:35], v[108:111]
    v_mfma_f32_16x16x32_bf16 v[112:115], v[204:207], v[20:23], v[112:115]
    v_mfma_f32_16x16x32_bf16 v[116:119], v[204:207], v[24:27], v[116:119]
    v_mfma_f32_16x16x32_bf16 v[120:123], v[204:207], v[28:31], v[120:123]
    v_mfma_f32_16x16x32_bf16 v[124:127], v[204:207], v[32:35], v[124:127]
    s_waitcnt lgkmcnt(0)
    v_mfma_f32_16x16x32_bf16 v[64:67], v[208:211], v[36:39], v[64:67]
    v_mfma_f32_16x16x32_bf16 v[68:71], v[208:211], v[40:43], v[68:71]
    v_mfma_f32_16x16x32_bf16 v[72:75], v[208:211], v[44:47], v[72:75]
    v_mfma_f32_16x16x32_bf16 v[76:79], v[208:211], v[48:51], v[76:79]
    v_mfma_f32_16x16x32_bf16 v[80:83], v[212:215], v[36:39], v[80:83]
    v_mfma_f32_16x16x32_bf16 v[84:87], v[212:215], v[40:43], v[84:87]
    v_mfma_f32_16x16x32_bf16 v[88:91], v[212:215], v[44:47], v[88:91]
    v_mfma_f32_16x16x32_bf16 v[92:95], v[212:215], v[48:51], v[92:95]
    v_mfma_f32_16x16x32_bf16 v[96:99], v[216:219], v[36:39], v[96:99]
    v_mfma_f32_16x16x32_bf16 v[100:103], v[216:219], v[40:43], v[100:103]
    v_mfma_f32_16x16x32_bf16 v[104:107], v[216:219], v[44:47], v[104:107]
    v_mfma_f32_16x16x32_bf16 v[108:111], v[216:219], v[48:51], v[108:111]
    v_mfma_f32_16x16x32_bf16 v[112:115], v[220:223], v[36:39], v[112:115]
    v_mfma_f32_16x16x32_bf16 v[116:119], v[220:223], v[40:43], v[116:119]
    v_mfma_f32_16x16x32_bf16 v[120:123], v[220:223], v[44:47], v[120:123]
    v_mfma_f32_16x16x32_bf16 v[124:127], v[220:223], v[48:51], v[124:127]
    s_nop 9
    s_lshr_b32 s21, s20, 1
    s_mul_i32 s21, s21, 64
    s_lshl_b32 s22, s40, 8
    s_add_u32 s21, s21, s22
    v_add_u32 v5, s21, v3
    v_mul_u32_u24 v5, 3456, v5
    s_and_b32 s21, s20, 1
    s_lshl_b32 s21, s21, 6
    s_mul_i32 s22, s41, 128
    s_add_u32 s21, s21, s22
    v_lshlrev_b32 v6, 3, v4
    v_add_u32 v5, v5, v6
    v_add_u32 v5, s21, v5
    v_cvt_pk_bf16_f32 v7, v64, v64
    v_lshlrev_b32 v64, 16, v7
    v_cvt_pk_bf16_f32 v7, v96, v96
    v_lshlrev_b32 v96, 16, v7
    v_mul_f32 v8, 0xbfb8aa3b, v64
    v_exp_f32 v8, v8
    s_nop 0
    v_add_f32 v8, 1.0, v8
    v_rcp_f32 v8, v8
    s_nop 0
    v_mul_f32 v64, v64, v8
    v_cvt_pk_bf16_f32 v7, v64, v64
    v_lshlrev_b32 v64, 16, v7
    v_mul_f32 v64, v64, v96
    v_cvt_pk_bf16_f32 v7, v65, v65
    v_lshlrev_b32 v65, 16, v7
    v_cvt_pk_bf16_f32 v7, v97, v97
    v_lshlrev_b32 v97, 16, v7
    v_mul_f32 v8, 0xbfb8aa3b, v65
    v_exp_f32 v8, v8
    s_nop 0
    v_add_f32 v8, 1.0, v8
    v_rcp_f32 v8, v8
    s_nop 0
    v_mul_f32 v65, v65, v8
    v_cvt_pk_bf16_f32 v7, v65, v65
    v_lshlrev_b32 v65, 16, v7
    v_mul_f32 v65, v65, v97
    v_cvt_pk_bf16_f32 v7, v66, v66
    v_lshlrev_b32 v66, 16, v7
    v_cvt_pk_bf16_f32 v7, v98, v98
    v_lshlrev_b32 v98, 16, v7
    v_mul_f32 v8, 0xbfb8aa3b, v66
    v_exp_f32 v8, v8
    s_nop 0
    v_add_f32 v8, 1.0, v8
    v_rcp_f32 v8, v8
    s_nop 0
    v_mul_f32 v66, v66, v8
    v_cvt_pk_bf16_f32 v7, v66, v66
    v_lshlrev_b32 v66, 16, v7
    v_mul_f32 v66, v66, v98
    v_cvt_pk_bf16_f32 v7, v67, v67
    v_lshlrev_b32 v67, 16, v7
    v_cvt_pk_bf16_f32 v7, v99, v99
    v_lshlrev_b32 v99, 16, v7
    v_mul_f32 v8, 0xbfb8aa3b, v67
    v_exp_f32 v8, v8
    s_nop 0
    v_add_f32 v8, 1.0, v8
    v_rcp_f32 v8, v8
    s_nop 0
    v_mul_f32 v67, v67, v8
    v_cvt_pk_bf16_f32 v7, v67, v67
    v_lshlrev_b32 v67, 16, v7
    v_mul_f32 v67, v67, v99
    v_cvt_pk_bf16_f32 v64, v64, v65
    v_cvt_pk_bf16_f32 v65, v66, v67
    v_add_u32 v6, 0, v5
    buffer_store_dwordx2 v[64:65], v6, s[28:31], 0 offen
    v_cvt_pk_bf16_f32 v7, v68, v68
    v_lshlrev_b32 v68, 16, v7
    v_cvt_pk_bf16_f32 v7, v100, v100
    v_lshlrev_b32 v100, 16, v7
    v_mul_f32 v8, 0xbfb8aa3b, v68
    v_exp_f32 v8, v8
    s_nop 0
    v_add_f32 v8, 1.0, v8
    v_rcp_f32 v8, v8
    s_nop 0
    v_mul_f32 v68, v68, v8
    v_cvt_pk_bf16_f32 v7, v68, v68
    v_lshlrev_b32 v68, 16, v7
    v_mul_f32 v68, v68, v100
    v_cvt_pk_bf16_f32 v7, v69, v69
    v_lshlrev_b32 v69, 16, v7
    v_cvt_pk_bf16_f32 v7, v101, v101
    v_lshlrev_b32 v101, 16, v7
    v_mul_f32 v8, 0xbfb8aa3b, v69
    v_exp_f32 v8, v8
    s_nop 0
    v_add_f32 v8, 1.0, v8
    v_rcp_f32 v8, v8
    s_nop 0
    v_mul_f32 v69, v69, v8
    v_cvt_pk_bf16_f32 v7, v69, v69
    v_lshlrev_b32 v69, 16, v7
    v_mul_f32 v69, v69, v101
    v_cvt_pk_bf16_f32 v7, v70, v70
    v_lshlrev_b32 v70, 16, v7
    v_cvt_pk_bf16_f32 v7, v102, v102
    v_lshlrev_b32 v102, 16, v7
    v_mul_f32 v8, 0xbfb8aa3b, v70
    v_exp_f32 v8, v8
    s_nop 0
    v_add_f32 v8, 1.0, v8
    v_rcp_f32 v8, v8
    s_nop 0
    v_mul_f32 v70, v70, v8
    v_cvt_pk_bf16_f32 v7, v70, v70
    v_lshlrev_b32 v70, 16, v7
    v_mul_f32 v70, v70, v102
    v_cvt_pk_bf16_f32 v7, v71, v71
    v_lshlrev_b32 v71, 16, v7
    v_cvt_pk_bf16_f32 v7, v103, v103
    v_lshlrev_b32 v103, 16, v7
    v_mul_f32 v8, 0xbfb8aa3b, v71
    v_exp_f32 v8, v8
    s_nop 0
    v_add_f32 v8, 1.0, v8
    v_rcp_f32 v8, v8
    s_nop 0
    v_mul_f32 v71, v71, v8
    v_cvt_pk_bf16_f32 v7, v71, v71
    v_lshlrev_b32 v71, 16, v7
    v_mul_f32 v71, v71, v103
    v_cvt_pk_bf16_f32 v68, v68, v69
    v_cvt_pk_bf16_f32 v69, v70, v71
    v_add_u32 v6, 55296, v5
    buffer_store_dwordx2 v[68:69], v6, s[28:31], 0 offen
    v_cvt_pk_bf16_f32 v7, v72, v72
    v_lshlrev_b32 v72, 16, v7
    v_cvt_pk_bf16_f32 v7, v104, v104
    v_lshlrev_b32 v104, 16, v7
    v_mul_f32 v8, 0xbfb8aa3b, v72
    v_exp_f32 v8, v8
    s_nop 0
    v_add_f32 v8, 1.0, v8
    v_rcp_f32 v8, v8
    s_nop 0
    v_mul_f32 v72, v72, v8
    v_cvt_pk_bf16_f32 v7, v72, v72
    v_lshlrev_b32 v72, 16, v7
    v_mul_f32 v72, v72, v104
    v_cvt_pk_bf16_f32 v7, v73, v73
    v_lshlrev_b32 v73, 16, v7
    v_cvt_pk_bf16_f32 v7, v105, v105
    v_lshlrev_b32 v105, 16, v7
    v_mul_f32 v8, 0xbfb8aa3b, v73
    v_exp_f32 v8, v8
    s_nop 0
    v_add_f32 v8, 1.0, v8
    v_rcp_f32 v8, v8
    s_nop 0
    v_mul_f32 v73, v73, v8
    v_cvt_pk_bf16_f32 v7, v73, v73
    v_lshlrev_b32 v73, 16, v7
    v_mul_f32 v73, v73, v105
    v_cvt_pk_bf16_f32 v7, v74, v74
    v_lshlrev_b32 v74, 16, v7
    v_cvt_pk_bf16_f32 v7, v106, v106
    v_lshlrev_b32 v106, 16, v7
    v_mul_f32 v8, 0xbfb8aa3b, v74
    v_exp_f32 v8, v8
    s_nop 0
    v_add_f32 v8, 1.0, v8
    v_rcp_f32 v8, v8
    s_nop 0
    v_mul_f32 v74, v74, v8
    v_cvt_pk_bf16_f32 v7, v74, v74
    v_lshlrev_b32 v74, 16, v7
    v_mul_f32 v74, v74, v106
    v_cvt_pk_bf16_f32 v7, v75, v75
    v_lshlrev_b32 v75, 16, v7
    v_cvt_pk_bf16_f32 v7, v107, v107
    v_lshlrev_b32 v107, 16, v7
    v_mul_f32 v8, 0xbfb8aa3b, v75
    v_exp_f32 v8, v8
    s_nop 0
    v_add_f32 v8, 1.0, v8
    v_rcp_f32 v8, v8
    s_nop 0
    v_mul_f32 v75, v75, v8
    v_cvt_pk_bf16_f32 v7, v75, v75
    v_lshlrev_b32 v75, 16, v7
    v_mul_f32 v75, v75, v107
    v_cvt_pk_bf16_f32 v72, v72, v73
    v_cvt_pk_bf16_f32 v73, v74, v75
    v_add_u32 v6, 110592, v5
    buffer_store_dwordx2 v[72:73], v6, s[28:31], 0 offen
    v_cvt_pk_bf16_f32 v7, v76, v76
    v_lshlrev_b32 v76, 16, v7
    v_cvt_pk_bf16_f32 v7, v108, v108
    v_lshlrev_b32 v108, 16, v7
    v_mul_f32 v8, 0xbfb8aa3b, v76
    v_exp_f32 v8, v8
    s_nop 0
    v_add_f32 v8, 1.0, v8
    v_rcp_f32 v8, v8
    s_nop 0
    v_mul_f32 v76, v76, v8
    v_cvt_pk_bf16_f32 v7, v76, v76
    v_lshlrev_b32 v76, 16, v7
    v_mul_f32 v76, v76, v108
    v_cvt_pk_bf16_f32 v7, v77, v77
    v_lshlrev_b32 v77, 16, v7
    v_cvt_pk_bf16_f32 v7, v109, v109
    v_lshlrev_b32 v109, 16, v7
    v_mul_f32 v8, 0xbfb8aa3b, v77
    v_exp_f32 v8, v8
    s_nop 0
    v_add_f32 v8, 1.0, v8
    v_rcp_f32 v8, v8
    s_nop 0
    v_mul_f32 v77, v77, v8
    v_cvt_pk_bf16_f32 v7, v77, v77
    v_lshlrev_b32 v77, 16, v7
    v_mul_f32 v77, v77, v109
    v_cvt_pk_bf16_f32 v7, v78, v78
    v_lshlrev_b32 v78, 16, v7
    v_cvt_pk_bf16_f32 v7, v110, v110
    v_lshlrev_b32 v110, 16, v7
    v_mul_f32 v8, 0xbfb8aa3b, v78
    v_exp_f32 v8, v8
    s_nop 0
    v_add_f32 v8, 1.0, v8
    v_rcp_f32 v8, v8
    s_nop 0
    v_mul_f32 v78, v78, v8
    v_cvt_pk_bf16_f32 v7, v78, v78
    v_lshlrev_b32 v78, 16, v7
    v_mul_f32 v78, v78, v110
    v_cvt_pk_bf16_f32 v7, v79, v79
    v_lshlrev_b32 v79, 16, v7
    v_cvt_pk_bf16_f32 v7, v111, v111
    v_lshlrev_b32 v111, 16, v7
    v_mul_f32 v8, 0xbfb8aa3b, v79
    v_exp_f32 v8, v8
    s_nop 0
    v_add_f32 v8, 1.0, v8
    v_rcp_f32 v8, v8
    s_nop 0
    v_mul_f32 v79, v79, v8
    v_cvt_pk_bf16_f32 v7, v79, v79
    v_lshlrev_b32 v79, 16, v7
    v_mul_f32 v79, v79, v111
    v_cvt_pk_bf16_f32 v76, v76, v77
    v_cvt_pk_bf16_f32 v77, v78, v79
    v_add_u32 v6, 165888, v5
    buffer_store_dwordx2 v[76:77], v6, s[28:31], 0 offen
    v_cvt_pk_bf16_f32 v7, v80, v80
    v_lshlrev_b32 v80, 16, v7
    v_cvt_pk_bf16_f32 v7, v112, v112
    v_lshlrev_b32 v112, 16, v7
    v_mul_f32 v8, 0xbfb8aa3b, v80
    v_exp_f32 v8, v8
    s_nop 0
    v_add_f32 v8, 1.0, v8
    v_rcp_f32 v8, v8
    s_nop 0
    v_mul_f32 v80, v80, v8
    v_cvt_pk_bf16_f32 v7, v80, v80
    v_lshlrev_b32 v80, 16, v7
    v_mul_f32 v80, v80, v112
    v_cvt_pk_bf16_f32 v7, v81, v81
    v_lshlrev_b32 v81, 16, v7
    v_cvt_pk_bf16_f32 v7, v113, v113
    v_lshlrev_b32 v113, 16, v7
    v_mul_f32 v8, 0xbfb8aa3b, v81
    v_exp_f32 v8, v8
    s_nop 0
    v_add_f32 v8, 1.0, v8
    v_rcp_f32 v8, v8
    s_nop 0
    v_mul_f32 v81, v81, v8
    v_cvt_pk_bf16_f32 v7, v81, v81
    v_lshlrev_b32 v81, 16, v7
    v_mul_f32 v81, v81, v113
    v_cvt_pk_bf16_f32 v7, v82, v82
    v_lshlrev_b32 v82, 16, v7
    v_cvt_pk_bf16_f32 v7, v114, v114
    v_lshlrev_b32 v114, 16, v7
    v_mul_f32 v8, 0xbfb8aa3b, v82
    v_exp_f32 v8, v8
    s_nop 0
    v_add_f32 v8, 1.0, v8
    v_rcp_f32 v8, v8
    s_nop 0
    v_mul_f32 v82, v82, v8
    v_cvt_pk_bf16_f32 v7, v82, v82
    v_lshlrev_b32 v82, 16, v7
    v_mul_f32 v82, v82, v114
    v_cvt_pk_bf16_f32 v7, v83, v83
    v_lshlrev_b32 v83, 16, v7
    v_cvt_pk_bf16_f32 v7, v115, v115
    v_lshlrev_b32 v115, 16, v7
    v_mul_f32 v8, 0xbfb8aa3b, v83
    v_exp_f32 v8, v8
    s_nop 0
    v_add_f32 v8, 1.0, v8
    v_rcp_f32 v8, v8
    s_nop 0
    v_mul_f32 v83, v83, v8
    v_cvt_pk_bf16_f32 v7, v83, v83
    v_lshlrev_b32 v83, 16, v7
    v_mul_f32 v83, v83, v115
    v_cvt_pk_bf16_f32 v80, v80, v81
    v_cvt_pk_bf16_f32 v81, v82, v83
    v_add_u32 v6, 32, v5
    buffer_store_dwordx2 v[80:81], v6, s[28:31], 0 offen
    v_cvt_pk_bf16_f32 v7, v84, v84
    v_lshlrev_b32 v84, 16, v7
    v_cvt_pk_bf16_f32 v7, v116, v116
    v_lshlrev_b32 v116, 16, v7
    v_mul_f32 v8, 0xbfb8aa3b, v84
    v_exp_f32 v8, v8
    s_nop 0
    v_add_f32 v8, 1.0, v8
    v_rcp_f32 v8, v8
    s_nop 0
    v_mul_f32 v84, v84, v8
    v_cvt_pk_bf16_f32 v7, v84, v84
    v_lshlrev_b32 v84, 16, v7
    v_mul_f32 v84, v84, v116
    v_cvt_pk_bf16_f32 v7, v85, v85
    v_lshlrev_b32 v85, 16, v7
    v_cvt_pk_bf16_f32 v7, v117, v117
    v_lshlrev_b32 v117, 16, v7
    v_mul_f32 v8, 0xbfb8aa3b, v85
    v_exp_f32 v8, v8
    s_nop 0
    v_add_f32 v8, 1.0, v8
    v_rcp_f32 v8, v8
    s_nop 0
    v_mul_f32 v85, v85, v8
    v_cvt_pk_bf16_f32 v7, v85, v85
    v_lshlrev_b32 v85, 16, v7
    v_mul_f32 v85, v85, v117
    v_cvt_pk_bf16_f32 v7, v86, v86
    v_lshlrev_b32 v86, 16, v7
    v_cvt_pk_bf16_f32 v7, v118, v118
    v_lshlrev_b32 v118, 16, v7
    v_mul_f32 v8, 0xbfb8aa3b, v86
    v_exp_f32 v8, v8
    s_nop 0
    v_add_f32 v8, 1.0, v8
    v_rcp_f32 v8, v8
    s_nop 0
    v_mul_f32 v86, v86, v8
    v_cvt_pk_bf16_f32 v7, v86, v86
    v_lshlrev_b32 v86, 16, v7
    v_mul_f32 v86, v86, v118
    v_cvt_pk_bf16_f32 v7, v87, v87
    v_lshlrev_b32 v87, 16, v7
    v_cvt_pk_bf16_f32 v7, v119, v119
    v_lshlrev_b32 v119, 16, v7
    v_mul_f32 v8, 0xbfb8aa3b, v87
    v_exp_f32 v8, v8
    s_nop 0
    v_add_f32 v8, 1.0, v8
    v_rcp_f32 v8, v8
    s_nop 0
    v_mul_f32 v87, v87, v8
    v_cvt_pk_bf16_f32 v7, v87, v87
    v_lshlrev_b32 v87, 16, v7
    v_mul_f32 v87, v87, v119
    v_cvt_pk_bf16_f32 v84, v84, v85
    v_cvt_pk_bf16_f32 v85, v86, v87
    v_add_u32 v6, 55328, v5
    buffer_store_dwordx2 v[84:85], v6, s[28:31], 0 offen
    v_cvt_pk_bf16_f32 v7, v88, v88
    v_lshlrev_b32 v88, 16, v7
    v_cvt_pk_bf16_f32 v7, v120, v120
    v_lshlrev_b32 v120, 16, v7
    v_mul_f32 v8, 0xbfb8aa3b, v88
    v_exp_f32 v8, v8
    s_nop 0
    v_add_f32 v8, 1.0, v8
    v_rcp_f32 v8, v8
    s_nop 0
    v_mul_f32 v88, v88, v8
    v_cvt_pk_bf16_f32 v7, v88, v88
    v_lshlrev_b32 v88, 16, v7
    v_mul_f32 v88, v88, v120
    v_cvt_pk_bf16_f32 v7, v89, v89
    v_lshlrev_b32 v89, 16, v7
    v_cvt_pk_bf16_f32 v7, v121, v121
    v_lshlrev_b32 v121, 16, v7
    v_mul_f32 v8, 0xbfb8aa3b, v89
    v_exp_f32 v8, v8
    s_nop 0
    v_add_f32 v8, 1.0, v8
    v_rcp_f32 v8, v8
    s_nop 0
    v_mul_f32 v89, v89, v8
    v_cvt_pk_bf16_f32 v7, v89, v89
    v_lshlrev_b32 v89, 16, v7
    v_mul_f32 v89, v89, v121
    v_cvt_pk_bf16_f32 v7, v90, v90
    v_lshlrev_b32 v90, 16, v7
    v_cvt_pk_bf16_f32 v7, v122, v122
    v_lshlrev_b32 v122, 16, v7
    v_mul_f32 v8, 0xbfb8aa3b, v90
    v_exp_f32 v8, v8
    s_nop 0
    v_add_f32 v8, 1.0, v8
    v_rcp_f32 v8, v8
    s_nop 0
    v_mul_f32 v90, v90, v8
    v_cvt_pk_bf16_f32 v7, v90, v90
    v_lshlrev_b32 v90, 16, v7
    v_mul_f32 v90, v90, v122
    v_cvt_pk_bf16_f32 v7, v91, v91
    v_lshlrev_b32 v91, 16, v7
    v_cvt_pk_bf16_f32 v7, v123, v123
    v_lshlrev_b32 v123, 16, v7
    v_mul_f32 v8, 0xbfb8aa3b, v91
    v_exp_f32 v8, v8
    s_nop 0
    v_add_f32 v8, 1.0, v8
    v_rcp_f32 v8, v8
    s_nop 0
    v_mul_f32 v91, v91, v8
    v_cvt_pk_bf16_f32 v7, v91, v91
    v_lshlrev_b32 v91, 16, v7
    v_mul_f32 v91, v91, v123
    v_cvt_pk_bf16_f32 v88, v88, v89
    v_cvt_pk_bf16_f32 v89, v90, v91
    v_add_u32 v6, 110624, v5
    buffer_store_dwordx2 v[88:89], v6, s[28:31], 0 offen
    v_cvt_pk_bf16_f32 v7, v92, v92
    v_lshlrev_b32 v92, 16, v7
    v_cvt_pk_bf16_f32 v7, v124, v124
    v_lshlrev_b32 v124, 16, v7
    v_mul_f32 v8, 0xbfb8aa3b, v92
    v_exp_f32 v8, v8
    s_nop 0
    v_add_f32 v8, 1.0, v8
    v_rcp_f32 v8, v8
    s_nop 0
    v_mul_f32 v92, v92, v8
    v_cvt_pk_bf16_f32 v7, v92, v92
    v_lshlrev_b32 v92, 16, v7
    v_mul_f32 v92, v92, v124
    v_cvt_pk_bf16_f32 v7, v93, v93
    v_lshlrev_b32 v93, 16, v7
    v_cvt_pk_bf16_f32 v7, v125, v125
    v_lshlrev_b32 v125, 16, v7
    v_mul_f32 v8, 0xbfb8aa3b, v93
    v_exp_f32 v8, v8
    s_nop 0
    v_add_f32 v8, 1.0, v8
    v_rcp_f32 v8, v8
    s_nop 0
    v_mul_f32 v93, v93, v8
    v_cvt_pk_bf16_f32 v7, v93, v93
    v_lshlrev_b32 v93, 16, v7
    v_mul_f32 v93, v93, v125
    v_cvt_pk_bf16_f32 v7, v94, v94
    v_lshlrev_b32 v94, 16, v7
    v_cvt_pk_bf16_f32 v7, v126, v126
    v_lshlrev_b32 v126, 16, v7
    v_mul_f32 v8, 0xbfb8aa3b, v94
    v_exp_f32 v8, v8
    s_nop 0
    v_add_f32 v8, 1.0, v8
    v_rcp_f32 v8, v8
    s_nop 0
    v_mul_f32 v94, v94, v8
    v_cvt_pk_bf16_f32 v7, v94, v94
    v_lshlrev_b32 v94, 16, v7
    v_mul_f32 v94, v94, v126
    v_cvt_pk_bf16_f32 v7, v95, v95
    v_lshlrev_b32 v95, 16, v7
    v_cvt_pk_bf16_f32 v7, v127, v127
    v_lshlrev_b32 v127, 16, v7
    v_mul_f32 v8, 0xbfb8aa3b, v95
    v_exp_f32 v8, v8
    s_nop 0
    v_add_f32 v8, 1.0, v8
    v_rcp_f32 v8, v8
    s_nop 0
    v_mul_f32 v95, v95, v8
    v_cvt_pk_bf16_f32 v7, v95, v95
    v_lshlrev_b32 v95, 16, v7
    v_mul_f32 v95, v95, v127
    v_cvt_pk_bf16_f32 v92, v92, v93
    v_cvt_pk_bf16_f32 v93, v94, v95
    v_add_u32 v6, 165920, v5
    buffer_store_dwordx2 v[92:93], v6, s[28:31], 0 offen
k4a_kernel_end:
    s_endpgm
.globl k5a_kernel
.p2align 8
.type k5a_kernel,@function
k5a_kernel:
    s_cmp_ge_u32 s2, 320
    s_cbranch_scc1 k5a_kernel_end
    s_and_b32 s47, s2, 7
    s_lshr_b32 s48, s2, 3
    s_mul_i32 s40, s48, 6554
    s_lshr_b32 s40, s40, 16
    s_mul_i32 s41, s40, 10
    s_sub_u32 s41, s48, s41
    s_lshl_b32 s40, s40, 3
    s_add_u32 s40, s40, s47
    s_load_dwordx2 s[6:7], s[0:1], 72
    s_load_dwordx2 s[16:17], s[0:1], 48
    s_load_dwordx2 s[18:19], s[0:1], 56
    v_lshrrev_b32 v1, 6, v0
    s_nop 0
    v_readfirstlane_b32 s20, v1
    v_and_b32 v2, 63, v0
    s_waitcnt lgkmcnt(0)
    s_mov_b32 s4, s6
    s_mov_b32 s5, s7
    s_add_u32 s4, s4, 0x1000000
    s_addc_u32 s5, s5, 0
    s_mov_b32 s8, s4
    s_and_b32 s9, s5, 0xffff
    s_mov_b32 s10, 0x6c0000
    s_mov_b32 s11, 0x00020000
    s_mov_b32 s12, s16
    s_and_b32 s13, s17, 0xffff
    s_mov_b32 s14, 0x21c000
    s_mov_b32 s15, 0x00020000
    s_mov_b32 s4, s6
    s_mov_b32 s5, s7
    s_add_u32 s4, s4, 0x1800000
    s_addc_u32 s5, s5, 0
    s_mov_b32 s28, s4
    s_and_b32 s29, s5, 0xffff
    s_mov_b32 s30, 0x280000
    s_mov_b32 s31, 0x00020000
    s_mov_b32 s4, s6
    s_mov_b32 s5, s7
    s_add_u32 s4, s4, 0x800000
    s_addc_u32 s5, s5, 0
    s_mov_b32 s24, s4
    s_and_b32 s25, s5, 0xffff
    s_mov_b32 s26, 0x280000
    s_mov_b32 s27, 0x00020000
    v_lshrrev_b32 v3, 2, v2
    v_and_b32 v5, 3, v2
    s_mul_i32 s21, s20, 16
    s_lshl_b32 s22, s40, 6
    s_add_u32 s21, s21, s22
    v_add_u32 v7, 0, v3
    v_lshrrev_b32 v6, 3, v7
    v_and_b32 v6, 1, v6
    v_lshlrev_b32 v6, 1, v6
    v_xor_b32 v6, v6, v5
    v_lshlrev_b32 v6, 4, v6
    v_add_u32 v7, s21, v7
    v_mul_u32_u24 v7, 3456, v7
    v_add_u32 v10, v6, v7
    v_lshrrev_b32 v3, 3, v2
    v_and_b32 v5, 7, v2
    s_and_b32 s21, s20, 3
    s_lshl_b32 s21, s21, 3
    s_mul_i32 s22, s41, 128
    v_add_u32 v7, s21, v3
    v_lshrrev_b32 v6, 1, v7
    v_and_b32 v6, 1, v6
    v_lshrrev_b32 v8, 3, v7
    v_and_b32 v8, 1, v8
    v_lshlrev_b32 v8, 1, v8
    v_or_b32 v6, v6, v8
    v_lshlrev_b32 v6, 1, v6
    v_xor_b32 v6, v6, v5
    v_lshlrev_b32 v6, 4, v6
    v_mul_u32_u24 v7, 1280, v7
    v_add_u32 v7, v7, v6
    v_add_u32 v14, s22, v7
    v_and_b32 v3, 15, v2
    v_lshrrev_b32 v4, 4, v2
    s_lshr_b32 s21, s20, 1
    s_mul_i32 s21, s21, 2048
    v_lshrrev_b32 v7, 3, v3
    v_lshlrev_b32 v7, 1, v7
    v_xor_b32 v6, v4, v7
    v_lshlrev_b32 v6, 4, v6
    v_lshlrev_b32 v7, 6, v3
    v_add_u32 v6, v6, v7
    v_add_u32 v16, s21, v6
    s_and_b32 s21, s20, 1
    v_lshrrev_b32 v5, 3, v3
    v_and_b32 v6, 1, v4
    v_lshlrev_b32 v6, 1, v6
    v_or_b32 v5, v5, v6
    v_lshlrev_b32 v5, 1, v5
    v_and_b32 v6, 3, v3
    v_lshrrev_b32 v6, 1, v6
    s_lshl_b32 s22, s21, 2
    v_add_u32 v6, s22, v6
    v_lshlrev_b32 v7, 3, v4
    v_lshrrev_b32 v8, 2, v3
    v_add_u32 v7, v7, v8
    v_lshlrev_b32 v7, 7, v7
    v_and_b32 v8, 1, v3
    v_lshlrev_b32 v8, 3, v8
    v_add_u32 v7, v7, v8
    v_add_u32 v7, 4096, v7
    v_add_u32 v8, 0, v6
    v_xor_b32 v8, v8, v5
    v_lshlrev_b32 v8, 4, v8
    v_add_u32 v18, v8, v7
    v_add_u32 v8, 2, v6
    v_xor_b32 v8, v8, v5
    v_lshlrev_b32 v8, 4, v8
    v_add_u32 v19, v8, v7
    v_add_u32 v15, 16384, v16
    v_add_u32 v12, 16384, v18
    v_add_u32 v13, 16384, v19
    v_mov_b32 v64, 0
    v_mov_b32 v65, 0
    v_mov_b32 v66, 0
    v_mov_b32 v67, 0
    v_mov_b32 v68, 0
    v_mov_b32 v69, 0
    v_mov_b32 v70, 0
    v_mov_b32 v71, 0
    v_mov_b32 v72, 0
    v_mov_b32 v73, 0
    v_mov_b32 v74, 0
    v_mov_b32 v75, 0
    v_mov_b32 v76, 0
    v_mov_b32 v77, 0
    v_mov_b32 v78, 0
    v_mov_b32 v79, 0
    s_mul_i32 s42, s20, 1024
    s_lshl_b32 s43, s20, 10
    s_cmp_ge_u32 s20, 4
    s_cselect_b32 s52, s12, s12
    s_cselect_b32 s53, s13, s13
    s_cselect_b32 s54, s14, s14
    s_cselect_b32 s55, s15, s15
    s_mov_b32 s44, 0
    s_mov_b32 s45, 0
    s_add_u32 m0, s42, 0
    s_nop 0
    buffer_load_dwordx4 v10, s[8:11], s44 offen lds
    s_add_u32 m0, s43, 4096
    s_nop 0
    buffer_load_dwordx4 v14, s[52:55], s45 offen lds
    s_add_u32 s44, s44, 64
    s_add_u32 s45, s45, 40960
    s_add_u32 m0, s42, 8192
    s_nop 0
    buffer_load_dwordx4 v10, s[8:11], s44 offen lds
    s_add_u32 m0, s43, 12288
    s_nop 0
    buffer_load_dwordx4 v14, s[52:55], s45 offen lds
    s_add_u32 s44, s44, 64
    s_add_u32 s45, s45, 40960
    s_add_u32 m0, s42, 16384
    s_nop 0
    buffer_load_dwordx4 v10, s[8:11], s44 offen lds
    s_add_u32 m0, s43, 20480
    s_nop 0
    buffer_load_dwordx4 v14, s[52:55], s45 offen lds
    s_add_u32 s44, s44, 64
    s_add_u32 s45, s45, 40960
    s_waitcnt vmcnt(4)
    s_barrier
    s_add_u32 m0, s42, 24576
    s_nop 0
    buffer_load_dwordx4 v10, s[8:11], s44 offen lds
    s_add_u32 m0, s43, 28672
    s_nop 0
    buffer_load_dwordx4 v14, s[52:55], s45 offen lds
    s_add_u32 s44, s44, 64
    s_add_u32 s45, s45, 40960
    ds_read_b128 v[20:23], v16 offset:0
    ds_read_b128 v[24:27], v16 offset:1024
    ds_read_b64_tr_b16 v[192:193], v18 offset:0
    ds_read_b64_tr_b16 v[194:195], v18 offset:512
    ds_read_b64_tr_b16 v[196:197], v19 offset:0
    ds_read_b64_tr_b16 v[198:199], v19 offset:512
    s_waitcnt lgkmcnt(0)
    s_waitcnt vmcnt(4)
    s_barrier
    s_add_u32 m0, s42, 0
    s_nop 0
    buffer_load_dwordx4 v10, s[8:11], s44 offen lds
    s_add_u32 m0, s43, 4096
    s_nop 0
    buffer_load_dwordx4 v14, s[52:55], s45 offen lds
    s_add_u32 s44, s44, 64
    s_add_u32 s45, s45, 40960
    ds_read_b128 v[36:39], v16 offset:8192
    ds_read_b128 v[40:43], v16 offset:9216
    ds_read_b64_tr_b16 v[208:209], v18 offset:8192
    ds_read_b64_tr_b16 v[210:211], v18 offset:8704
    ds_read_b64_tr_b16 v[212:213], v19 offset:8192
    ds_read_b64_tr_b16 v[214:215], v19 offset:8704
    v_mfma_f32_16x16x32_bf16 v[64:67], v[192:195], v[20:23], v[64:67]
    v_mfma_f32_16x16x32_bf16 v[68:71], v[192:195], v[24:27], v[68:71]
    v_mfma_f32_16x16x32_bf16 v[72:75], v[196:199], v[20:23], v[72:75]
    v_mfma_f32_16x16x32_bf16 v[76:79], v[196:199], v[24:27], v[76:79]
    s_waitcnt lgkmcnt(0)
    s_waitcnt vmcnt(4)
    s_barrier
    s_add_u32 m0, s42, 8192
    s_nop 0
    buffer_load_dwordx4 v10, s[8:11], s44 offen lds
    s_add_u32 m0, s43, 12288
    s_nop 0
    buffer_load_dwordx4 v14, s[52:55], s45 offen lds
    s_add_u32 s44, s44, 64
    s_add_u32 s45, s45, 40960
    ds_read_b128 v[20:23], v15 offset:0
    ds_read_b128 v[24:27], v15 offset:1024
    ds_read_b64_tr_b16 v[192:193], v12 offset:0
    ds_read_b64_tr_b16 v[194:195], v12 offset:512
    ds_read_b64_tr_b16 v[196:197], v13 offset:0
    ds_read_b64_tr_b16 v[198:199], v13 offset:512
    v_mfma_f32_16x16x32_bf16 v[64:67], v[208:211], v[36:39], v[64:67]
    v_mfma_f32_16x16x32_bf16 v[68:71], v[208:211], v[40:43], v[68:71]
    v_mfma_f32_16x16x32_bf16 v[72:75], v[212:215], v[36:39], v[72:75]
    v_mfma_f32_16x16x32_bf16 v[76:79], v[212:215], v[40:43], v[76:79]
    s_waitcnt lgkmcnt(0)
    s_waitcnt vmcnt(4)
    s_barrier
    s_add_u32 m0, s42, 16384
    s_nop 0
    buffer_load_dwordx4 v10, s[8:11], s44 offen lds
    s_add_u32 m0, s43, 20480
    s_nop 0
    buffer_load_dwordx4 v14, s[52:55], s45 offen lds
    s_add_u32 s44, s44, 64
    s_add_u32 s45, s45, 40960
    ds_read_b128 v[36:39], v15 offset:8192
    ds_read_b128 v[40:43], v15 offset:9216
    ds_read_b64_tr_b16 v[208:209], v12 offset:8192
    ds_read_b64_tr_b16 v[210:211], v12 offset:8704
    ds_read_b64_tr_b16 v[212:213], v13 offset:8192
    ds_read_b64_tr_b16 v[214:215], v13 offset:8704
    v_mfma_f32_16x16x32_bf16 v[64:67], v[192:195], v[20:23], v[64:67]
    v_mfma_f32_16x16x32_bf16 v[68:71], v[192:195], v[24:27], v[68:71]
    v_mfma_f32_16x16x32_bf16 v[72:75], v[196:199], v[20:23], v[72:75]
    v_mfma_f32_16x16x32_bf16 v[76:79], v[196:199], v[24:27], v[76:79]
    s_waitcnt lgkmcnt(0)
    s_mov_b32 s46, 1
k5a_kernel_loop:
    s_waitcnt vmcnt(4)
    s_barrier
    s_add_u32 m0, s42, 24576
    s_nop 0
    buffer_load_dwordx4 v10, s[8:11], s44 offen lds
    s_add_u32 m0, s43, 28672
    s_nop 0
    buffer_load_dwordx4 v14, s[52:55], s45 offen lds
    s_add_u32 s44, s44, 64
    s_add_u32 s45, s45, 40960
    ds_read_b128 v[20:23], v16 offset:0
    ds_read_b128 v[24:27], v16 offset:1024
    ds_read_b64_tr_b16 v[192:193], v18 offset:0
    ds_read_b64_tr_b16 v[194:195], v18 offset:512
    ds_read_b64_tr_b16 v[196:197], v19 offset:0
    ds_read_b64_tr_b16 v[198:199], v19 offset:512
    v_mfma_f32_16x16x32_bf16 v[64:67], v[208:211], v[36:39], v[64:67]
    v_mfma_f32_16x16x32_bf16 v[68:71], v[208:211], v[40:43], v[68:71]
    v_mfma_f32_16x16x32_bf16 v[72:75], v[212:215], v[36:39], v[72:75]
    v_mfma_f32_16x16x32_bf16 v[76:79], v[212:215], v[40:43], v[76:79]
    s_waitcnt lgkmcnt(0)
    s_waitcnt vmcnt(4)
    s_barrier
    s_add_u32 m0, s42, 0
    s_nop 0
    buffer_load_dwordx4 v10, s[8:11], s44 offen lds
    s_add_u32 m0, s43, 4096
    s_nop 0
    buffer_load_dwordx4 v14, s[52:55], s45 offen lds
    s_add_u32 s44, s44, 64
    s_add_u32 s45, s45, 40960
    ds_read_b128 v[36:39], v16 offset:8192
    ds_read_b128 v[40:43], v16 offset:9216
    ds_read_b64_tr_b16 v[208:209], v18 offset:8192
    ds_read_b64_tr_b16 v[210:211], v18 offset:8704
    ds_read_b64_tr_b16 v[212:213], v19 offset:8192
    ds_read_b64_tr_b16 v[214:215], v19 offset:8704
    v_mfma_f32_16x16x32_bf16 v[64:67], v[192:195], v[20:23], v[64:67]
    v_mfma_f32_16x16x32_bf16 v[68:71], v[192:195], v[24:27], v[68:71]
    v_mfma_f32_16x16x32_bf16 v[72:75], v[196:199], v[20:23], v[72:75]
    v_mfma_f32_16x16x32_bf16 v[76:79], v[196:199], v[24:27], v[76:79]
    s_waitcnt lgkmcnt(0)
    s_waitcnt vmcnt(4)
    s_barrier
    s_add_u32 m0, s42, 8192
    s_nop 0
    buffer_load_dwordx4 v10, s[8:11], s44 offen lds
    s_add_u32 m0, s43, 12288
    s_nop 0
    buffer_load_dwordx4 v14, s[52:55], s45 offen lds
    s_add_u32 s44, s44, 64
    s_add_u32 s45, s45, 40960
    ds_read_b128 v[20:23], v15 offset:0
    ds_read_b128 v[24:27], v15 offset:1024
    ds_read_b64_tr_b16 v[192:193], v12 offset:0
    ds_read_b64_tr_b16 v[194:195], v12 offset:512
    ds_read_b64_tr_b16 v[196:197], v13 offset:0
    ds_read_b64_tr_b16 v[198:199], v13 offset:512
    v_mfma_f32_16x16x32_bf16 v[64:67], v[208:211], v[36:39], v[64:67]
    v_mfma_f32_16x16x32_bf16 v[68:71], v[208:211], v[40:43], v[68:71]
    v_mfma_f32_16x16x32_bf16 v[72:75], v[212:215], v[36:39], v[72:75]
    v_mfma_f32_16x16x32_bf16 v[76:79], v[212:215], v[40:43], v[76:79]
    s_waitcnt lgkmcnt(0)
    s_waitcnt vmcnt(4)
    s_barrier
    s_add_u32 m0, s42, 16384
    s_nop 0
    buffer_load_dwordx4 v10, s[8:11], s44 offen lds
    s_add_u32 m0, s43, 20480
    s_nop 0
    buffer_load_dwordx4 v14, s[52:55], s45 offen lds
    s_add_u32 s44, s44, 64
    s_add_u32 s45, s45, 40960
    ds_read_b128 v[36:39], v15 offset:8192
    ds_read_b128 v[40:43], v15 offset:9216
    ds_read_b64_tr_b16 v[208:209], v12 offset:8192
    ds_read_b64_tr_b16 v[210:211], v12 offset:8704
    ds_read_b64_tr_b16 v[212:213], v13 offset:8192
    ds_read_b64_tr_b16 v[214:215], v13 offset:8704
    v_mfma_f32_16x16x32_bf16 v[64:67], v[192:195], v[20:23], v[64:67]
    v_mfma_f32_16x16x32_bf16 v[68:71], v[192:195], v[24:27], v[68:71]
    v_mfma_f32_16x16x32_bf16 v[72:75], v[196:199], v[20:23], v[72:75]
    v_mfma_f32_16x16x32_bf16 v[76:79], v[196:199], v[24:27], v[76:79]
    s_waitcnt lgkmcnt(0)
    s_add_u32 s46, s46, 1
    s_cmp_lt_u32 s46, 12
    s_cbranch_scc1 k5a_kernel_loop
    s_waitcnt vmcnt(4)
    s_barrier
    s_add_u32 m0, s42, 24576
    s_nop 0
    buffer_load_dwordx4 v10, s[8:11], s44 offen lds
    s_add_u32 m0, s43, 28672
    s_nop 0
    buffer_load_dwordx4 v14, s[52:55], s45 offen lds
    s_add_u32 s44, s44, 64
    s_add_u32 s45, s45, 40960
    ds_read_b128 v[20:23], v16 offset:0
    ds_read_b128 v[24:27], v16 offset:1024
    ds_read_b64_tr_b16 v[192:193], v18 offset:0
    ds_read_b64_tr_b16 v[194:195], v18 offset:512
    ds_read_b64_tr_b16 v[196:197], v19 offset:0
    ds_read_b64_tr_b16 v[198:199], v19 offset:512
    v_mfma_f32_16x16x32_bf16 v[64:67], v[208:211], v[36:39], v[64:67]
    v_mfma_f32_16x16x32_bf16 v[68:71], v[208:211], v[40:43], v[68:71]
    v_mfma_f32_16x16x32_bf16 v[72:75], v[212:215], v[36:39], v[72:75]
    v_mfma_f32_16x16x32_bf16 v[76:79], v[212:215], v[40:43], v[76:79]
    s_waitcnt lgkmcnt(0)
    s_waitcnt vmcnt(4)
    s_barrier
    s_add_u32 m0, s42, 0
    s_nop 0
    buffer_load_dwordx4 v10, s[8:11], s44 offen lds
    s_add_u32 m0, s43, 4096
    s_nop 0
    buffer_load_dwordx4 v14, s[52:55], s45 offen lds
    s_add_u32 s44, s44, 64
    s_add_u32 s45, s45, 40960
    ds_read_b128 v[36:39], v16 offset:8192
    ds_read_b128 v[40:43], v16 offset:9216
    ds_read_b64_tr_b16 v[208:209], v18 offset:8192
    ds_read_b64_tr_b16 v[210:211], v18 offset:8704
    ds_read_b64_tr_b16 v[212:213], v19 offset:8192
    ds_read_b64_tr_b16 v[214:215], v19 offset:8704
    v_mfma_f32_16x16x32_bf16 v[64:67], v[192:195], v[20:23], v[64:67]
    v_mfma_f32_16x16x32_bf16 v[68:71], v[192:195], v[24:27], v[68:71]
    v_mfma_f32_16x16x32_bf16 v[72:75], v[196:199], v[20:23], v[72:75]
    v_mfma_f32_16x16x32_bf16 v[76:79], v[196:199], v[24:27], v[76:79]
    s_waitcnt lgkmcnt(0)
    s_waitcnt vmcnt(4)
    s_barrier
    s_add_u32 m0, s42, 8192
    s_nop 0
    buffer_load_dwordx4 v10, s[8:11], s44 offen lds
    s_add_u32 m0, s43, 12288
    s_nop 0
    buffer_load_dwordx4 v14, s[52:55], s45 offen lds
    s_add_u32 s44, s44, 64
    s_add_u32 s45, s45, 40960
    ds_read_b128 v[20:23], v15 offset:0
    ds_read_b128 v[24:27], v15 offset:1024
    ds_read_b64_tr_b16 v[192:193], v12 offset:0
    ds_read_b64_tr_b16 v[194:195], v12 offset:512
    ds_read_b64_tr_b16 v[196:197], v13 offset:0
    ds_read_b64_tr_b16 v[198:199], v13 offset:512
    v_mfma_f32_16x16x32_bf16 v[64:67], v[208:211], v[36:39], v[64:67]
    v_mfma_f32_16x16x32_bf16 v[68:71], v[208:211], v[40:43], v[68:71]
    v_mfma_f32_16x16x32_bf16 v[72:75], v[212:215], v[36:39], v[72:75]
    v_mfma_f32_16x16x32_bf16 v[76:79], v[212:215], v[40:43], v[76:79]
    s_waitcnt lgkmcnt(0)
    s_waitcnt vmcnt(4)
    s_barrier
    ds_read_b128 v[36:39], v15 offset:8192
    ds_read_b128 v[40:43], v15 offset:9216
    ds_read_b64_tr_b16 v[208:209], v12 offset:8192
    ds_read_b64_tr_b16 v[210:211], v12 offset:8704
    ds_read_b64_tr_b16 v[212:213], v13 offset:8192
    ds_read_b64_tr_b16 v[214:215], v13 offset:8704
    v_mfma_f32_16x16x32_bf16 v[64:67], v[192:195], v[20:23], v[64:67]
    v_mfma_f32_16x16x32_bf16 v[68:71], v[192:195], v[24:27], v[68:71]
    v_mfma_f32_16x16x32_bf16 v[72:75], v[196:199], v[20:23], v[72:75]
    v_mfma_f32_16x16x32_bf16 v[76:79], v[196:199], v[24:27], v[76:79]
    s_waitcnt lgkmcnt(0)
    s_waitcnt vmcnt(2)
    s_barrier
    ds_read_b128 v[20:23], v16 offset:0
    ds_read_b128 v[24:27], v16 offset:1024
    ds_read_b64_tr_b16 v[192:193], v18 offset:0
    ds_read_b64_tr_b16 v[194:195], v18 offset:512
    ds_read_b64_tr_b16 v[196:197], v19 offset:0
    ds_read_b64_tr_b16 v[198:199], v19 offset:512
    v_mfma_f32_16x16x32_bf16 v[64:67], v[208:211], v[36:39], v[64:67]
    v_mfma_f32_16x16x32_bf16 v[68:71], v[208:211], v[40:43], v[68:71]
    v_mfma_f32_16x16x32_bf16 v[72:75], v[212:215], v[36:39], v[72:75]
    v_mfma_f32_16x16x32_bf16 v[76:79], v[212:215], v[40:43], v[76:79]
    s_waitcnt lgkmcnt(0)
    s_waitcnt vmcnt(0)
    s_barrier
    ds_read_b128 v[36:39], v16 offset:8192
    ds_read_b128 v[40:43], v16 offset:9216
    ds_read_b64_tr_b16 v[208:209], v18 offset:8192
    ds_read_b64_tr_b16 v[210:211], v18 offset:8704
    ds_read_b64_tr_b16 v[212:213], v19 offset:8192
    ds_read_b64_tr_b16 v[214:215], v19 offset:8704
    v_mfma_f32_16x16x32_bf16 v[64:67], v[192:195], v[20:23], v[64:67]
    v_mfma_f32_16x16x32_bf16 v[68:71], v[192:195], v[24:27], v[68:71]
    v_mfma_f32_16x16x32_bf16 v[72:75], v[196:199], v[20:23], v[72:75]
    v_mfma_f32_16x16x32_bf16 v[76:79], v[196:199], v[24:27], v[76:79]
    s_waitcnt lgkmcnt(0)
    v_mfma_f32_16x16x32_bf16 v[64:67], v[208:211], v[36:39], v[64:67]
    v_mfma_f32_16x16x32_bf16 v[68:71], v[208:211], v[40:43], v[68:71]
    v_mfma_f32_16x16x32_bf16 v[72:75], v[212:215], v[36:39], v[72:75]
    v_mfma_f32_16x16x32_bf16 v[76:79], v[212:215], v[40:43], v[76:79]
    s_nop 9
    s_lshr_b32 s21, s20, 1
    s_mul_i32 s21, s21, 32
    s_lshl_b32 s22, s40, 6
    s_add_u32 s21, s21, s22
    v_add_u32 v5, s21, v3
    v_mul_u32_u24 v5, 1280, v5
    s_and_b32 s21, s20, 1
    s_lshl_b32 s21, s21, 6
    s_mul_i32 s22, s41, 128
    s_add_u32 s21, s21, s22
    v_lshlrev_b32 v6, 3, v4
    v_add_u32 v5, v5, v6
    v_add_u32 v5, s21, v5
    v_add_u32 v6, 0, v5
    buffer_load_dwordx2 v[20:21], v6, s[24:27], 0 offen
    v_add_u32 v6, 20480, v5
    buffer_load_dwordx2 v[22:23], v6, s[24:27], 0 offen
    v_add_u32 v6, 32, v5
    buffer_load_dwordx2 v[24:25], v6, s[24:27], 0 offen
    v_add_u32 v6, 20512, v5
    buffer_load_dwordx2 v[26:27], v6, s[24:27], 0 offen
    s_waitcnt vmcnt(0)
    v_cvt_pk_bf16_f32 v7, v64, v64
    v_lshlrev_b32 v64, 16, v7
    v_lshlrev_b32 v8, 16, v20
    v_add_f32 v64, v64, v8
    v_cvt_pk_bf16_f32 v7, v65, v65
    v_lshlrev_b32 v65, 16, v7
    v_and_b32 v8, 0xffff0000, v20
    v_add_f32 v65, v65, v8
    v_cvt_pk_bf16_f32 v7, v66, v66
    v_lshlrev_b32 v66, 16, v7
    v_lshlrev_b32 v8, 16, v21
    v_add_f32 v66, v66, v8
    v_cvt_pk_bf16_f32 v7, v67, v67
    v_lshlrev_b32 v67, 16, v7
    v_and_b32 v8, 0xffff0000, v21
    v_add_f32 v67, v67, v8
    v_cvt_pk_bf16_f32 v64, v64, v65
    v_cvt_pk_bf16_f32 v65, v66, v67
    v_add_u32 v6, 0, v5
    buffer_store_dwordx2 v[64:65], v6, s[28:31], 0 offen
    v_cvt_pk_bf16_f32 v7, v68, v68
    v_lshlrev_b32 v68, 16, v7
    v_lshlrev_b32 v8, 16, v22
    v_add_f32 v68, v68, v8
    v_cvt_pk_bf16_f32 v7, v69, v69
    v_lshlrev_b32 v69, 16, v7
    v_and_b32 v8, 0xffff0000, v22
    v_add_f32 v69, v69, v8
    v_cvt_pk_bf16_f32 v7, v70, v70
    v_lshlrev_b32 v70, 16, v7
    v_lshlrev_b32 v8, 16, v23
    v_add_f32 v70, v70, v8
    v_cvt_pk_bf16_f32 v7, v71, v71
    v_lshlrev_b32 v71, 16, v7
    v_and_b32 v8, 0xffff0000, v23
    v_add_f32 v71, v71, v8
    v_cvt_pk_bf16_f32 v68, v68, v69
    v_cvt_pk_bf16_f32 v69, v70, v71
    v_add_u32 v6, 20480, v5
    buffer_store_dwordx2 v[68:69], v6, s[28:31], 0 offen
    v_cvt_pk_bf16_f32 v7, v72, v72
    v_lshlrev_b32 v72, 16, v7
    v_lshlrev_b32 v8, 16, v24
    v_add_f32 v72, v72, v8
    v_cvt_pk_bf16_f32 v7, v73, v73
    v_lshlrev_b32 v73, 16, v7
    v_and_b32 v8, 0xffff0000, v24
    v_add_f32 v73, v73, v8
    v_cvt_pk_bf16_f32 v7, v74, v74
    v_lshlrev_b32 v74, 16, v7
    v_lshlrev_b32 v8, 16, v25
    v_add_f32 v74, v74, v8
    v_cvt_pk_bf16_f32 v7, v75, v75
    v_lshlrev_b32 v75, 16, v7
    v_and_b32 v8, 0xffff0000, v25
    v_add_f32 v75, v75, v8
    v_cvt_pk_bf16_f32 v72, v72, v73
    v_cvt_pk_bf16_f32 v73, v74, v75
    v_add_u32 v6, 32, v5
    buffer_store_dwordx2 v[72:73], v6, s[28:31], 0 offen
    v_cvt_pk_bf16_f32 v7, v76, v76
    v_lshlrev_b32 v76, 16, v7
    v_lshlrev_b32 v8, 16, v26
    v_add_f32 v76, v76, v8
    v_cvt_pk_bf16_f32 v7, v77, v77
    v_lshlrev_b32 v77, 16, v7
    v_and_b32 v8, 0xffff0000, v26
    v_add_f32 v77, v77, v8
    v_cvt_pk_bf16_f32 v7, v78, v78
    v_lshlrev_b32 v78, 16, v7
    v_lshlrev_b32 v8, 16, v27
    v_add_f32 v78, v78, v8
    v_cvt_pk_bf16_f32 v7, v79, v79
    v_lshlrev_b32 v79, 16, v7
    v_and_b32 v8, 0xffff0000, v27
    v_add_f32 v79, v79, v8
    v_cvt_pk_bf16_f32 v76, v76, v77
    v_cvt_pk_bf16_f32 v77, v78, v79
    v_add_u32 v6, 20512, v5
    buffer_store_dwordx2 v[76:77], v6, s[28:31], 0 offen
k5a_kernel_end:
    s_endpgm
.globl k1b_kernel
.p2align 8
.type k1b_kernel,@function
k1b_kernel:
    s_cmp_ge_u32 s2, 256
    s_cbranch_scc1 k1b_kernel_end
    s_load_dwordx2 s[4:5], s[0:1], 72
    s_load_dwordx2 s[6:7], s[0:1], 72
    v_lshrrev_b32 v1, 6, v0
    s_nop 0
    v_readfirstlane_b32 s20, v1
    v_and_b32 v2, 63, v0
    s_waitcnt lgkmcnt(0)
    s_add_u32 s4, s4, 0x1800000
    s_addc_u32 s5, s5, 0
    s_mov_b32 s8, s4
    s_and_b32 s9, s5, 0xffff
    s_mov_b32 s10, 0x280000
    s_mov_b32 s11, 0x00020000
    s_mov_b32 s12, s6
    s_and_b32 s13, s7, 0xffff
    s_mov_b32 s14, 0x504000
    s_mov_b32 s15, 0x00020000
    s_cmp_ge_u32 s20, 4
    s_cbranch_scc1 k1b_kernel_p2
    s_mul_i32 s21, s2, 10240
    s_mul_i32 s22, s20, 2560
    s_add_u32 s21, s21, s22
    v_lshlrev_b32 v3, 1, v2
    buffer_load_ushort v4, v3, s[8:11], s21 offen offset:0
    buffer_load_ushort v14, v3, s[8:11], s21 offen offset:1280
    buffer_load_ushort v5, v3, s[8:11], s21 offen offset:128
    buffer_load_ushort v15, v3, s[8:11], s21 offen offset:1408
    buffer_load_ushort v6, v3, s[8:11], s21 offen offset:256
    buffer_load_ushort v16, v3, s[8:11], s21 offen offset:1536
    buffer_load_ushort v7, v3, s[8:11], s21 offen offset:384
    buffer_load_ushort v17, v3, s[8:11], s21 offen offset:1664
    buffer_load_ushort v8, v3, s[8:11], s21 offen offset:512
    buffer_load_ushort v18, v3, s[8:11], s21 offen offset:1792
    buffer_load_ushort v9, v3, s[8:11], s21 offen offset:640
    buffer_load_ushort v19, v3, s[8:11], s21 offen offset:1920
    buffer_load_ushort v10, v3, s[8:11], s21 offen offset:768
    buffer_load_ushort v20, v3, s[8:11], s21 offen offset:2048
    buffer_load_ushort v11, v3, s[8:11], s21 offen offset:896
    buffer_load_ushort v21, v3, s[8:11], s21 offen offset:2176
    buffer_load_ushort v12, v3, s[8:11], s21 offen offset:1024
    buffer_load_ushort v22, v3, s[8:11], s21 offen offset:2304
    buffer_load_ushort v13, v3, s[8:11], s21 offen offset:1152
    buffer_load_ushort v23, v3, s[8:11], s21 offen offset:2432
    s_waitcnt vmcnt(0)
    v_lshlrev_b32 v4, 16, v4
    v_lshlrev_b32 v5, 16, v5
    v_lshlrev_b32 v6, 16, v6
    v_lshlrev_b32 v7, 16, v7
    v_lshlrev_b32 v8, 16, v8
    v_lshlrev_b32 v9, 16, v9
    v_lshlrev_b32 v10, 16, v10
    v_lshlrev_b32 v11, 16, v11
    v_lshlrev_b32 v12, 16, v12
    v_lshlrev_b32 v13, 16, v13
    v_lshlrev_b32 v14, 16, v14
    v_lshlrev_b32 v15, 16, v15
    v_lshlrev_b32 v16, 16, v16
    v_lshlrev_b32 v17, 16, v17
    v_lshlrev_b32 v18, 16, v18
    v_lshlrev_b32 v19, 16, v19
    v_lshlrev_b32 v20, 16, v20
    v_lshlrev_b32 v21, 16, v21
    v_lshlrev_b32 v22, 16, v22
    v_lshlrev_b32 v23, 16, v23
    v_add_f32 v24, v4, v5
    v_add_f32 v24, v24, v6
    v_add_f32 v24, v24, v7
    v_add_f32 v24, v24, v8
    v_add_f32 v24, v24, v9
    v_add_f32 v24, v24, v10
    v_add_f32 v24, v24, v11
    v_add_f32 v24, v24, v12
    v_add_f32 v24, v24, v13
    v_add_f32 v25, v14, v15
    v_add_f32 v25, v25, v16
    v_add_f32 v25, v25, v17
    v_add_f32 v25, v25, v18
    v_add_f32 v25, v25, v19
    v_add_f32 v25, v25, v20
    v_add_f32 v25, v25, v21
    v_add_f32 v25, v25, v22
    v_add_f32 v25, v25, v23
    v_add_f32_dpp v24, v24, v24 quad_perm:[1,0,3,2] row_mask:0xf bank_mask:0xf
    s_nop 0
    v_add_f32_dpp v25, v25, v25 quad_perm:[1,0,3,2] row_mask:0xf bank_mask:0xf
    v_add_f32_dpp v24, v24, v24 quad_perm:[2,3,0,1] row_mask:0xf bank_mask:0xf
    s_nop 0
    v_add_f32_dpp v25, v25, v25 quad_perm:[2,3,0,1] row_mask:0xf bank_mask:0xf
    v_add_f32_dpp v24, v24, v24 row_ror:4 row_mask:0xf bank_mask:0xf
    s_nop 0
    v_add_f32_dpp v25, v25, v25 row_ror:4 row_mask:0xf bank_mask:0xf
    v_add_f32_dpp v24, v24, v24 row_ror:8 row_mask:0xf bank_mask:0xf
    s_nop 0
    v_add_f32_dpp v25, v25, v25 row_ror:8 row_mask:0xf bank_mask:0xf
    v_mov_b32 v26, v24
    v_mov_b32 v27, v25
    s_nop 0
    v_permlane16_swap_b32 v26, v24
    v_permlane16_swap_b32 v27, v25
    v_add_f32 v24, v24, v26
    v_add_f32 v25, v25, v27
    v_mov_b32 v26, v24
    v_mov_b32 v27, v25
    s_nop 0
    v_permlane32_swap_b32 v26, v24
    v_permlane32_swap_b32 v27, v25
    v_add_f32 v24, v24, v26
    v_add_f32 v25, v25, v27
    v_mul_f32 v24, 0x3acccccd, v24
    v_sub_f32 v30, v4, v24
    v_mul_f32 v28, v30, v30
    v_sub_f32 v30, v5, v24
    v_fmac_f32 v28, v30, v30
    v_sub_f32 v30, v6, v24
    v_fmac_f32 v28, v30, v30
    v_sub_f32 v30, v7, v24
    v_fmac_f32 v28, v30, v30
    v_sub_f32 v30, v8, v24
    v_fmac_f32 v28, v30, v30
    v_sub_f32 v30, v9, v24
    v_fmac_f32 v28, v30, v30
    v_sub_f32 v30, v10, v24
    v_fmac_f32 v28, v30, v30
    v_sub_f32 v30, v11, v24
    v_fmac_f32 v28, v30, v30
    v_sub_f32 v30, v12, v24
    v_fmac_f32 v28, v30, v30
    v_sub_f32 v30, v13, v24
    v_fmac_f32 v28, v30, v30
    v_mul_f32 v25, 0x3acccccd, v25
    v_sub_f32 v30, v14, v25
    v_mul_f32 v29, v30, v30
    v_sub_f32 v30, v15, v25
    v_fmac_f32 v29, v30, v30
    v_sub_f32 v30, v16, v25
    v_fmac_f32 v29, v30, v30
    v_sub_f32 v30, v17, v25
    v_fmac_f32 v29, v30, v30
    v_sub_f32 v30, v18, v25
    v_fmac_f32 v29, v30, v30
    v_sub_f32 v30, v19, v25
    v_fmac_f32 v29, v30, v30
    v_sub_f32 v30, v20, v25
    v_fmac_f32 v29, v30, v30
    v_sub_f32 v30, v21, v25
    v_fmac_f32 v29, v30, v30
    v_sub_f32 v30, v22, v25
    v_fmac_f32 v29, v30, v30
    v_sub_f32 v30, v23, v25
    v_fmac_f32 v29, v30, v30
    v_add_f32_dpp v28, v28, v28 quad_perm:[1,0,3,2] row_mask:0xf bank_mask:0xf
    s_nop 0
    v_add_f32_dpp v29, v29, v29 quad_perm:[1,0,3,2] row_mask:0xf bank_mask:0xf
    v_add_f32_dpp v28, v28, v28 quad_perm:[2,3,0,1] row_mask:0xf bank_mask:0xf
    s_nop 0
    v_add_f32_dpp v29, v29, v29 quad_perm:[2,3,0,1] row_mask:0xf bank_mask:0xf
    v_add_f32_dpp v28, v28, v28 row_ror:4 row_mask:0xf bank_mask:0xf
    s_nop 0
    v_add_f32_dpp v29, v29, v29 row_ror:4 row_mask:0xf bank_mask:0xf
    v_add_f32_dpp v28, v28, v28 row_ror:8 row_mask:0xf bank_mask:0xf
    s_nop 0
    v_add_f32_dpp v29, v29, v29 row_ror:8 row_mask:0xf bank_mask:0xf
    v_mov_b32 v26, v28
    v_mov_b32 v27, v29
    s_nop 0
    v_permlane16_swap_b32 v26, v28
    v_permlane16_swap_b32 v27, v29
    v_add_f32 v28, v28, v26
    v_add_f32 v29, v29, v27
    v_mov_b32 v26, v28
    v_mov_b32 v27, v29
    s_nop 0
    v_permlane32_swap_b32 v26, v28
    v_permlane32_swap_b32 v27, v29
    v_add_f32 v28, v28, v26
    v_add_f32 v29, v29, v27
    v_mul_f32 v28, 0x3acccccd, v28
    v_cvt_pk_bf16_f32 v30, v28, v28
    v_lshlrev_b32 v28, 16, v30
    v_add_f32 v28, 0x3727c5ac, v28
    v_cvt_pk_bf16_f32 v30, v28, v28
    v_lshlrev_b32 v28, 16, v30
    v_sqrt_f32 v28, v28
    s_nop 0
    v_cvt_pk_bf16_f32 v30, v28, v28
    v_lshlrev_b32 v28, 16, v30
    v_rcp_f32 v28, v28
    v_cvt_pk_bf16_f32 v30, v24, v24
    v_lshlrev_b32 v24, 16, v30
    v_sub_f32 v4, v4, v24
    v_cvt_pk_bf16_f32 v30, v4, v4
    v_lshlrev_b32 v4, 16, v30
    v_mul_f32 v4, v4, v28
    v_cvt_pk_bf16_f32 v30, v4, v4
    v_lshlrev_b32 v4, 16, v30
    v_sub_f32 v5, v5, v24
    v_cvt_pk_bf16_f32 v30, v5, v5
    v_lshlrev_b32 v5, 16, v30
    v_mul_f32 v5, v5, v28
    v_cvt_pk_bf16_f32 v30, v5, v5
    v_lshlrev_b32 v5, 16, v30
    v_sub_f32 v6, v6, v24
    v_cvt_pk_bf16_f32 v30, v6, v6
    v_lshlrev_b32 v6, 16, v30
    v_mul_f32 v6, v6, v28
    v_cvt_pk_bf16_f32 v30, v6, v6
    v_lshlrev_b32 v6, 16, v30
    v_sub_f32 v7, v7, v24
    v_cvt_pk_bf16_f32 v30, v7, v7
    v_lshlrev_b32 v7, 16, v30
    v_mul_f32 v7, v7, v28
    v_cvt_pk_bf16_f32 v30, v7, v7
    v_lshlrev_b32 v7, 16, v30
    v_sub_f32 v8, v8, v24
    v_cvt_pk_bf16_f32 v30, v8, v8
    v_lshlrev_b32 v8, 16, v30
    v_mul_f32 v8, v8, v28
    v_cvt_pk_bf16_f32 v30, v8, v8
    v_lshlrev_b32 v8, 16, v30
    v_sub_f32 v9, v9, v24
    v_cvt_pk_bf16_f32 v30, v9, v9
    v_lshlrev_b32 v9, 16, v30
    v_mul_f32 v9, v9, v28
    v_cvt_pk_bf16_f32 v30, v9, v9
    v_lshlrev_b32 v9, 16, v30
    v_sub_f32 v10, v10, v24
    v_cvt_pk_bf16_f32 v30, v10, v10
    v_lshlrev_b32 v10, 16, v30
    v_mul_f32 v10, v10, v28
    v_cvt_pk_bf16_f32 v30, v10, v10
    v_lshlrev_b32 v10, 16, v30
    v_sub_f32 v11, v11, v24
    v_cvt_pk_bf16_f32 v30, v11, v11
    v_lshlrev_b32 v11, 16, v30
    v_mul_f32 v11, v11, v28
    v_cvt_pk_bf16_f32 v30, v11, v11
    v_lshlrev_b32 v11, 16, v30
    v_sub_f32 v12, v12, v24
    v_cvt_pk_bf16_f32 v30, v12, v12
    v_lshlrev_b32 v12, 16, v30
    v_mul_f32 v12, v12, v28
    v_cvt_pk_bf16_f32 v30, v12, v12
    v_lshlrev_b32 v12, 16, v30
    v_sub_f32 v13, v13, v24
    v_cvt_pk_bf16_f32 v30, v13, v13
    v_lshlrev_b32 v13, 16, v30
    v_mul_f32 v13, v13, v28
    v_cvt_pk_bf16_f32 v30, v13, v13
    v_lshlrev_b32 v13, 16, v30
    v_mul_f32 v29, 0x3acccccd, v29
    v_cvt_pk_bf16_f32 v30, v29, v29
    v_lshlrev_b32 v29, 16, v30
    v_add_f32 v29, 0x3727c5ac, v29
    v_cvt_pk_bf16_f32 v30, v29, v29
    v_lshlrev_b32 v29, 16, v30
    v_sqrt_f32 v29, v29
    s_nop 0
    v_cvt_pk_bf16_f32 v30, v29, v29
    v_lshlrev_b32 v29, 16, v30
    v_rcp_f32 v29, v29
    v_cvt_pk_bf16_f32 v30, v25, v25
    v_lshlrev_b32 v25, 16, v30
    v_sub_f32 v14, v14, v25
    v_cvt_pk_bf16_f32 v30, v14, v14
    v_lshlrev_b32 v14, 16, v30
    v_mul_f32 v14, v14, v29
    v_cvt_pk_bf16_f32 v30, v14, v14
    v_lshlrev_b32 v14, 16, v30
    v_sub_f32 v15, v15, v25
    v_cvt_pk_bf16_f32 v30, v15, v15
    v_lshlrev_b32 v15, 16, v30
    v_mul_f32 v15, v15, v29
    v_cvt_pk_bf16_f32 v30, v15, v15
    v_lshlrev_b32 v15, 16, v30
    v_sub_f32 v16, v16, v25
    v_cvt_pk_bf16_f32 v30, v16, v16
    v_lshlrev_b32 v16, 16, v30
    v_mul_f32 v16, v16, v29
    v_cvt_pk_bf16_f32 v30, v16, v16
    v_lshlrev_b32 v16, 16, v30
    v_sub_f32 v17, v17, v25
    v_cvt_pk_bf16_f32 v30, v17, v17
    v_lshlrev_b32 v17, 16, v30
    v_mul_f32 v17, v17, v29
    v_cvt_pk_bf16_f32 v30, v17, v17
    v_lshlrev_b32 v17, 16, v30
    v_sub_f32 v18, v18, v25
    v_cvt_pk_bf16_f32 v30, v18, v18
    v_lshlrev_b32 v18, 16, v30
    v_mul_f32 v18, v18, v29
    v_cvt_pk_bf16_f32 v30, v18, v18
    v_lshlrev_b32 v18, 16, v30
    v_sub_f32 v19, v19, v25
    v_cvt_pk_bf16_f32 v30, v19, v19
    v_lshlrev_b32 v19, 16, v30
    v_mul_f32 v19, v19, v29
    v_cvt_pk_bf16_f32 v30, v19, v19
    v_lshlrev_b32 v19, 16, v30
    v_sub_f32 v20, v20, v25
    v_cvt_pk_bf16_f32 v30, v20, v20
    v_lshlrev_b32 v20, 16, v30
    v_mul_f32 v20, v20, v29
    v_cvt_pk_bf16_f32 v30, v20, v20
    v_lshlrev_b32 v20, 16, v30
    v_sub_f32 v21, v21, v25
    v_cvt_pk_bf16_f32 v30, v21, v21
    v_lshlrev_b32 v21, 16, v30
    v_mul_f32 v21, v21, v29
    v_cvt_pk_bf16_f32 v30, v21, v21
    v_lshlrev_b32 v21, 16, v30
    v_sub_f32 v22, v22, v25
    v_cvt_pk_bf16_f32 v30, v22, v22
    v_lshlrev_b32 v22, 16, v30
    v_mul_f32 v22, v22, v29
    v_cvt_pk_bf16_f32 v30, v22, v22
    v_lshlrev_b32 v22, 16, v30
    v_sub_f32 v23, v23, v25
    v_cvt_pk_bf16_f32 v30, v23, v23
    v_lshlrev_b32 v23, 16, v30
    v_mul_f32 v23, v23, v29
    v_cvt_pk_bf16_f32 v30, v23, v23
    v_lshlrev_b32 v23, 16, v30
    v_add_f32 v24, v6, v12
    v_add_f32 v25, v16, v22
    v_add_f32 v26, v6, -v12
    v_add_f32 v27, v16, -v22
    v_add_f32 v28, v8, v10
    v_add_f32 v29, v18, v20
    v_add_f32 v30, v8, -v10
    v_add_f32 v31, v18, -v20
    v_mov_b32 v6, v4
    v_fmac_f32 v6, 0x3e9e377a, v24
    v_fmac_f32 v6, 0xbf4f1bbd, v28
    v_mov_b32 v8, v14
    v_fmac_f32 v8, 0x3e9e377a, v25
    v_fmac_f32 v8, 0xbf4f1bbd, v29
    v_mov_b32 v10, v4
    v_fmac_f32 v10, 0xbf4f1bbd, v24
    v_fmac_f32 v10, 0x3e9e377a, v28
    v_mov_b32 v12, v14
    v_fmac_f32 v12, 0xbf4f1bbd, v25
    v_fmac_f32 v12, 0x3e9e377a, v29
    v_mul_f32 v16, 0x3f737871, v26
    v_fmac_f32 v16, 0x3f167918, v30
    v_mul_f32 v18, 0x3f737871, v27
    v_fmac_f32 v18, 0x3f167918, v31
    v_mul_f32 v20, 0x3f167918, v26
    v_fmac_f32 v20, 0xbf737871, v30
    v_mul_f32 v22, 0x3f167918, v27
    v_fmac_f32 v22, 0xbf737871, v31
    v_add_f32 v32, v24, v28
    v_add_f32 v33, v25, v29
    v_add_f32 v34, v4, v32
    v_add_f32 v35, v14, v33
    v_add_f32 v4, v6, v18
    v_add_f32 v14, v8, -v16
    v_add_f32 v24, v6, -v18
    v_add_f32 v25, v8, v16
    v_add_f32 v26, v10, v22
    v_add_f32 v27, v12, -v20
    v_add_f32 v28, v10, -v22
    v_add_f32 v29, v12, v20
    v_add_f32 v6, v7, v13
    v_add_f32 v8, v17, v23
    v_add_f32 v10, v7, -v13
    v_add_f32 v12, v17, -v23
    v_add_f32 v16, v9, v11
    v_add_f32 v18, v19, v21
    v_add_f32 v20, v9, -v11
    v_add_f32 v22, v19, -v21
    v_mov_b32 v7, v5
    v_fmac_f32 v7, 0x3e9e377a, v6
    v_fmac_f32 v7, 0xbf4f1bbd, v16
    v_mov_b32 v9, v15
    v_fmac_f32 v9, 0x3e9e377a, v8
    v_fmac_f32 v9, 0xbf4f1bbd, v18
    v_mov_b32 v11, v5
    v_fmac_f32 v11, 0xbf4f1bbd, v6
    v_fmac_f32 v11, 0x3e9e377a, v16
    v_mov_b32 v13, v15
    v_fmac_f32 v13, 0xbf4f1bbd, v8
    v_fmac_f32 v13, 0x3e9e377a, v18
    v_mul_f32 v17, 0x3f737871, v10
    v_fmac_f32 v17, 0x3f167918, v20
    v_mul_f32 v19, 0x3f737871, v12
    v_fmac_f32 v19, 0x3f167918, v22
    v_mul_f32 v21, 0x3f167918, v10
    v_fmac_f32 v21, 0xbf737871, v20
    v_mul_f32 v23, 0x3f167918, v12
    v_fmac_f32 v23, 0xbf737871, v22
    v_add_f32 v30, v6, v16
    v_add_f32 v31, v8, v18
    v_add_f32 v32, v5, v30
    v_add_f32 v33, v15, v31
    v_add_f32 v5, v7, v19
    v_add_f32 v6, v9, -v17
    v_add_f32 v8, v7, -v19
    v_add_f32 v10, v9, v17
    v_add_f32 v12, v11, v23
    v_add_f32 v15, v13, -v21
    v_add_f32 v16, v11, -v23
    v_add_f32 v18, v13, v21
    v_add_f32 v7, v34, -v32
    v_add_f32 v9, v35, -v33
    v_add_f32 v34, v34, v32
    v_add_f32 v35, v35, v33
    v_mul_f32 v11, 0x3f4f1bbd, v5
    v_mul_f32 v13, 0xbf167918, v5
    v_fmac_f32 v11, 0x3f167918, v6
    v_fmac_f32 v13, 0x3f4f1bbd, v6
    v_add_f32 v5, v4, -v11
    v_add_f32 v6, v14, -v13
    v_add_f32 v4, v4, v11
    v_add_f32 v14, v14, v13
    v_mul_f32 v11, 0x3e9e377a, v12
    v_mul_f32 v13, 0xbf737871, v12
    v_fmac_f32 v11, 0x3f737871, v15
    v_fmac_f32 v13, 0x3e9e377a, v15
    v_add_f32 v12, v26, -v11
    v_add_f32 v15, v27, -v13
    v_add_f32 v26, v26, v11
    v_add_f32 v27, v27, v13
    v_mul_f32 v11, 0xbe9e377a, v16
    v_mul_f32 v13, 0xbf737871, v16
    v_fmac_f32 v11, 0x3f737871, v18
    v_fmac_f32 v13, 0xbe9e377a, v18
    v_add_f32 v16, v28, -v11
    v_add_f32 v17, v29, -v13
    v_add_f32 v28, v28, v11
    v_add_f32 v29, v29, v13
    v_mul_f32 v11, 0xbf4f1bbd, v8
    v_mul_f32 v13, 0xbf167918, v8
    v_fmac_f32 v11, 0x3f167918, v10
    v_fmac_f32 v13, 0xbf4f1bbd, v10
    v_add_f32 v8, v24, -v11
    v_add_f32 v10, v25, -v13
    v_add_f32 v24, v24, v11
    v_add_f32 v25, v25, v13
    v_mul_u32_u24 v11, 80, v2
    s_mul_i32 s22, s20, 5120
    v_add_u32 v11, s22, v11
    ds_write_b64 v11, v[34:35] offset:0
    v_mov_b32 v18, v4
    v_mov_b32 v19, v14
    ds_write_b64 v11, v[18:19] offset:8
    ds_write_b64 v11, v[26:27] offset:16
    ds_write_b64 v11, v[28:29] offset:24
    ds_write_b64 v11, v[24:25] offset:32
    v_mov_b32 v18, v7
    v_mov_b32 v19, v9
    ds_write_b64 v11, v[18:19] offset:40
    v_mov_b32 v18, v5
    v_mov_b32 v19, v6
    ds_write_b64 v11, v[18:19] offset:48
    v_mov_b32 v4, v12
    v_mov_b32 v5, v15
    ds_write_b64 v11, v[4:5] offset:56
    ds_write_b64 v11, v[16:17] offset:64
    v_mov_b32 v4, v8
    v_mov_b32 v5, v10
    ds_write_b64 v11, v[4:5] offset:72
k1b_kernel_p2:
    v_mul_u32_u24 v4, 205, v0
    v_lshrrev_b32 v4, 14, v4
    v_mul_u32_u24 v5, 80, v4
    v_sub_u32 v5, v0, v5
    v_mul_u32_u24 v6, 205, v5
    v_lshrrev_b32 v6, 11, v6
    v_mul_u32_u24 v7, 10, v6
    v_sub_u32 v7, v5, v7
    v_mul_u32_u24 v4, 5120, v4
    v_lshlrev_b32 v8, 3, v5
    v_add_u32 v8, v8, v4
    v_mul_u32_u24 v9, 80, v6
    v_add_u32 v9, v9, v7
    v_lshlrev_b32 v9, 3, v9
    v_add_u32 v9, v9, v4
    v_cvt_f32_u32 v11, v7
    v_cvt_f32_u32 v12, v5
    s_waitcnt lgkmcnt(0)
    s_barrier
    ds_read_b64 v[14:15], v8 offset:0
    ds_read_b64 v[16:17], v8 offset:640
    ds_read_b64 v[18:19], v8 offset:1280
    ds_read_b64 v[20:21], v8 offset:1920
    ds_read_b64 v[22:23], v8 offset:2560
    ds_read_b64 v[24:25], v8 offset:3200
    ds_read_b64 v[26:27], v8 offset:3840
    ds_read_b64 v[28:29], v8 offset:4480
    s_waitcnt lgkmcnt(0)
    v_mul_f32 v13, 0xbc4ccccd, v11
    v_cos_f32 v30, v13
    v_sin_f32 v31, v13
    v_mul_f32 v13, v16, v30
    v_mul_f32 v32, v16, v31
    v_fma_f32 v13, -v17, v31, v13
    v_fma_f32 v32, v17, v30, v32
    v_mul_f32 v16, 0xbccccccd, v11
    v_cos_f32 v17, v16
    v_sin_f32 v30, v16
    v_mul_f32 v16, v18, v17
    v_mul_f32 v31, v18, v30
    v_fma_f32 v16, -v19, v30, v16
    v_fma_f32 v31, v19, v17, v31
    v_mul_f32 v17, 0xbd19999a, v11
    v_cos_f32 v18, v17
    v_sin_f32 v19, v17
    v_mul_f32 v17, v20, v18
    v_mul_f32 v30, v20, v19
    v_fma_f32 v17, -v21, v19, v17
    v_fma_f32 v30, v21, v18, v30
    v_mul_f32 v18, 0xbd4ccccd, v11
    v_cos_f32 v19, v18
    v_sin_f32 v20, v18
    v_mul_f32 v18, v22, v19
    v_mul_f32 v21, v22, v20
    v_fma_f32 v18, -v23, v20, v18
    v_fma_f32 v21, v23, v19, v21
    v_mul_f32 v19, 0xbd800000, v11
    v_cos_f32 v20, v19
    v_sin_f32 v22, v19
    v_mul_f32 v19, v24, v20
    v_mul_f32 v23, v24, v22
    v_fma_f32 v19, -v25, v22, v19
    v_fma_f32 v23, v25, v20, v23
    v_mul_f32 v20, 0xbd99999a, v11
    v_cos_f32 v22, v20
    v_sin_f32 v24, v20
    v_mul_f32 v20, v26, v22
    v_mul_f32 v25, v26, v24
    v_fma_f32 v20, -v27, v24, v20
    v_fma_f32 v25, v27, v22, v25
    v_mul_f32 v22, 0xbdb33333, v11
    v_cos_f32 v24, v22
    v_sin_f32 v26, v22
    v_mul_f32 v22, v28, v24
    v_mul_f32 v27, v28, v26
    v_fma_f32 v22, -v29, v26, v22
    v_fma_f32 v27, v29, v24, v27
    v_add_f32 v24, v14, -v18
    v_add_f32 v26, v15, -v21
    v_add_f32 v14, v14, v18
    v_add_f32 v15, v15, v21
    v_add_f32 v18, v16, -v20
    v_add_f32 v21, v31, -v25
    v_add_f32 v16, v16, v20
    v_add_f32 v31, v31, v25
    v_add_f32 v20, v14, -v16
    v_add_f32 v25, v15, -v31
    v_add_f32 v14, v14, v16
    v_add_f32 v15, v15, v31
    v_add_f32 v16, v24, -v21
    v_add_f32 v28, v26, v18
    v_add_f32 v24, v24, v21
    v_add_f32 v26, v26, -v18
    v_add_f32 v18, v13, -v19
    v_add_f32 v21, v32, -v23
    v_add_f32 v13, v13, v19
    v_add_f32 v32, v32, v23
    v_add_f32 v19, v17, -v22
    v_add_f32 v23, v30, -v27
    v_add_f32 v17, v17, v22
    v_add_f32 v30, v30, v27
    v_add_f32 v22, v13, -v17
    v_add_f32 v27, v32, -v30
    v_add_f32 v13, v13, v17
    v_add_f32 v32, v32, v30
    v_add_f32 v17, v18, -v23
    v_add_f32 v29, v21, v19
    v_add_f32 v18, v18, v23
    v_add_f32 v21, v21, -v19
    v_add_f32 v19, v14, -v13
    v_add_f32 v23, v15, -v32
    v_add_f32 v14, v14, v13
    v_add_f32 v15, v15, v32
    v_mul_f32 v13, 0x3f3504f3, v18
    v_mul_f32 v30, 0xbf3504f3, v18
    v_fmac_f32 v13, 0x3f3504f3, v21
    v_fmac_f32 v30, 0x3f3504f3, v21
    v_add_f32 v18, v24, -v13
    v_add_f32 v21, v26, -v30
    v_add_f32 v24, v24, v13
    v_add_f32 v26, v26, v30
    v_add_f32 v13, v20, -v27
    v_add_f32 v30, v25, v22
    v_add_f32 v20, v20, v27
    v_add_f32 v25, v25, -v22
    v_mul_f32 v22, 0xbf3504f3, v17
    v_mul_f32 v27, 0xbf3504f3, v17
    v_fmac_f32 v22, 0x3f3504f3, v29
    v_fmac_f32 v27, 0xbf3504f3, v29
    v_add_f32 v17, v16, -v22
    v_add_f32 v29, v28, -v27
    v_add_f32 v16, v16, v22
    v_add_f32 v28, v28, v27
    ds_write_b64 v9, v[14:15] offset:20480
    v_mov_b32 v14, v24
    v_mov_b32 v15, v26
    ds_write_b64 v9, v[14:15] offset:20560
    v_mov_b32 v14, v20
    v_mov_b32 v15, v25
    ds_write_b64 v9, v[14:15] offset:20640
    v_mov_b32 v14, v16
    v_mov_b32 v15, v28
    ds_write_b64 v9, v[14:15] offset:20720
    v_mov_b32 v14, v19
    v_mov_b32 v15, v23
    ds_write_b64 v9, v[14:15] offset:20800
    v_mov_b32 v14, v18
    v_mov_b32 v15, v21
    ds_write_b64 v9, v[14:15] offset:20880
    v_mov_b32 v14, v13
    v_mov_b32 v15, v30
    ds_write_b64 v9, v[14:15] offset:20960
    v_mov_b32 v14, v17
    v_mov_b32 v15, v29
    ds_write_b64 v9, v[14:15] offset:21040
    s_waitcnt lgkmcnt(0)
    s_barrier
    ds_read_b64 v[14:15], v8 offset:20480
    ds_read_b64 v[16:17], v8 offset:21120
    ds_read_b64 v[18:19], v8 offset:21760
    ds_read_b64 v[20:21], v8 offset:22400
    ds_read_b64 v[22:23], v8 offset:23040
    ds_read_b64 v[24:25], v8 offset:23680
    ds_read_b64 v[26:27], v8 offset:24320
    ds_read_b64 v[28:29], v8 offset:24960
    s_waitcnt lgkmcnt(0)
    v_mul_f32 v13, 0xbacccccd, v12
    v_cos_f32 v30, v13
    v_sin_f32 v31, v13
    v_mul_f32 v13, v16, v30
    v_mul_f32 v32, v16, v31
    v_fma_f32 v13, -v17, v31, v13
    v_fma_f32 v32, v17, v30, v32
    v_mul_f32 v16, 0xbb4ccccd, v12
    v_cos_f32 v17, v16
    v_sin_f32 v30, v16
    v_mul_f32 v16, v18, v17
    v_mul_f32 v31, v18, v30
    v_fma_f32 v16, -v19, v30, v16
    v_fma_f32 v31, v19, v17, v31
    v_mul_f32 v17, 0xbb99999a, v12
    v_cos_f32 v18, v17
    v_sin_f32 v19, v17
    v_mul_f32 v17, v20, v18
    v_mul_f32 v30, v20, v19
    v_fma_f32 v17, -v21, v19, v17
    v_fma_f32 v30, v21, v18, v30
    v_mul_f32 v18, 0xbbcccccd, v12
    v_cos_f32 v19, v18
    v_sin_f32 v20, v18
    v_mul_f32 v18, v22, v19
    v_mul_f32 v21, v22, v20
    v_fma_f32 v18, -v23, v20, v18
    v_fma_f32 v21, v23, v19, v21
    v_mul_f32 v19, 0xbc000000, v12
    v_cos_f32 v20, v19
    v_sin_f32 v22, v19
    v_mul_f32 v19, v24, v20
    v_mul_f32 v23, v24, v22
    v_fma_f32 v19, -v25, v22, v19
    v_fma_f32 v23, v25, v20, v23
    v_mul_f32 v20, 0xbc19999a, v12
    v_cos_f32 v22, v20
    v_sin_f32 v24, v20
    v_mul_f32 v20, v26, v22
    v_mul_f32 v25, v26, v24
    v_fma_f32 v20, -v27, v24, v20
    v_fma_f32 v25, v27, v22, v25
    v_mul_f32 v22, 0xbc333333, v12
    v_cos_f32 v24, v22
    v_sin_f32 v26, v22
    v_mul_f32 v22, v28, v24
    v_mul_f32 v27, v28, v26
    v_fma_f32 v22, -v29, v26, v22
    v_fma_f32 v27, v29, v24, v27
    v_add_f32 v24, v14, -v18
    v_add_f32 v26, v15, -v21
    v_add_f32 v14, v14, v18
    v_add_f32 v15, v15, v21
    v_add_f32 v18, v16, -v20
    v_add_f32 v21, v31, -v25
    v_add_f32 v16, v16, v20
    v_add_f32 v31, v31, v25
    v_add_f32 v20, v14, -v16
    v_add_f32 v25, v15, -v31
    v_add_f32 v14, v14, v16
    v_add_f32 v15, v15, v31
    v_add_f32 v16, v24, -v21
    v_add_f32 v28, v26, v18
    v_add_f32 v24, v24, v21
    v_add_f32 v26, v26, -v18
    v_add_f32 v18, v13, -v19
    v_add_f32 v21, v32, -v23
    v_add_f32 v13, v13, v19
    v_add_f32 v32, v32, v23
    v_add_f32 v19, v17, -v22
    v_add_f32 v23, v30, -v27
    v_add_f32 v17, v17, v22
    v_add_f32 v30, v30, v27
    v_add_f32 v22, v13, -v17
    v_add_f32 v27, v32, -v30
    v_add_f32 v13, v13, v17
    v_add_f32 v32, v32, v30
    v_add_f32 v17, v18, -v23
    v_add_f32 v29, v21, v19
    v_add_f32 v18, v18, v23
    v_add_f32 v21, v21, -v19
    v_add_f32 v19, v14, -v13
    v_add_f32 v23, v15, -v32
    v_add_f32 v14, v14, v13
    v_add_f32 v15, v15, v32
    v_mul_f32 v13, 0x3f3504f3, v18
    v_mul_f32 v30, 0xbf3504f3, v18
    v_fmac_f32 v13, 0x3f3504f3, v21
    v_fmac_f32 v30, 0x3f3504f3, v21
    v_add_f32 v18, v24, -v13
    v_add_f32 v21, v26, -v30
    v_add_f32 v24, v24, v13
    v_add_f32 v26, v26, v30
    v_add_f32 v13, v20, -v27
    v_add_f32 v30, v25, v22
    v_add_f32 v20, v20, v27
    v_add_f32 v25, v25, -v22
    v_mul_f32 v22, 0xbf3504f3, v17
    v_mul_f32 v27, 0xbf3504f3, v17
    v_fmac_f32 v22, 0x3f3504f3, v29
    v_fmac_f32 v27, 0xbf3504f3, v29
    v_add_f32 v17, v16, -v22
    v_add_f32 v29, v28, -v27
    v_add_f32 v16, v16, v22
    v_add_f32 v28, v28, v27
    ds_write_b64 v8, v[14:15] offset:0
    v_mov_b32 v14, v24
    v_mov_b32 v15, v26
    ds_write_b64 v8, v[14:15] offset:640
    v_mov_b32 v14, v20
    v_mov_b32 v15, v25
    ds_write_b64 v8, v[14:15] offset:1280
    v_mov_b32 v14, v16
    v_mov_b32 v15, v28
    ds_write_b64 v8, v[14:15] offset:1920
    v_mov_b32 v14, v19
    v_mov_b32 v15, v23
    ds_write_b64 v8, v[14:15] offset:2560
    v_mov_b32 v14, v18
    v_mov_b32 v15, v21
    ds_write_b64 v8, v[14:15] offset:3200
    v_mov_b32 v14, v13
    v_mov_b32 v15, v30
    ds_write_b64 v8, v[14:15] offset:3840
    v_mov_b32 v14, v17
    v_mov_b32 v15, v29
    ds_write_b64 v8, v[14:15] offset:4480
    s_waitcnt lgkmcnt(0)
    s_barrier
    v_lshlrev_b32 v4, 3, v0
    v_sub_u32 v5, 640, v0
    v_cmp_eq_u32 vcc, 0, v0
    s_nop 1
    v_cndmask_b32 v5, v5, 0, vcc
    v_lshlrev_b32 v5, 3, v5
    ds_read_b64 v[6:7], v4 offset:0
    ds_read_b64 v[24:25], v5 offset:0
    ds_read_b64 v[26:27], v4 offset:5120
    ds_read_b64 v[28:29], v5 offset:5120
    ds_read_b64 v[30:31], v4 offset:10240
    ds_read_b64 v[32:33], v5 offset:10240
    ds_read_b64 v[34:35], v4 offset:15360
    ds_read_b64 v[36:37], v5 offset:15360
    s_waitcnt lgkmcnt(0)
    v_add_f32 v8, v6, v24
    v_sub_f32 v9, v7, v25
    v_add_f32 v10, v7, v25
    v_sub_f32 v11, v24, v6
    v_add_f32 v12, v26, v28
    v_sub_f32 v13, v27, v29
    v_add_f32 v14, v27, v29
    v_sub_f32 v15, v28, v26
    v_add_f32 v16, v30, v32
    v_sub_f32 v17, v31, v33
    v_add_f32 v18, v31, v33
    v_sub_f32 v19, v32, v30
    v_add_f32 v20, v34, v36
    v_sub_f32 v21, v35, v37
    v_add_f32 v22, v35, v37
    v_sub_f32 v23, v36, v34
    v_lshlrev_b32 v4, 14, v0
    s_lshl_b32 s22, s2, 6
    buffer_store_dwordx4 v[8:11], v4, s[12:15], s22 offen offset:0
    buffer_store_dwordx4 v[12:15], v4, s[12:15], s22 offen offset:16
    buffer_store_dwordx4 v[16:19], v4, s[12:15], s22 offen offset:32
    buffer_store_dwordx4 v[20:23], v4, s[12:15], s22 offen offset:48
    v_cmp_eq_u32 vcc, 0, v0
    s_and_saveexec_b64 s[24:25], vcc
    s_cbranch_execz k1b_kernel_end
    v_mov_b32 v4, 320
    v_lshlrev_b32 v5, 3, v4
    v_sub_u32 v6, 640, v4
    v_cmp_eq_u32 vcc, 0, v4
    s_nop 1
    v_cndmask_b32 v6, v6, 0, vcc
    v_lshlrev_b32 v6, 3, v6
    ds_read_b64 v[24:25], v5 offset:0
    ds_read_b64 v[26:27], v6 offset:0
    ds_read_b64 v[28:29], v5 offset:5120
    ds_read_b64 v[30:31], v6 offset:5120
    ds_read_b64 v[32:33], v5 offset:10240
    ds_read_b64 v[34:35], v6 offset:10240
    ds_read_b64 v[36:37], v5 offset:15360
    ds_read_b64 v[38:39], v6 offset:15360
    s_waitcnt lgkmcnt(0)
    v_add_f32 v8, v24, v26
    v_sub_f32 v9, v25, v27
    v_add_f32 v10, v25, v27
    v_sub_f32 v11, v26, v24
    v_add_f32 v12, v28, v30
    v_sub_f32 v13, v29, v31
    v_add_f32 v14, v29, v31
    v_sub_f32 v15, v30, v28
    v_add_f32 v16, v32, v34
    v_sub_f32 v17, v33, v35
    v_add_f32 v18, v33, v35
    v_sub_f32 v19, v34, v32
    v_add_f32 v20, v36, v38
    v_sub_f32 v21, v37, v39
    v_add_f32 v22, v37, v39
    v_sub_f32 v23, v38, v36
    v_lshlrev_b32 v5, 14, v4
    s_lshl_b32 s22, s2, 6
    buffer_store_dwordx4 v[8:11], v5, s[12:15], s22 offen offset:0
    buffer_store_dwordx4 v[12:15], v5, s[12:15], s22 offen offset:16
    buffer_store_dwordx4 v[16:19], v5, s[12:15], s22 offen offset:32
    buffer_store_dwordx4 v[20:23], v5, s[12:15], s22 offen offset:48
k1b_kernel_end:
    s_endpgm
.globl k2b_kernel
.p2align 8
.type k2b_kernel,@function
k2b_kernel:
    s_cmp_ge_u32 s2, 321
    s_cbranch_scc1 k2b_kernel_end
    s_load_dwordx4 s[4:7], s[0:1], 8
    s_load_dwordx2 s[16:17], s[0:1], 72
    s_waitcnt lgkmcnt(0)
    s_mov_b32 s8, s16
    s_and_b32 s9, s17, 0xffff
    s_mov_b32 s10, 0x504000
    s_mov_b32 s11, 0x00020000
    s_mov_b32 s12, s4
    s_and_b32 s13, s5, 0xffff
    s_mov_b32 s14, 0x141000
    s_mov_b32 s15, 0x00020000
    s_mov_b32 s20, s6
    s_and_b32 s21, s7, 0xffff
    s_mov_b32 s22, 0x141000
    s_mov_b32 s23, 0x00020000
    s_lshl_b32 s24, s2, 14
    s_add_u32 s32, s24, 0
    s_add_u32 s33, s24, 2048
    s_add_u32 s34, s24, 4096
    s_add_u32 s35, s24, 6144
    s_add_u32 s36, s24, 8192
    s_add_u32 s37, s24, 10240
    s_add_u32 s38, s24, 12288
    s_add_u32 s39, s24, 14336
    s_lshl_b32 s25, s2, 1
    s_add_u32 s40, s25, 0
    s_add_u32 s41, s25, 164352
    s_add_u32 s42, s25, 328704
    s_add_u32 s43, s25, 493056
    s_add_u32 s44, s25, 657408
    s_add_u32 s45, s25, 821760
    s_add_u32 s46, s25, 986112
    s_add_u32 s47, s25, 1150464
    v_lshlrev_b32 v2, 3, v0
    v_mul_u32_u24 v3, 642, v0
    buffer_load_dwordx2 v[4:5], v2, s[8:11], s32 offen
    buffer_load_dwordx2 v[6:7], v2, s[8:11], s33 offen
    buffer_load_dwordx2 v[8:9], v2, s[8:11], s34 offen
    buffer_load_dwordx2 v[10:11], v2, s[8:11], s35 offen
    buffer_load_dwordx2 v[12:13], v2, s[8:11], s36 offen
    buffer_load_dwordx2 v[14:15], v2, s[8:11], s37 offen
    buffer_load_dwordx2 v[16:17], v2, s[8:11], s38 offen
    buffer_load_dwordx2 v[18:19], v2, s[8:11], s39 offen
    buffer_load_ushort v20, v3, s[12:15], s40 offen
    buffer_load_ushort v21, v3, s[20:23], s40 offen
    buffer_load_ushort v22, v3, s[12:15], s41 offen
    buffer_load_ushort v23, v3, s[20:23], s41 offen
    buffer_load_ushort v24, v3, s[12:15], s42 offen
    buffer_load_ushort v25, v3, s[20:23], s42 offen
    buffer_load_ushort v26, v3, s[12:15], s43 offen
    buffer_load_ushort v27, v3, s[20:23], s43 offen
    buffer_load_ushort v28, v3, s[12:15], s44 offen
    buffer_load_ushort v29, v3, s[20:23], s44 offen
    buffer_load_ushort v30, v3, s[12:15], s45 offen
    buffer_load_ushort v31, v3, s[20:23], s45 offen
    buffer_load_ushort v32, v3, s[12:15], s46 offen
    buffer_load_ushort v33, v3, s[20:23], s46 offen
    buffer_load_ushort v34, v3, s[12:15], s47 offen
    buffer_load_ushort v35, v3, s[20:23], s47 offen
    v_lshlrev_b32 v3, 6, v0
    v_and_b32 v42, 7, v0
    v_cvt_f32_u32 v38, v42
    v_lshrrev_b32 v36, 3, v0
    v_lshlrev_b32 v36, 6, v36
    v_add_u32 v36, v36, v42
    v_lshlrev_b32 v36, 3, v36
    v_and_b32 v42, 63, v0
    v_cvt_f32_u32 v39, v42
    v_lshrrev_b32 v37, 6, v0
    v_lshlrev_b32 v37, 9, v37
    v_add_u32 v37, v37, v42
    v_lshlrev_b32 v37, 3, v37
    v_cvt_f32_u32 v40, v0
    v_add_f32 v41, 0x43800000, v40
    s_waitcnt vmcnt(16)
    v_add_f32 v42, v4, -v12
    v_add_f32 v43, v5, -v13
    v_add_f32 v4, v4, v12
    v_add_f32 v5, v5, v13
    v_add_f32 v12, v8, -v16
    v_add_f32 v13, v9, -v17
    v_add_f32 v8, v8, v16
    v_add_f32 v9, v9, v17
    v_add_f32 v16, v4, -v8
    v_add_f32 v17, v5, -v9
    v_add_f32 v4, v4, v8
    v_add_f32 v5, v5, v9
    v_add_f32 v8, v42, -v13
    v_add_f32 v9, v43, v12
    v_add_f32 v42, v42, v13
    v_add_f32 v43, v43, -v12
    v_add_f32 v12, v6, -v14
    v_add_f32 v13, v7, -v15
    v_add_f32 v6, v6, v14
    v_add_f32 v7, v7, v15
    v_add_f32 v14, v10, -v18
    v_add_f32 v15, v11, -v19
    v_add_f32 v10, v10, v18
    v_add_f32 v11, v11, v19
    v_add_f32 v18, v6, -v10
    v_add_f32 v19, v7, -v11
    v_add_f32 v6, v6, v10
    v_add_f32 v7, v7, v11
    v_add_f32 v10, v12, -v15
    v_add_f32 v11, v13, v14
    v_add_f32 v12, v12, v15
    v_add_f32 v13, v13, -v14
    v_add_f32 v14, v4, -v6
    v_add_f32 v15, v5, -v7
    v_add_f32 v4, v4, v6
    v_add_f32 v5, v5, v7
    v_mul_f32 v6, 0x3f3504f3, v12
    v_mul_f32 v7, 0xbf3504f3, v12
    v_fmac_f32 v6, 0x3f3504f3, v13
    v_fmac_f32 v7, 0x3f3504f3, v13
    v_add_f32 v12, v42, -v6
    v_add_f32 v13, v43, -v7
    v_add_f32 v42, v42, v6
    v_add_f32 v43, v43, v7
    v_add_f32 v6, v16, -v19
    v_add_f32 v7, v17, v18
    v_add_f32 v16, v16, v19
    v_add_f32 v17, v17, -v18
    v_mul_f32 v18, 0xbf3504f3, v10
    v_mul_f32 v19, 0xbf3504f3, v10
    v_fmac_f32 v18, 0x3f3504f3, v11
    v_fmac_f32 v19, 0xbf3504f3, v11
    v_add_f32 v10, v8, -v18
    v_add_f32 v11, v9, -v19
    v_add_f32 v8, v8, v18
    v_add_f32 v9, v9, v19
    ds_write_b64 v3, v[4:5] offset:0
    ds_write_b64 v3, v[42:43] offset:8
    ds_write_b64 v3, v[16:17] offset:16
    ds_write_b64 v3, v[8:9] offset:24
    ds_write_b64 v3, v[14:15] offset:32
    ds_write_b64 v3, v[12:13] offset:40
    ds_write_b64 v3, v[6:7] offset:48
    ds_write_b64 v3, v[10:11] offset:56
    s_waitcnt lgkmcnt(0)
    s_barrier
    ds_read_b64 v[4:5], v2 offset:0
    ds_read_b64 v[6:7], v2 offset:2048
    ds_read_b64 v[8:9], v2 offset:4096
    ds_read_b64 v[10:11], v2 offset:6144
    ds_read_b64 v[12:13], v2 offset:8192
    ds_read_b64 v[14:15], v2 offset:10240
    ds_read_b64 v[16:17], v2 offset:12288
    ds_read_b64 v[18:19], v2 offset:14336
    s_waitcnt lgkmcnt(0)
    v_mul_f32 v42, 0xbc800000, v38
    v_cos_f32 v43, v42
    v_sin_f32 v44, v42
    v_mul_f32 v42, v6, v43
    v_mul_f32 v45, v6, v44
    v_fma_f32 v42, -v7, v44, v42
    v_fma_f32 v45, v7, v43, v45
    v_mul_f32 v6, 0xbd000000, v38
    v_cos_f32 v7, v6
    v_sin_f32 v43, v6
    v_mul_f32 v6, v8, v7
    v_mul_f32 v44, v8, v43
    v_fma_f32 v6, -v9, v43, v6
    v_fma_f32 v44, v9, v7, v44
    v_mul_f32 v7, 0xbd400000, v38
    v_cos_f32 v8, v7
    v_sin_f32 v9, v7
    v_mul_f32 v7, v10, v8
    v_mul_f32 v43, v10, v9
    v_fma_f32 v7, -v11, v9, v7
    v_fma_f32 v43, v11, v8, v43
    v_mul_f32 v8, 0xbd800000, v38
    v_cos_f32 v9, v8
    v_sin_f32 v10, v8
    v_mul_f32 v8, v12, v9
    v_mul_f32 v11, v12, v10
    v_fma_f32 v8, -v13, v10, v8
    v_fma_f32 v11, v13, v9, v11
    v_mul_f32 v9, 0xbda00000, v38
    v_cos_f32 v10, v9
    v_sin_f32 v12, v9
    v_mul_f32 v9, v14, v10
    v_mul_f32 v13, v14, v12
    v_fma_f32 v9, -v15, v12, v9
    v_fma_f32 v13, v15, v10, v13
    v_mul_f32 v10, 0xbdc00000, v38
    v_cos_f32 v12, v10
    v_sin_f32 v14, v10
    v_mul_f32 v10, v16, v12
    v_mul_f32 v15, v16, v14
    v_fma_f32 v10, -v17, v14, v10
    v_fma_f32 v15, v17, v12, v15
    v_mul_f32 v12, 0xbde00000, v38
    v_cos_f32 v14, v12
    v_sin_f32 v16, v12
    v_mul_f32 v12, v18, v14
    v_mul_f32 v17, v18, v16
    v_fma_f32 v12, -v19, v16, v12
    v_fma_f32 v17, v19, v14, v17
    v_add_f32 v14, v4, -v8
    v_add_f32 v16, v5, -v11
    v_add_f32 v4, v4, v8
    v_add_f32 v5, v5, v11
    v_add_f32 v8, v6, -v10
    v_add_f32 v11, v44, -v15
    v_add_f32 v6, v6, v10
    v_add_f32 v44, v44, v15
    v_add_f32 v10, v4, -v6
    v_add_f32 v15, v5, -v44
    v_add_f32 v4, v4, v6
    v_add_f32 v5, v5, v44
    v_add_f32 v6, v14, -v11
    v_add_f32 v18, v16, v8
    v_add_f32 v14, v14, v11
    v_add_f32 v16, v16, -v8
    v_add_f32 v8, v42, -v9
    v_add_f32 v11, v45, -v13
    v_add_f32 v42, v42, v9
    v_add_f32 v45, v45, v13
    v_add_f32 v9, v7, -v12
    v_add_f32 v13, v43, -v17
    v_add_f32 v7, v7, v12
    v_add_f32 v43, v43, v17
    v_add_f32 v12, v42, -v7
    v_add_f32 v17, v45, -v43
    v_add_f32 v42, v42, v7
    v_add_f32 v45, v45, v43
    v_add_f32 v7, v8, -v13
    v_add_f32 v19, v11, v9
    v_add_f32 v8, v8, v13
    v_add_f32 v11, v11, -v9
    v_add_f32 v9, v4, -v42
    v_add_f32 v13, v5, -v45
    v_add_f32 v4, v4, v42
    v_add_f32 v5, v5, v45
    v_mul_f32 v42, 0x3f3504f3, v8
    v_mul_f32 v43, 0xbf3504f3, v8
    v_fmac_f32 v42, 0x3f3504f3, v11
    v_fmac_f32 v43, 0x3f3504f3, v11
    v_add_f32 v8, v14, -v42
    v_add_f32 v11, v16, -v43
    v_add_f32 v14, v14, v42
    v_add_f32 v16, v16, v43
    v_add_f32 v42, v10, -v17
    v_add_f32 v43, v15, v12
    v_add_f32 v10, v10, v17
    v_add_f32 v15, v15, -v12
    v_mul_f32 v12, 0xbf3504f3, v7
    v_mul_f32 v17, 0xbf3504f3, v7
    v_fmac_f32 v12, 0x3f3504f3, v19
    v_fmac_f32 v17, 0xbf3504f3, v19
    v_add_f32 v7, v6, -v12
    v_add_f32 v19, v18, -v17
    v_add_f32 v6, v6, v12
    v_add_f32 v18, v18, v17
    ds_write_b64 v36, v[4:5] offset:16384
    v_mov_b32 v4, v14
    v_mov_b32 v5, v16
    ds_write_b64 v36, v[4:5] offset:16448
    v_mov_b32 v4, v10
    v_mov_b32 v5, v15
    ds_write_b64 v36, v[4:5] offset:16512
    v_mov_b32 v4, v6
    v_mov_b32 v5, v18
    ds_write_b64 v36, v[4:5] offset:16576
    v_mov_b32 v4, v9
    v_mov_b32 v5, v13
    ds_write_b64 v36, v[4:5] offset:16640
    v_mov_b32 v4, v8
    v_mov_b32 v5, v11
    ds_write_b64 v36, v[4:5] offset:16704
    ds_write_b64 v36, v[42:43] offset:16768
    v_mov_b32 v4, v7
    v_mov_b32 v5, v19
    ds_write_b64 v36, v[4:5] offset:16832
    s_waitcnt lgkmcnt(0)
    s_barrier
    ds_read_b64 v[4:5], v2 offset:16384
    ds_read_b64 v[6:7], v2 offset:18432
    ds_read_b64 v[8:9], v2 offset:20480
    ds_read_b64 v[10:11], v2 offset:22528
    ds_read_b64 v[12:13], v2 offset:24576
    ds_read_b64 v[14:15], v2 offset:26624
    ds_read_b64 v[16:17], v2 offset:28672
    ds_read_b64 v[18:19], v2 offset:30720
    s_waitcnt lgkmcnt(0)
    v_mul_f32 v42, 0xbb000000, v39
    v_cos_f32 v43, v42
    v_sin_f32 v44, v42
    v_mul_f32 v42, v6, v43
    v_mul_f32 v45, v6, v44
    v_fma_f32 v42, -v7, v44, v42
    v_fma_f32 v45, v7, v43, v45
    v_mul_f32 v6, 0xbb800000, v39
    v_cos_f32 v7, v6
    v_sin_f32 v43, v6
    v_mul_f32 v6, v8, v7
    v_mul_f32 v44, v8, v43
    v_fma_f32 v6, -v9, v43, v6
    v_fma_f32 v44, v9, v7, v44
    v_mul_f32 v7, 0xbbc00000, v39
    v_cos_f32 v8, v7
    v_sin_f32 v9, v7
    v_mul_f32 v7, v10, v8
    v_mul_f32 v43, v10, v9
    v_fma_f32 v7, -v11, v9, v7
    v_fma_f32 v43, v11, v8, v43
    v_mul_f32 v8, 0xbc000000, v39
    v_cos_f32 v9, v8
    v_sin_f32 v10, v8
    v_mul_f32 v8, v12, v9
    v_mul_f32 v11, v12, v10
    v_fma_f32 v8, -v13, v10, v8
    v_fma_f32 v11, v13, v9, v11
    v_mul_f32 v9, 0xbc200000, v39
    v_cos_f32 v10, v9
    v_sin_f32 v12, v9
    v_mul_f32 v9, v14, v10
    v_mul_f32 v13, v14, v12
    v_fma_f32 v9, -v15, v12, v9
    v_fma_f32 v13, v15, v10, v13
    v_mul_f32 v10, 0xbc400000, v39
    v_cos_f32 v12, v10
    v_sin_f32 v14, v10
    v_mul_f32 v10, v16, v12
    v_mul_f32 v15, v16, v14
    v_fma_f32 v10, -v17, v14, v10
    v_fma_f32 v15, v17, v12, v15
    v_mul_f32 v12, 0xbc600000, v39
    v_cos_f32 v14, v12
    v_sin_f32 v16, v12
    v_mul_f32 v12, v18, v14
    v_mul_f32 v17, v18, v16
    v_fma_f32 v12, -v19, v16, v12
    v_fma_f32 v17, v19, v14, v17
    v_add_f32 v14, v4, -v8
    v_add_f32 v16, v5, -v11
    v_add_f32 v4, v4, v8
    v_add_f32 v5, v5, v11
    v_add_f32 v8, v6, -v10
    v_add_f32 v11, v44, -v15
    v_add_f32 v6, v6, v10
    v_add_f32 v44, v44, v15
    v_add_f32 v10, v4, -v6
    v_add_f32 v15, v5, -v44
    v_add_f32 v4, v4, v6
    v_add_f32 v5, v5, v44
    v_add_f32 v6, v14, -v11
    v_add_f32 v18, v16, v8
    v_add_f32 v14, v14, v11
    v_add_f32 v16, v16, -v8
    v_add_f32 v8, v42, -v9
    v_add_f32 v11, v45, -v13
    v_add_f32 v42, v42, v9
    v_add_f32 v45, v45, v13
    v_add_f32 v9, v7, -v12
    v_add_f32 v13, v43, -v17
    v_add_f32 v7, v7, v12
    v_add_f32 v43, v43, v17
    v_add_f32 v12, v42, -v7
    v_add_f32 v17, v45, -v43
    v_add_f32 v42, v42, v7
    v_add_f32 v45, v45, v43
    v_add_f32 v7, v8, -v13
    v_add_f32 v19, v11, v9
    v_add_f32 v8, v8, v13
    v_add_f32 v11, v11, -v9
    v_add_f32 v9, v4, -v42
    v_add_f32 v13, v5, -v45
    v_add_f32 v4, v4, v42
    v_add_f32 v5, v5, v45
    v_mul_f32 v42, 0x3f3504f3, v8
    v_mul_f32 v43, 0xbf3504f3, v8
    v_fmac_f32 v42, 0x3f3504f3, v11
    v_fmac_f32 v43, 0x3f3504f3, v11
    v_add_f32 v8, v14, -v42
    v_add_f32 v11, v16, -v43
    v_add_f32 v14, v14, v42
    v_add_f32 v16, v16, v43
    v_add_f32 v42, v10, -v17
    v_add_f32 v43, v15, v12
    v_add_f32 v10, v10, v17
    v_add_f32 v15, v15, -v12
    v_mul_f32 v12, 0xbf3504f3, v7
    v_mul_f32 v17, 0xbf3504f3, v7
    v_fmac_f32 v12, 0x3f3504f3, v19
    v_fmac_f32 v17, 0xbf3504f3, v19
    v_add_f32 v7, v6, -v12
    v_add_f32 v19, v18, -v17
    v_add_f32 v6, v6, v12
    v_add_f32 v18, v18, v17
    ds_write_b64 v37, v[4:5] offset:0
    v_mov_b32 v4, v14
    v_mov_b32 v5, v16
    ds_write_b64 v37, v[4:5] offset:512
    v_mov_b32 v4, v10
    v_mov_b32 v5, v15
    ds_write_b64 v37, v[4:5] offset:1024
    v_mov_b32 v4, v6
    v_mov_b32 v5, v18
    ds_write_b64 v37, v[4:5] offset:1536
    v_mov_b32 v4, v9
    v_mov_b32 v5, v13
    ds_write_b64 v37, v[4:5] offset:2048
    v_mov_b32 v4, v8
    v_mov_b32 v5, v11
    ds_write_b64 v37, v[4:5] offset:2560
    ds_write_b64 v37, v[42:43] offset:3072
    v_mov_b32 v4, v7
    v_mov_b32 v5, v19
    ds_write_b64 v37, v[4:5] offset:3584
    s_waitcnt lgkmcnt(0)
    s_barrier
    ds_read_b64 v[4:5], v2 offset:0
    ds_read_b64 v[6:7], v2 offset:2048
    ds_read_b64 v[8:9], v2 offset:4096
    ds_read_b64 v[10:11], v2 offset:6144
    ds_read_b64 v[12:13], v2 offset:8192
    ds_read_b64 v[14:15], v2 offset:10240
    ds_read_b64 v[16:17], v2 offset:12288
    ds_read_b64 v[18:19], v2 offset:14336
    s_waitcnt lgkmcnt(0)
    v_mul_f32 v42, 0xba000000, v40
    v_cos_f32 v43, v42
    v_sin_f32 v44, v42
    v_mul_f32 v42, v8, v43
    v_mul_f32 v45, v8, v44
    v_fma_f32 v42, -v9, v44, v42
    v_fma_f32 v45, v9, v43, v45
    v_mul_f32 v8, 0xba800000, v40
    v_cos_f32 v9, v8
    v_sin_f32 v43, v8
    v_mul_f32 v8, v12, v9
    v_mul_f32 v44, v12, v43
    v_fma_f32 v8, -v13, v43, v8
    v_fma_f32 v44, v13, v9, v44
    v_mul_f32 v9, 0xbac00000, v40
    v_cos_f32 v12, v9
    v_sin_f32 v13, v9
    v_mul_f32 v9, v16, v12
    v_mul_f32 v43, v16, v13
    v_fma_f32 v9, -v17, v13, v9
    v_fma_f32 v43, v17, v12, v43
    v_add_f32 v12, v4, -v8
    v_add_f32 v13, v5, -v44
    v_add_f32 v4, v4, v8
    v_add_f32 v5, v5, v44
    v_add_f32 v8, v42, -v9
    v_add_f32 v16, v45, -v43
    v_add_f32 v42, v42, v9
    v_add_f32 v45, v45, v43
    v_add_f32 v9, v4, -v42
    v_add_f32 v17, v5, -v45
    v_add_f32 v4, v4, v42
    v_add_f32 v5, v5, v45
    v_add_f32 v42, v12, -v16
    v_add_f32 v43, v13, v8
    v_add_f32 v12, v12, v16
    v_add_f32 v13, v13, -v8
    v_mul_f32 v8, 0xba000000, v41
    v_cos_f32 v16, v8
    v_sin_f32 v44, v8
    v_mul_f32 v8, v10, v16
    v_mul_f32 v45, v10, v44
    v_fma_f32 v8, -v11, v44, v8
    v_fma_f32 v45, v11, v16, v45
    v_mul_f32 v10, 0xba800000, v41
    v_cos_f32 v11, v10
    v_sin_f32 v16, v10
    v_mul_f32 v10, v14, v11
    v_mul_f32 v44, v14, v16
    v_fma_f32 v10, -v15, v16, v10
    v_fma_f32 v44, v15, v11, v44
    v_mul_f32 v11, 0xbac00000, v41
    v_cos_f32 v14, v11
    v_sin_f32 v15, v11
    v_mul_f32 v11, v18, v14
    v_mul_f32 v16, v18, v15
    v_fma_f32 v11, -v19, v15, v11
    v_fma_f32 v16, v19, v14, v16
    v_add_f32 v14, v6, -v10
    v_add_f32 v15, v7, -v44
    v_add_f32 v6, v6, v10
    v_add_f32 v7, v7, v44
    v_add_f32 v10, v8, -v11
    v_add_f32 v18, v45, -v16
    v_add_f32 v8, v8, v11
    v_add_f32 v45, v45, v16
    v_add_f32 v11, v6, -v8
    v_add_f32 v16, v7, -v45
    v_add_f32 v6, v6, v8
    v_add_f32 v7, v7, v45
    v_add_f32 v8, v14, -v18
    v_add_f32 v19, v15, v10
    v_add_f32 v14, v14, v18
    v_add_f32 v15, v15, -v10
    s_waitcnt vmcnt(0)
    v_lshlrev_b32 v20, 16, v20
    v_lshlrev_b32 v21, 16, v21
    v_mul_f32 v20, 0x34cccccd, v20
    v_mul_f32 v21, 0x34cccccd, v21
    v_mul_f32 v10, v4, v20
    v_mul_f32 v18, v4, v21
    v_fma_f32 v10, -v5, v21, v10
    v_fma_f32 v18, v5, v20, v18
    v_lshlrev_b32 v22, 16, v22
    v_lshlrev_b32 v23, 16, v23
    v_mul_f32 v22, 0x34cccccd, v22
    v_mul_f32 v23, 0x34cccccd, v23
    v_mul_f32 v4, v6, v22
    v_mul_f32 v5, v6, v23
    v_fma_f32 v4, -v7, v23, v4
    v_fma_f32 v5, v7, v22, v5
    v_lshlrev_b32 v24, 16, v24
    v_lshlrev_b32 v25, 16, v25
    v_mul_f32 v24, 0x34cccccd, v24
    v_mul_f32 v25, 0x34cccccd, v25
    v_mul_f32 v6, v12, v24
    v_mul_f32 v7, v12, v25
    v_fma_f32 v6, -v13, v25, v6
    v_fma_f32 v7, v13, v24, v7
    v_lshlrev_b32 v26, 16, v26
    v_lshlrev_b32 v27, 16, v27
    v_mul_f32 v26, 0x34cccccd, v26
    v_mul_f32 v27, 0x34cccccd, v27
    v_mul_f32 v12, v14, v26
    v_mul_f32 v13, v14, v27
    v_fma_f32 v12, -v15, v27, v12
    v_fma_f32 v13, v15, v26, v13
    v_lshlrev_b32 v28, 16, v28
    v_lshlrev_b32 v29, 16, v29
    v_mul_f32 v28, 0x34cccccd, v28
    v_mul_f32 v29, 0x34cccccd, v29
    v_mul_f32 v14, v9, v28
    v_mul_f32 v15, v9, v29
    v_fma_f32 v14, -v17, v29, v14
    v_fma_f32 v15, v17, v28, v15
    v_lshlrev_b32 v30, 16, v30
    v_lshlrev_b32 v31, 16, v31
    v_mul_f32 v30, 0x34cccccd, v30
    v_mul_f32 v31, 0x34cccccd, v31
    v_mul_f32 v9, v11, v30
    v_mul_f32 v17, v11, v31
    v_fma_f32 v9, -v16, v31, v9
    v_fma_f32 v17, v16, v30, v17
    v_lshlrev_b32 v32, 16, v32
    v_lshlrev_b32 v33, 16, v33
    v_mul_f32 v32, 0x34cccccd, v32
    v_mul_f32 v33, 0x34cccccd, v33
    v_mul_f32 v11, v42, v32
    v_mul_f32 v16, v42, v33
    v_fma_f32 v11, -v43, v33, v11
    v_fma_f32 v16, v43, v32, v16
    v_lshlrev_b32 v34, 16, v34
    v_lshlrev_b32 v35, 16, v35
    v_mul_f32 v34, 0x34cccccd, v34
    v_mul_f32 v35, 0x34cccccd, v35
    v_mul_f32 v20, v8, v34
    v_mul_f32 v21, v8, v35
    v_fma_f32 v20, -v19, v35, v20
    v_fma_f32 v21, v19, v34, v21
    v_add_f32 v8, v10, -v14
    v_add_f32 v19, v18, -v15
    v_add_f32 v10, v10, v14
    v_add_f32 v18, v18, v15
    v_add_f32 v14, v6, -v11
    v_add_f32 v15, v7, -v16
    v_add_f32 v6, v6, v11
    v_add_f32 v7, v7, v16
    v_add_f32 v11, v10, -v6
    v_add_f32 v16, v18, -v7
    v_add_f32 v10, v10, v6
    v_add_f32 v18, v18, v7
    v_add_f32 v6, v8, v15
    v_add_f32 v7, v19, -v14
    v_add_f32 v8, v8, -v15
    v_add_f32 v19, v19, v14
    v_add_f32 v14, v4, -v9
    v_add_f32 v15, v5, -v17
    v_add_f32 v4, v4, v9
    v_add_f32 v5, v5, v17
    v_add_f32 v9, v12, -v20
    v_add_f32 v17, v13, -v21
    v_add_f32 v12, v12, v20
    v_add_f32 v13, v13, v21
    v_add_f32 v20, v4, -v12
    v_add_f32 v21, v5, -v13
    v_add_f32 v4, v4, v12
    v_add_f32 v5, v5, v13
    v_add_f32 v12, v14, v17
    v_add_f32 v13, v15, -v9
    v_add_f32 v14, v14, -v17
    v_add_f32 v15, v15, v9
    v_add_f32 v9, v10, -v4
    v_add_f32 v17, v18, -v5
    v_add_f32 v10, v10, v4
    v_add_f32 v18, v18, v5
    v_mul_f32 v4, 0x3f3504f3, v14
    v_mul_f32 v5, 0x3f3504f3, v14
    v_fmac_f32 v4, 0xbf3504f3, v15
    v_fmac_f32 v5, 0x3f3504f3, v15
    v_add_f32 v14, v8, -v4
    v_add_f32 v15, v19, -v5
    v_add_f32 v8, v8, v4
    v_add_f32 v19, v19, v5
    v_add_f32 v4, v11, v21
    v_add_f32 v5, v16, -v20
    v_add_f32 v11, v11, -v21
    v_add_f32 v16, v16, v20
    v_mul_f32 v20, 0xbf3504f3, v12
    v_mul_f32 v21, 0x3f3504f3, v12
    v_fmac_f32 v20, 0xbf3504f3, v13
    v_fmac_f32 v21, 0xbf3504f3, v13
    v_add_f32 v12, v6, -v20
    v_add_f32 v13, v7, -v21
    v_add_f32 v6, v6, v20
    v_add_f32 v7, v7, v21
    v_mov_b32 v20, v10
    v_mov_b32 v21, v18
    ds_write_b64 v3, v[20:21] offset:16384
    v_mov_b32 v20, v8
    v_mov_b32 v21, v19
    ds_write_b64 v3, v[20:21] offset:16392
    v_mov_b32 v18, v11
    v_mov_b32 v19, v16
    ds_write_b64 v3, v[18:19] offset:16400
    ds_write_b64 v3, v[6:7] offset:16408
    v_mov_b32 v6, v9
    v_mov_b32 v7, v17
    ds_write_b64 v3, v[6:7] offset:16416
    ds_write_b64 v3, v[14:15] offset:16424
    ds_write_b64 v3, v[4:5] offset:16432
    ds_write_b64 v3, v[12:13] offset:16440
    s_waitcnt lgkmcnt(0)
    s_barrier
    ds_read_b64 v[4:5], v2 offset:16384
    ds_read_b64 v[6:7], v2 offset:18432
    ds_read_b64 v[8:9], v2 offset:20480
    ds_read_b64 v[10:11], v2 offset:22528
    ds_read_b64 v[12:13], v2 offset:24576
    ds_read_b64 v[14:15], v2 offset:26624
    ds_read_b64 v[16:17], v2 offset:28672
    ds_read_b64 v[18:19], v2 offset:30720
    s_waitcnt lgkmcnt(0)
    v_mul_f32 v20, 0x3c800000, v38
    v_cos_f32 v21, v20
    v_sin_f32 v22, v20
    v_mul_f32 v20, v6, v21
    v_mul_f32 v23, v6, v22
    v_fma_f32 v20, -v7, v22, v20
    v_fma_f32 v23, v7, v21, v23
    v_mul_f32 v6, 0x3d000000, v38
    v_cos_f32 v7, v6
    v_sin_f32 v21, v6
    v_mul_f32 v6, v8, v7
    v_mul_f32 v22, v8, v21
    v_fma_f32 v6, -v9, v21, v6
    v_fma_f32 v22, v9, v7, v22
    v_mul_f32 v7, 0x3d400000, v38
    v_cos_f32 v8, v7
    v_sin_f32 v9, v7
    v_mul_f32 v7, v10, v8
    v_mul_f32 v21, v10, v9
    v_fma_f32 v7, -v11, v9, v7
    v_fma_f32 v21, v11, v8, v21
    v_mul_f32 v8, 0x3d800000, v38
    v_cos_f32 v9, v8
    v_sin_f32 v10, v8
    v_mul_f32 v8, v12, v9
    v_mul_f32 v11, v12, v10
    v_fma_f32 v8, -v13, v10, v8
    v_fma_f32 v11, v13, v9, v11
    v_mul_f32 v9, 0x3da00000, v38
    v_cos_f32 v10, v9
    v_sin_f32 v12, v9
    v_mul_f32 v9, v14, v10
    v_mul_f32 v13, v14, v12
    v_fma_f32 v9, -v15, v12, v9
    v_fma_f32 v13, v15, v10, v13
    v_mul_f32 v10, 0x3dc00000, v38
    v_cos_f32 v12, v10
    v_sin_f32 v14, v10
    v_mul_f32 v10, v16, v12
    v_mul_f32 v15, v16, v14
    v_fma_f32 v10, -v17, v14, v10
    v_fma_f32 v15, v17, v12, v15
    v_mul_f32 v12, 0x3de00000, v38
    v_cos_f32 v14, v12
    v_sin_f32 v16, v12
    v_mul_f32 v12, v18, v14
    v_mul_f32 v17, v18, v16
    v_fma_f32 v12, -v19, v16, v12
    v_fma_f32 v17, v19, v14, v17
    v_add_f32 v14, v4, -v8
    v_add_f32 v16, v5, -v11
    v_add_f32 v4, v4, v8
    v_add_f32 v5, v5, v11
    v_add_f32 v8, v6, -v10
    v_add_f32 v11, v22, -v15
    v_add_f32 v6, v6, v10
    v_add_f32 v22, v22, v15
    v_add_f32 v10, v4, -v6
    v_add_f32 v15, v5, -v22
    v_add_f32 v4, v4, v6
    v_add_f32 v5, v5, v22
    v_add_f32 v6, v14, v11
    v_add_f32 v18, v16, -v8
    v_add_f32 v14, v14, -v11
    v_add_f32 v16, v16, v8
    v_add_f32 v8, v20, -v9
    v_add_f32 v11, v23, -v13
    v_add_f32 v20, v20, v9
    v_add_f32 v23, v23, v13
    v_add_f32 v9, v7, -v12
    v_add_f32 v13, v21, -v17
    v_add_f32 v7, v7, v12
    v_add_f32 v21, v21, v17
    v_add_f32 v12, v20, -v7
    v_add_f32 v17, v23, -v21
    v_add_f32 v20, v20, v7
    v_add_f32 v23, v23, v21
    v_add_f32 v7, v8, v13
    v_add_f32 v19, v11, -v9
    v_add_f32 v8, v8, -v13
    v_add_f32 v11, v11, v9
    v_add_f32 v9, v4, -v20
    v_add_f32 v13, v5, -v23
    v_add_f32 v4, v4, v20
    v_add_f32 v5, v5, v23
    v_mul_f32 v20, 0x3f3504f3, v8
    v_mul_f32 v21, 0x3f3504f3, v8
    v_fmac_f32 v20, 0xbf3504f3, v11
    v_fmac_f32 v21, 0x3f3504f3, v11
    v_add_f32 v8, v14, -v20
    v_add_f32 v11, v16, -v21
    v_add_f32 v14, v14, v20
    v_add_f32 v16, v16, v21
    v_add_f32 v20, v10, v17
    v_add_f32 v21, v15, -v12
    v_add_f32 v10, v10, -v17
    v_add_f32 v15, v15, v12
    v_mul_f32 v12, 0xbf3504f3, v7
    v_mul_f32 v17, 0x3f3504f3, v7
    v_fmac_f32 v12, 0xbf3504f3, v19
    v_fmac_f32 v17, 0xbf3504f3, v19
    v_add_f32 v7, v6, -v12
    v_add_f32 v19, v18, -v17
    v_add_f32 v6, v6, v12
    v_add_f32 v18, v18, v17
    ds_write_b64 v36, v[4:5] offset:0
    v_mov_b32 v4, v14
    v_mov_b32 v5, v16
    ds_write_b64 v36, v[4:5] offset:64
    v_mov_b32 v4, v10
    v_mov_b32 v5, v15
    ds_write_b64 v36, v[4:5] offset:128
    v_mov_b32 v4, v6
    v_mov_b32 v5, v18
    ds_write_b64 v36, v[4:5] offset:192
    v_mov_b32 v4, v9
    v_mov_b32 v5, v13
    ds_write_b64 v36, v[4:5] offset:256
    v_mov_b32 v4, v8
    v_mov_b32 v5, v11
    ds_write_b64 v36, v[4:5] offset:320
    ds_write_b64 v36, v[20:21] offset:384
    v_mov_b32 v4, v7
    v_mov_b32 v5, v19
    ds_write_b64 v36, v[4:5] offset:448
    s_waitcnt lgkmcnt(0)
    s_barrier
    ds_read_b64 v[4:5], v2 offset:0
    ds_read_b64 v[6:7], v2 offset:2048
    ds_read_b64 v[8:9], v2 offset:4096
    ds_read_b64 v[10:11], v2 offset:6144
    ds_read_b64 v[12:13], v2 offset:8192
    ds_read_b64 v[14:15], v2 offset:10240
    ds_read_b64 v[16:17], v2 offset:12288
    ds_read_b64 v[18:19], v2 offset:14336
    s_waitcnt lgkmcnt(0)
    v_mul_f32 v20, 0x3b000000, v39
    v_cos_f32 v21, v20
    v_sin_f32 v22, v20
    v_mul_f32 v20, v6, v21
    v_mul_f32 v23, v6, v22
    v_fma_f32 v20, -v7, v22, v20
    v_fma_f32 v23, v7, v21, v23
    v_mul_f32 v6, 0x3b800000, v39
    v_cos_f32 v7, v6
    v_sin_f32 v21, v6
    v_mul_f32 v6, v8, v7
    v_mul_f32 v22, v8, v21
    v_fma_f32 v6, -v9, v21, v6
    v_fma_f32 v22, v9, v7, v22
    v_mul_f32 v7, 0x3bc00000, v39
    v_cos_f32 v8, v7
    v_sin_f32 v9, v7
    v_mul_f32 v7, v10, v8
    v_mul_f32 v21, v10, v9
    v_fma_f32 v7, -v11, v9, v7
    v_fma_f32 v21, v11, v8, v21
    v_mul_f32 v8, 0x3c000000, v39
    v_cos_f32 v9, v8
    v_sin_f32 v10, v8
    v_mul_f32 v8, v12, v9
    v_mul_f32 v11, v12, v10
    v_fma_f32 v8, -v13, v10, v8
    v_fma_f32 v11, v13, v9, v11
    v_mul_f32 v9, 0x3c200000, v39
    v_cos_f32 v10, v9
    v_sin_f32 v12, v9
    v_mul_f32 v9, v14, v10
    v_mul_f32 v13, v14, v12
    v_fma_f32 v9, -v15, v12, v9
    v_fma_f32 v13, v15, v10, v13
    v_mul_f32 v10, 0x3c400000, v39
    v_cos_f32 v12, v10
    v_sin_f32 v14, v10
    v_mul_f32 v10, v16, v12
    v_mul_f32 v15, v16, v14
    v_fma_f32 v10, -v17, v14, v10
    v_fma_f32 v15, v17, v12, v15
    v_mul_f32 v12, 0x3c600000, v39
    v_cos_f32 v14, v12
    v_sin_f32 v16, v12
    v_mul_f32 v12, v18, v14
    v_mul_f32 v17, v18, v16
    v_fma_f32 v12, -v19, v16, v12
    v_fma_f32 v17, v19, v14, v17
    v_add_f32 v14, v4, -v8
    v_add_f32 v16, v5, -v11
    v_add_f32 v4, v4, v8
    v_add_f32 v5, v5, v11
    v_add_f32 v8, v6, -v10
    v_add_f32 v11, v22, -v15
    v_add_f32 v6, v6, v10
    v_add_f32 v22, v22, v15
    v_add_f32 v10, v4, -v6
    v_add_f32 v15, v5, -v22
    v_add_f32 v4, v4, v6
    v_add_f32 v5, v5, v22
    v_add_f32 v6, v14, v11
    v_add_f32 v18, v16, -v8
    v_add_f32 v14, v14, -v11
    v_add_f32 v16, v16, v8
    v_add_f32 v8, v20, -v9
    v_add_f32 v11, v23, -v13
    v_add_f32 v20, v20, v9
    v_add_f32 v23, v23, v13
    v_add_f32 v9, v7, -v12
    v_add_f32 v13, v21, -v17
    v_add_f32 v7, v7, v12
    v_add_f32 v21, v21, v17
    v_add_f32 v12, v20, -v7
    v_add_f32 v17, v23, -v21
    v_add_f32 v20, v20, v7
    v_add_f32 v23, v23, v21
    v_add_f32 v7, v8, v13
    v_add_f32 v19, v11, -v9
    v_add_f32 v8, v8, -v13
    v_add_f32 v11, v11, v9
    v_add_f32 v9, v4, -v20
    v_add_f32 v13, v5, -v23
    v_add_f32 v4, v4, v20
    v_add_f32 v5, v5, v23
    v_mul_f32 v20, 0x3f3504f3, v8
    v_mul_f32 v21, 0x3f3504f3, v8
    v_fmac_f32 v20, 0xbf3504f3, v11
    v_fmac_f32 v21, 0x3f3504f3, v11
    v_add_f32 v8, v14, -v20
    v_add_f32 v11, v16, -v21
    v_add_f32 v14, v14, v20
    v_add_f32 v16, v16, v21
    v_add_f32 v20, v10, v17
    v_add_f32 v21, v15, -v12
    v_add_f32 v10, v10, -v17
    v_add_f32 v15, v15, v12
    v_mul_f32 v12, 0xbf3504f3, v7
    v_mul_f32 v17, 0x3f3504f3, v7
    v_fmac_f32 v12, 0xbf3504f3, v19
    v_fmac_f32 v17, 0xbf3504f3, v19
    v_add_f32 v7, v6, -v12
    v_add_f32 v19, v18, -v17
    v_add_f32 v6, v6, v12
    v_add_f32 v18, v18, v17
    ds_write_b64 v37, v[4:5] offset:16384
    v_mov_b32 v4, v14
    v_mov_b32 v5, v16
    ds_write_b64 v37, v[4:5] offset:16896
    v_mov_b32 v4, v10
    v_mov_b32 v5, v15
    ds_write_b64 v37, v[4:5] offset:17408
    v_mov_b32 v4, v6
    v_mov_b32 v5, v18
    ds_write_b64 v37, v[4:5] offset:17920
    v_mov_b32 v4, v9
    v_mov_b32 v5, v13
    ds_write_b64 v37, v[4:5] offset:18432
    v_mov_b32 v4, v8
    v_mov_b32 v5, v11
    ds_write_b64 v37, v[4:5] offset:18944
    ds_write_b64 v37, v[20:21] offset:19456
    v_mov_b32 v4, v7
    v_mov_b32 v5, v19
    ds_write_b64 v37, v[4:5] offset:19968
    s_waitcnt lgkmcnt(0)
    s_barrier
    ds_read_b64 v[4:5], v2 offset:16384
    ds_read_b64 v[6:7], v2 offset:18432
    ds_read_b64 v[8:9], v2 offset:20480
    ds_read_b64 v[10:11], v2 offset:22528
    ds_read_b64 v[12:13], v2 offset:24576
    ds_read_b64 v[14:15], v2 offset:26624
    ds_read_b64 v[16:17], v2 offset:28672
    ds_read_b64 v[18:19], v2 offset:30720
    s_waitcnt lgkmcnt(0)
    v_mul_f32 v20, 0x3a000000, v40
    v_cos_f32 v21, v20
    v_sin_f32 v22, v20
    v_mul_f32 v20, v8, v21
    v_mul_f32 v23, v8, v22
    v_fma_f32 v20, -v9, v22, v20
    v_fma_f32 v23, v9, v21, v23
    v_mul_f32 v8, 0x3a800000, v40
    v_cos_f32 v9, v8
    v_sin_f32 v21, v8
    v_mul_f32 v8, v12, v9
    v_mul_f32 v22, v12, v21
    v_fma_f32 v8, -v13, v21, v8
    v_fma_f32 v22, v13, v9, v22
    v_mul_f32 v9, 0x3ac00000, v40
    v_cos_f32 v12, v9
    v_sin_f32 v13, v9
    v_mul_f32 v9, v16, v12
    v_mul_f32 v21, v16, v13
    v_fma_f32 v9, -v17, v13, v9
    v_fma_f32 v21, v17, v12, v21
    v_add_f32 v12, v4, -v8
    v_add_f32 v13, v5, -v22
    v_add_f32 v4, v4, v8
    v_add_f32 v5, v5, v22
    v_add_f32 v8, v20, -v9
    v_add_f32 v16, v23, -v21
    v_add_f32 v20, v20, v9
    v_add_f32 v23, v23, v21
    v_add_f32 v9, v4, -v20
    v_add_f32 v17, v5, -v23
    v_add_f32 v4, v4, v20
    v_add_f32 v5, v5, v23
    v_add_f32 v20, v12, v16
    v_add_f32 v21, v13, -v8
    v_add_f32 v12, v12, -v16
    v_add_f32 v13, v13, v8
    v_mul_f32 v8, 0x3a000000, v41
    v_cos_f32 v16, v8
    v_sin_f32 v22, v8
    v_mul_f32 v8, v10, v16
    v_mul_f32 v23, v10, v22
    v_fma_f32 v8, -v11, v22, v8
    v_fma_f32 v23, v11, v16, v23
    v_mul_f32 v10, 0x3a800000, v41
    v_cos_f32 v11, v10
    v_sin_f32 v16, v10
    v_mul_f32 v10, v14, v11
    v_mul_f32 v22, v14, v16
    v_fma_f32 v10, -v15, v16, v10
    v_fma_f32 v22, v15, v11, v22
    v_mul_f32 v11, 0x3ac00000, v41
    v_cos_f32 v14, v11
    v_sin_f32 v15, v11
    v_mul_f32 v11, v18, v14
    v_mul_f32 v16, v18, v15
    v_fma_f32 v11, -v19, v15, v11
    v_fma_f32 v16, v19, v14, v16
    v_add_f32 v14, v6, -v10
    v_add_f32 v15, v7, -v22
    v_add_f32 v6, v6, v10
    v_add_f32 v7, v7, v22
    v_add_f32 v10, v8, -v11
    v_add_f32 v18, v23, -v16
    v_add_f32 v8, v8, v11
    v_add_f32 v23, v23, v16
    v_add_f32 v11, v6, -v8
    v_add_f32 v16, v7, -v23
    v_add_f32 v6, v6, v8
    v_add_f32 v7, v7, v23
    v_add_f32 v8, v14, v18
    v_add_f32 v19, v15, -v10
    v_add_f32 v14, v14, -v18
    v_add_f32 v15, v15, v10
    buffer_store_dwordx2 v[4:5], v2, s[8:11], s32 offen
    buffer_store_dwordx2 v[6:7], v2, s[8:11], s33 offen
    buffer_store_dwordx2 v[12:13], v2, s[8:11], s34 offen
    buffer_store_dwordx2 v[14:15], v2, s[8:11], s35 offen
    v_mov_b32 v4, v9
    v_mov_b32 v5, v17
    buffer_store_dwordx2 v[4:5], v2, s[8:11], s36 offen
    v_mov_b32 v4, v11
    v_mov_b32 v5, v16
    buffer_store_dwordx2 v[4:5], v2, s[8:11], s37 offen
    buffer_store_dwordx2 v[20:21], v2, s[8:11], s38 offen
    v_mov_b32 v4, v8
    v_mov_b32 v5, v19
    buffer_store_dwordx2 v[4:5], v2, s[8:11], s39 offen
k2b_kernel_end:
    s_endpgm
.globl k3b_kernel
.p2align 8
.type k3b_kernel,@function
k3b_kernel:
    s_cmp_ge_u32 s2, 256
    s_cbranch_scc1 k3b_kernel_end
    s_load_dwordx2 s[4:5], s[0:1], 72
    s_load_dwordx2 s[6:7], s[0:1], 72
    v_lshrrev_b32 v1, 6, v0
    s_nop 0
    v_readfirstlane_b32 s20, v1
    v_and_b32 v2, 63, v0
    s_waitcnt lgkmcnt(0)
    s_add_u32 s4, s4, 0x1800000
    s_addc_u32 s5, s5, 0
    s_mov_b32 s8, s4
    s_and_b32 s9, s5, 0xffff
    s_mov_b32 s10, 0x280000
    s_mov_b32 s11, 0x00020000
    s_mov_b32 s28, s6
    s_mov_b32 s29, s7
    s_mov_b32 s12, s6
    s_and_b32 s13, s7, 0xffff
    s_mov_b32 s14, 0x504000
    s_mov_b32 s15, 0x00020000
    s_mov_b32 s6, s28
    s_mov_b32 s7, s29
    s_add_u32 s6, s6, 0x800000
    s_addc_u32 s7, s7, 0
    s_mov_b32 s32, s6
    s_and_b32 s33, s7, 0xffff
    s_mov_b32 s34, 0x280000
    s_mov_b32 s35, 0x00020000
    s_add_u32 s28, s28, 0xc00000
    s_addc_u32 s29, s29, 0
    s_mov_b32 s36, s28
    s_and_b32 s37, s29, 0xffff
    s_mov_b32 s38, 0x280000
    s_mov_b32 s39, 0x00020000
    v_lshlrev_b32 v3, 1, v2
    s_mul_i32 s21, s2, 10240
    s_mul_i32 s22, s20, 2560
    s_add_u32 s21, s21, s22
    s_cmp_ge_u32 s20, 4
    s_cbranch_scc1 k3b_kernel_p0
    buffer_load_ushort v4, v3, s[8:11], s21 offen offset:0
    buffer_load_ushort v14, v3, s[8:11], s21 offen offset:1280
    buffer_load_ushort v5, v3, s[8:11], s21 offen offset:128
    buffer_load_ushort v15, v3, s[8:11], s21 offen offset:1408
    buffer_load_ushort v6, v3, s[8:11], s21 offen offset:256
    buffer_load_ushort v16, v3, s[8:11], s21 offen offset:1536
    buffer_load_ushort v7, v3, s[8:11], s21 offen offset:384
    buffer_load_ushort v17, v3, s[8:11], s21 offen offset:1664
    buffer_load_ushort v8, v3, s[8:11], s21 offen offset:512
    buffer_load_ushort v18, v3, s[8:11], s21 offen offset:1792
    buffer_load_ushort v9, v3, s[8:11], s21 offen offset:640
    buffer_load_ushort v19, v3, s[8:11], s21 offen offset:1920
    buffer_load_ushort v10, v3, s[8:11], s21 offen offset:768
    buffer_load_ushort v20, v3, s[8:11], s21 offen offset:2048
    buffer_load_ushort v11, v3, s[8:11], s21 offen offset:896
    buffer_load_ushort v21, v3, s[8:11], s21 offen offset:2176
    buffer_load_ushort v12, v3, s[8:11], s21 offen offset:1024
    buffer_load_ushort v22, v3, s[8:11], s21 offen offset:2304
    buffer_load_ushort v13, v3, s[8:11], s21 offen offset:1152
    buffer_load_ushort v23, v3, s[8:11], s21 offen offset:2432
k3b_kernel_p0:
    v_lshlrev_b32 v24, 14, v0
    s_lshl_b32 s22, s2, 6
    buffer_load_dwordx4 v[28:31], v24, s[12:15], s22 offen offset:0
    buffer_load_dwordx4 v[32:35], v24, s[12:15], s22 offen offset:16
    buffer_load_dwordx4 v[36:39], v24, s[12:15], s22 offen offset:32
    buffer_load_dwordx4 v[40:43], v24, s[12:15], s22 offen offset:48
    v_lshlrev_b32 v24, 3, v0
    v_sub_u32 v25, 640, v0
    v_cmp_eq_u32 vcc, 0, v0
    s_nop 1
    v_cndmask_b32 v25, v25, 0, vcc
    v_lshlrev_b32 v25, 3, v25
    s_waitcnt vmcnt(0)
    v_cndmask_b32 v29, v29, 0, vcc
    v_cndmask_b32 v31, v31, 0, vcc
    v_sub_f32 v26, v28, v31
    v_add_f32 v27, v29, v30
    v_add_f32 v44, v28, v31
    v_sub_f32 v45, v30, v29
    ds_write_b64 v24, v[26:27] offset:0
    ds_write_b64 v25, v[44:45] offset:0
    v_cndmask_b32 v33, v33, 0, vcc
    v_cndmask_b32 v35, v35, 0, vcc
    v_sub_f32 v26, v32, v35
    v_add_f32 v27, v33, v34
    v_add_f32 v44, v32, v35
    v_sub_f32 v45, v34, v33
    ds_write_b64 v24, v[26:27] offset:5120
    ds_write_b64 v25, v[44:45] offset:5120
    v_cndmask_b32 v37, v37, 0, vcc
    v_cndmask_b32 v39, v39, 0, vcc
    v_sub_f32 v26, v36, v39
    v_add_f32 v27, v37, v38
    v_add_f32 v44, v36, v39
    v_sub_f32 v45, v38, v37
    ds_write_b64 v24, v[26:27] offset:10240
    ds_write_b64 v25, v[44:45] offset:10240
    v_cndmask_b32 v41, v41, 0, vcc
    v_cndmask_b32 v43, v43, 0, vcc
    v_sub_f32 v26, v40, v43
    v_add_f32 v27, v41, v42
    v_add_f32 v44, v40, v43
    v_sub_f32 v45, v42, v41
    ds_write_b64 v24, v[26:27] offset:15360
    ds_write_b64 v25, v[44:45] offset:15360
    v_cmp_eq_u32 vcc, 0, v0
    s_and_saveexec_b64 s[24:25], vcc
    s_cbranch_execz k3b_kernel_skip320
    v_mov_b32 v24, 320
    v_lshlrev_b32 v25, 14, v24
    s_lshl_b32 s22, s2, 6
    buffer_load_dwordx4 v[28:31], v25, s[12:15], s22 offen offset:0
    buffer_load_dwordx4 v[32:35], v25, s[12:15], s22 offen offset:16
    buffer_load_dwordx4 v[36:39], v25, s[12:15], s22 offen offset:32
    buffer_load_dwordx4 v[40:43], v25, s[12:15], s22 offen offset:48
    v_lshlrev_b32 v25, 3, v24
    v_sub_u32 v26, 640, v24
    v_cmp_eq_u32 vcc, 0, v24
    s_nop 1
    v_cndmask_b32 v26, v26, 0, vcc
    v_lshlrev_b32 v26, 3, v26
    v_cmp_eq_u32 vcc, 320, v24
    s_waitcnt vmcnt(0)
    s_nop 0
    v_cndmask_b32 v29, v29, 0, vcc
    v_cndmask_b32 v31, v31, 0, vcc
    v_sub_f32 v44, v28, v31
    v_add_f32 v45, v29, v30
    v_add_f32 v46, v28, v31
    v_sub_f32 v47, v30, v29
    ds_write_b64 v25, v[44:45] offset:0
    ds_write_b64 v26, v[46:47] offset:0
    v_cndmask_b32 v33, v33, 0, vcc
    v_cndmask_b32 v35, v35, 0, vcc
    v_sub_f32 v44, v32, v35
    v_add_f32 v45, v33, v34
    v_add_f32 v46, v32, v35
    v_sub_f32 v47, v34, v33
    ds_write_b64 v25, v[44:45] offset:5120
    ds_write_b64 v26, v[46:47] offset:5120
    v_cndmask_b32 v37, v37, 0, vcc
    v_cndmask_b32 v39, v39, 0, vcc
    v_sub_f32 v44, v36, v39
    v_add_f32 v45, v37, v38
    v_add_f32 v46, v36, v39
    v_sub_f32 v47, v38, v37
    ds_write_b64 v25, v[44:45] offset:10240
    ds_write_b64 v26, v[46:47] offset:10240
    v_cndmask_b32 v41, v41, 0, vcc
    v_cndmask_b32 v43, v43, 0, vcc
    v_sub_f32 v44, v40, v43
    v_add_f32 v45, v41, v42
    v_add_f32 v46, v40, v43
    v_sub_f32 v47, v42, v41
    ds_write_b64 v25, v[44:45] offset:15360
    ds_write_b64 v26, v[46:47] offset:15360
k3b_kernel_skip320:
    s_mov_b64 exec, s[24:25]
    v_mul_u32_u24 v24, 205, v0
    v_lshrrev_b32 v24, 14, v24
    v_mul_u32_u24 v25, 80, v24
    v_sub_u32 v25, v0, v25
    v_mul_u32_u24 v24, 5120, v24
    v_lshlrev_b32 v28, 3, v25
    v_add_u32 v28, v28, v24
    v_lshlrev_b32 v29, 6, v25
    v_add_u32 v29, v29, v24
    v_lshrrev_b32 v26, 3, v25
    v_and_b32 v27, 7, v25
    v_lshlrev_b32 v30, 6, v26
    v_add_u32 v30, v30, v27
    v_lshlrev_b32 v30, 3, v30
    v_add_u32 v30, v30, v24
    v_cvt_f32_u32 v31, v27
    s_waitcnt lgkmcnt(0)
    s_barrier
    ds_read_b64 v[32:33], v28 offset:0
    ds_read_b64 v[34:35], v28 offset:640
    ds_read_b64 v[36:37], v28 offset:1280
    ds_read_b64 v[38:39], v28 offset:1920
    ds_read_b64 v[40:41], v28 offset:2560
    ds_read_b64 v[42:43], v28 offset:3200
    ds_read_b64 v[44:45], v28 offset:3840
    ds_read_b64 v[46:47], v28 offset:4480
    s_waitcnt lgkmcnt(0)
    v_add_f32 v48, v32, -v40
    v_add_f32 v49, v33, -v41
    v_add_f32 v32, v32, v40
    v_add_f32 v33, v33, v41
    v_add_f32 v40, v36, -v44
    v_add_f32 v41, v37, -v45
    v_add_f32 v36, v36, v44
    v_add_f32 v37, v37, v45
    v_add_f32 v44, v32, -v36
    v_add_f32 v45, v33, -v37
    v_add_f32 v32, v32, v36
    v_add_f32 v33, v33, v37
    v_add_f32 v36, v48, v41
    v_add_f32 v37, v49, -v40
    v_add_f32 v48, v48, -v41
    v_add_f32 v49, v49, v40
    v_add_f32 v40, v34, -v42
    v_add_f32 v41, v35, -v43
    v_add_f32 v34, v34, v42
    v_add_f32 v35, v35, v43
    v_add_f32 v42, v38, -v46
    v_add_f32 v43, v39, -v47
    v_add_f32 v38, v38, v46
    v_add_f32 v39, v39, v47
    v_add_f32 v46, v34, -v38
    v_add_f32 v47, v35, -v39
    v_add_f32 v34, v34, v38
    v_add_f32 v35, v35, v39
    v_add_f32 v38, v40, v43
    v_add_f32 v39, v41, -v42
    v_add_f32 v40, v40, -v43
    v_add_f32 v41, v41, v42
    v_add_f32 v42, v32, -v34
    v_add_f32 v43, v33, -v35
    v_add_f32 v32, v32, v34
    v_add_f32 v33, v33, v35
    v_mul_f32 v34, 0x3f3504f3, v40
    v_mul_f32 v35, 0x3f3504f3, v40
    v_fmac_f32 v34, 0xbf3504f3, v41
    v_fmac_f32 v35, 0x3f3504f3, v41
    v_add_f32 v40, v48, -v34
    v_add_f32 v41, v49, -v35
    v_add_f32 v48, v48, v34
    v_add_f32 v49, v49, v35
    v_add_f32 v34, v44, v47
    v_add_f32 v35, v45, -v46
    v_add_f32 v44, v44, -v47
    v_add_f32 v45, v45, v46
    v_mul_f32 v46, 0xbf3504f3, v38
    v_mul_f32 v47, 0x3f3504f3, v38
    v_fmac_f32 v46, 0xbf3504f3, v39
    v_fmac_f32 v47, 0xbf3504f3, v39
    v_add_f32 v38, v36, -v46
    v_add_f32 v39, v37, -v47
    v_add_f32 v36, v36, v46
    v_add_f32 v37, v37, v47
    ds_write_b64 v29, v[32:33] offset:20480
    ds_write_b64 v29, v[48:49] offset:20488
    ds_write_b64 v29, v[44:45] offset:20496
    ds_write_b64 v29, v[36:37] offset:20504
    ds_write_b64 v29, v[42:43] offset:20512
    ds_write_b64 v29, v[40:41] offset:20520
    ds_write_b64 v29, v[34:35] offset:20528
    ds_write_b64 v29, v[38:39] offset:20536
    s_waitcnt lgkmcnt(0)
    s_barrier
    ds_read_b64 v[32:33], v28 offset:20480
    ds_read_b64 v[34:35], v28 offset:21120
    ds_read_b64 v[36:37], v28 offset:21760
    ds_read_b64 v[38:39], v28 offset:22400
    ds_read_b64 v[40:41], v28 offset:23040
    ds_read_b64 v[42:43], v28 offset:23680
    ds_read_b64 v[44:45], v28 offset:24320
    ds_read_b64 v[46:47], v28 offset:24960
    s_waitcnt lgkmcnt(0)
    v_mul_f32 v48, 0x3c800000, v31
    v_cos_f32 v49, v48
    v_sin_f32 v50, v48
    v_mul_f32 v48, v34, v49
    v_mul_f32 v51, v34, v50
    v_fma_f32 v48, -v35, v50, v48
    v_fma_f32 v51, v35, v49, v51
    v_mul_f32 v34, 0x3d000000, v31
    v_cos_f32 v35, v34
    v_sin_f32 v49, v34
    v_mul_f32 v34, v36, v35
    v_mul_f32 v50, v36, v49
    v_fma_f32 v34, -v37, v49, v34
    v_fma_f32 v50, v37, v35, v50
    v_mul_f32 v35, 0x3d400000, v31
    v_cos_f32 v36, v35
    v_sin_f32 v37, v35
    v_mul_f32 v35, v38, v36
    v_mul_f32 v49, v38, v37
    v_fma_f32 v35, -v39, v37, v35
    v_fma_f32 v49, v39, v36, v49
    v_mul_f32 v36, 0x3d800000, v31
    v_cos_f32 v37, v36
    v_sin_f32 v38, v36
    v_mul_f32 v36, v40, v37
    v_mul_f32 v39, v40, v38
    v_fma_f32 v36, -v41, v38, v36
    v_fma_f32 v39, v41, v37, v39
    v_mul_f32 v37, 0x3da00000, v31
    v_cos_f32 v38, v37
    v_sin_f32 v40, v37
    v_mul_f32 v37, v42, v38
    v_mul_f32 v41, v42, v40
    v_fma_f32 v37, -v43, v40, v37
    v_fma_f32 v41, v43, v38, v41
    v_mul_f32 v38, 0x3dc00000, v31
    v_cos_f32 v40, v38
    v_sin_f32 v42, v38
    v_mul_f32 v38, v44, v40
    v_mul_f32 v43, v44, v42
    v_fma_f32 v38, -v45, v42, v38
    v_fma_f32 v43, v45, v40, v43
    v_mul_f32 v40, 0x3de00000, v31
    v_cos_f32 v42, v40
    v_sin_f32 v44, v40
    v_mul_f32 v40, v46, v42
    v_mul_f32 v45, v46, v44
    v_fma_f32 v40, -v47, v44, v40
    v_fma_f32 v45, v47, v42, v45
    v_add_f32 v42, v32, -v36
    v_add_f32 v44, v33, -v39
    v_add_f32 v32, v32, v36
    v_add_f32 v33, v33, v39
    v_add_f32 v36, v34, -v38
    v_add_f32 v39, v50, -v43
    v_add_f32 v34, v34, v38
    v_add_f32 v50, v50, v43
    v_add_f32 v38, v32, -v34
    v_add_f32 v43, v33, -v50
    v_add_f32 v32, v32, v34
    v_add_f32 v33, v33, v50
    v_add_f32 v34, v42, v39
    v_add_f32 v46, v44, -v36
    v_add_f32 v42, v42, -v39
    v_add_f32 v44, v44, v36
    v_add_f32 v36, v48, -v37
    v_add_f32 v39, v51, -v41
    v_add_f32 v48, v48, v37
    v_add_f32 v51, v51, v41
    v_add_f32 v37, v35, -v40
    v_add_f32 v41, v49, -v45
    v_add_f32 v35, v35, v40
    v_add_f32 v49, v49, v45
    v_add_f32 v40, v48, -v35
    v_add_f32 v45, v51, -v49
    v_add_f32 v48, v48, v35
    v_add_f32 v51, v51, v49
    v_add_f32 v35, v36, v41
    v_add_f32 v47, v39, -v37
    v_add_f32 v36, v36, -v41
    v_add_f32 v39, v39, v37
    v_add_f32 v37, v32, -v48
    v_add_f32 v41, v33, -v51
    v_add_f32 v32, v32, v48
    v_add_f32 v33, v33, v51
    v_mul_f32 v48, 0x3f3504f3, v36
    v_mul_f32 v49, 0x3f3504f3, v36
    v_fmac_f32 v48, 0xbf3504f3, v39
    v_fmac_f32 v49, 0x3f3504f3, v39
    v_add_f32 v36, v42, -v48
    v_add_f32 v39, v44, -v49
    v_add_f32 v42, v42, v48
    v_add_f32 v44, v44, v49
    v_add_f32 v48, v38, v45
    v_add_f32 v49, v43, -v40
    v_add_f32 v38, v38, -v45
    v_add_f32 v43, v43, v40
    v_mul_f32 v40, 0xbf3504f3, v35
    v_mul_f32 v45, 0x3f3504f3, v35
    v_fmac_f32 v40, 0xbf3504f3, v47
    v_fmac_f32 v45, 0xbf3504f3, v47
    v_add_f32 v35, v34, -v40
    v_add_f32 v47, v46, -v45
    v_add_f32 v34, v34, v40
    v_add_f32 v46, v46, v45
    ds_write_b64 v30, v[32:33] offset:0
    v_mov_b32 v32, v42
    v_mov_b32 v33, v44
    ds_write_b64 v30, v[32:33] offset:64
    v_mov_b32 v32, v38
    v_mov_b32 v33, v43
    ds_write_b64 v30, v[32:33] offset:128
    v_mov_b32 v32, v34
    v_mov_b32 v33, v46
    ds_write_b64 v30, v[32:33] offset:192
    v_mov_b32 v32, v37
    v_mov_b32 v33, v41
    ds_write_b64 v30, v[32:33] offset:256
    v_mov_b32 v32, v36
    v_mov_b32 v33, v39
    ds_write_b64 v30, v[32:33] offset:320
    ds_write_b64 v30, v[48:49] offset:384
    v_mov_b32 v32, v35
    v_mov_b32 v33, v47
    ds_write_b64 v30, v[32:33] offset:448
    s_waitcnt lgkmcnt(0)
    s_barrier
    s_cmp_ge_u32 s20, 4
    s_cbranch_scc1 k3b_kernel_end
    v_lshlrev_b32 v24, 3, v2
    s_mul_i32 s22, s20, 5120
    v_add_u32 v24, s22, v24
    v_cvt_f32_u32 v25, v2
    ds_read_b64 v[26:27], v24 offset:0
    ds_read_b64 v[28:29], v24 offset:512
    ds_read_b64 v[30:31], v24 offset:1024
    ds_read_b64 v[32:33], v24 offset:1536
    ds_read_b64 v[34:35], v24 offset:2048
    ds_read_b64 v[36:37], v24 offset:2560
    ds_read_b64 v[38:39], v24 offset:3072
    ds_read_b64 v[40:41], v24 offset:3584
    ds_read_b64 v[42:43], v24 offset:4096
    ds_read_b64 v[44:45], v24 offset:4608
    s_waitcnt lgkmcnt(0)
    v_mul_f32 v46, 0x3acccccd, v25
    v_cos_f32 v47, v46
    v_sin_f32 v48, v46
    v_mul_f32 v46, v28, v47
    v_mul_f32 v49, v28, v48
    v_fma_f32 v46, -v29, v48, v46
    v_fma_f32 v49, v29, v47, v49
    v_mul_f32 v28, 0x3b4ccccd, v25
    v_cos_f32 v29, v28
    v_sin_f32 v47, v28
    v_mul_f32 v28, v30, v29
    v_mul_f32 v48, v30, v47
    v_fma_f32 v28, -v31, v47, v28
    v_fma_f32 v48, v31, v29, v48
    v_mul_f32 v29, 0x3b99999a, v25
    v_cos_f32 v30, v29
    v_sin_f32 v31, v29
    v_mul_f32 v29, v32, v30
    v_mul_f32 v47, v32, v31
    v_fma_f32 v29, -v33, v31, v29
    v_fma_f32 v47, v33, v30, v47
    v_mul_f32 v30, 0x3bcccccd, v25
    v_cos_f32 v31, v30
    v_sin_f32 v32, v30
    v_mul_f32 v30, v34, v31
    v_mul_f32 v33, v34, v32
    v_fma_f32 v30, -v35, v32, v30
    v_fma_f32 v33, v35, v31, v33
    v_mul_f32 v31, 0x3c000000, v25
    v_cos_f32 v32, v31
    v_sin_f32 v34, v31
    v_mul_f32 v31, v36, v32
    v_mul_f32 v35, v36, v34
    v_fma_f32 v31, -v37, v34, v31
    v_fma_f32 v35, v37, v32, v35
    v_mul_f32 v32, 0x3c19999a, v25
    v_cos_f32 v34, v32
    v_sin_f32 v36, v32
    v_mul_f32 v32, v38, v34
    v_mul_f32 v37, v38, v36
    v_fma_f32 v32, -v39, v36, v32
    v_fma_f32 v37, v39, v34, v37
    v_mul_f32 v34, 0x3c333333, v25
    v_cos_f32 v36, v34
    v_sin_f32 v38, v34
    v_mul_f32 v34, v40, v36
    v_mul_f32 v39, v40, v38
    v_fma_f32 v34, -v41, v38, v34
    v_fma_f32 v39, v41, v36, v39
    v_mul_f32 v36, 0x3c4ccccd, v25
    v_cos_f32 v38, v36
    v_sin_f32 v40, v36
    v_mul_f32 v36, v42, v38
    v_mul_f32 v41, v42, v40
    v_fma_f32 v36, -v43, v40, v36
    v_fma_f32 v41, v43, v38, v41
    v_mul_f32 v38, 0x3c666666, v25
    v_cos_f32 v40, v38
    v_sin_f32 v42, v38
    v_mul_f32 v38, v44, v40
    v_mul_f32 v43, v44, v42
    v_fma_f32 v38, -v45, v42, v38
    v_fma_f32 v43, v45, v40, v43
    v_add_f32 v40, v28, v36
    v_add_f32 v42, v48, v41
    v_add_f32 v44, v28, -v36
    v_add_f32 v45, v48, -v41
    v_add_f32 v50, v30, v32
    v_add_f32 v51, v33, v37
    v_add_f32 v52, v30, -v32
    v_add_f32 v53, v33, -v37
    v_mov_b32 v28, v26
    v_fmac_f32 v28, 0x3e9e377a, v40
    v_fmac_f32 v28, 0xbf4f1bbd, v50
    v_mov_b32 v30, v27
    v_fmac_f32 v30, 0x3e9e377a, v42
    v_fmac_f32 v30, 0xbf4f1bbd, v51
    v_mov_b32 v32, v26
    v_fmac_f32 v32, 0xbf4f1bbd, v40
    v_fmac_f32 v32, 0x3e9e377a, v50
    v_mov_b32 v33, v27
    v_fmac_f32 v33, 0xbf4f1bbd, v42
    v_fmac_f32 v33, 0x3e9e377a, v51
    v_mul_f32 v36, 0x3f737871, v44
    v_fmac_f32 v36, 0x3f167918, v52
    v_mul_f32 v37, 0x3f737871, v45
    v_fmac_f32 v37, 0x3f167918, v53
    v_mul_f32 v41, 0x3f167918, v44
    v_fmac_f32 v41, 0xbf737871, v52
    v_mul_f32 v48, 0x3f167918, v45
    v_fmac_f32 v48, 0xbf737871, v53
    v_add_f32 v54, v40, v50
    v_add_f32 v55, v42, v51
    v_add_f32 v56, v26, v54
    v_add_f32 v57, v27, v55
    v_add_f32 v26, v28, -v37
    v_add_f32 v27, v30, v36
    v_add_f32 v40, v28, v37
    v_add_f32 v42, v30, -v36
    v_add_f32 v44, v32, -v48
    v_add_f32 v45, v33, v41
    v_add_f32 v50, v32, v48
    v_add_f32 v51, v33, -v41
    v_add_f32 v28, v29, v38
    v_add_f32 v30, v47, v43
    v_add_f32 v32, v29, -v38
    v_add_f32 v33, v47, -v43
    v_add_f32 v36, v31, v34
    v_add_f32 v37, v35, v39
    v_add_f32 v41, v31, -v34
    v_add_f32 v48, v35, -v39
    v_mov_b32 v29, v46
    v_fmac_f32 v29, 0x3e9e377a, v28
    v_fmac_f32 v29, 0xbf4f1bbd, v36
    v_mov_b32 v31, v49
    v_fmac_f32 v31, 0x3e9e377a, v30
    v_fmac_f32 v31, 0xbf4f1bbd, v37
    v_mov_b32 v34, v46
    v_fmac_f32 v34, 0xbf4f1bbd, v28
    v_fmac_f32 v34, 0x3e9e377a, v36
    v_mov_b32 v35, v49
    v_fmac_f32 v35, 0xbf4f1bbd, v30
    v_fmac_f32 v35, 0x3e9e377a, v37
    v_mul_f32 v38, 0x3f737871, v32
    v_fmac_f32 v38, 0x3f167918, v41
    v_mul_f32 v39, 0x3f737871, v33
    v_fmac_f32 v39, 0x3f167918, v48
    v_mul_f32 v43, 0x3f167918, v32
    v_fmac_f32 v43, 0xbf737871, v41
    v_mul_f32 v47, 0x3f167918, v33
    v_fmac_f32 v47, 0xbf737871, v48
    v_add_f32 v52, v28, v36
    v_add_f32 v53, v30, v37
    v_add_f32 v54, v46, v52
    v_add_f32 v55, v49, v53
    v_add_f32 v28, v29, -v39
    v_add_f32 v30, v31, v38
    v_add_f32 v32, v29, v39
    v_add_f32 v33, v31, -v38
    v_add_f32 v36, v34, -v47
    v_add_f32 v37, v35, v43
    v_add_f32 v41, v34, v47
    v_add_f32 v46, v35, -v43
    v_add_f32 v29, v56, -v54
    v_add_f32 v31, v57, -v55
    v_add_f32 v56, v56, v54
    v_add_f32 v57, v57, v55
    v_mul_f32 v34, 0x3f4f1bbd, v28
    v_mul_f32 v35, 0x3f167918, v28
    v_fmac_f32 v34, 0xbf167918, v30
    v_fmac_f32 v35, 0x3f4f1bbd, v30
    v_add_f32 v28, v26, -v34
    v_add_f32 v30, v27, -v35
    v_add_f32 v26, v26, v34
    v_add_f32 v27, v27, v35
    v_mul_f32 v34, 0x3e9e377a, v36
    v_mul_f32 v35, 0x3f737871, v36
    v_fmac_f32 v34, 0xbf737871, v37
    v_fmac_f32 v35, 0x3e9e377a, v37
    v_add_f32 v36, v44, -v34
    v_add_f32 v37, v45, -v35
    v_add_f32 v44, v44, v34
    v_add_f32 v45, v45, v35
    v_mul_f32 v34, 0xbe9e377a, v41
    v_mul_f32 v35, 0x3f737871, v41
    v_fmac_f32 v34, 0xbf737871, v46
    v_fmac_f32 v35, 0xbe9e377a, v46
    v_add_f32 v38, v50, -v34
    v_add_f32 v39, v51, -v35
    v_add_f32 v50, v50, v34
    v_add_f32 v51, v51, v35
    v_mul_f32 v34, 0xbf4f1bbd, v32
    v_mul_f32 v35, 0x3f167918, v32
    v_fmac_f32 v34, 0xbf167918, v33
    v_fmac_f32 v35, 0xbf4f1bbd, v33
    v_add_f32 v32, v40, -v34
    v_add_f32 v33, v42, -v35
    v_add_f32 v40, v40, v34
    v_add_f32 v42, v42, v35
    s_waitcnt vmcnt(0)
    v_cvt_pk_bf16_f32 v24, v56, v56
    v_lshlrev_b32 v56, 16, v24
    v_lshlrev_b32 v4, 16, v4
    v_add_f32 v4, v4, v56
    v_cvt_pk_bf16_f32 v24, v4, v4
    v_lshlrev_b32 v4, 16, v24
    v_cvt_pk_bf16_f32 v24, v57, v57
    v_lshlrev_b32 v57, 16, v24
    v_lshlrev_b32 v14, 16, v14
    v_add_f32 v14, v14, v57
    v_cvt_pk_bf16_f32 v24, v14, v14
    v_lshlrev_b32 v14, 16, v24
    v_cvt_pk_bf16_f32 v24, v26, v26
    v_lshlrev_b32 v26, 16, v24
    v_lshlrev_b32 v5, 16, v5
    v_add_f32 v5, v5, v26
    v_cvt_pk_bf16_f32 v24, v5, v5
    v_lshlrev_b32 v5, 16, v24
    v_cvt_pk_bf16_f32 v24, v27, v27
    v_lshlrev_b32 v27, 16, v24
    v_lshlrev_b32 v15, 16, v15
    v_add_f32 v15, v15, v27
    v_cvt_pk_bf16_f32 v24, v15, v15
    v_lshlrev_b32 v15, 16, v24
    v_cvt_pk_bf16_f32 v24, v44, v44
    v_lshlrev_b32 v44, 16, v24
    v_lshlrev_b32 v6, 16, v6
    v_add_f32 v6, v6, v44
    v_cvt_pk_bf16_f32 v24, v6, v6
    v_lshlrev_b32 v6, 16, v24
    v_cvt_pk_bf16_f32 v24, v45, v45
    v_lshlrev_b32 v45, 16, v24
    v_lshlrev_b32 v16, 16, v16
    v_add_f32 v16, v16, v45
    v_cvt_pk_bf16_f32 v24, v16, v16
    v_lshlrev_b32 v16, 16, v24
    v_cvt_pk_bf16_f32 v24, v50, v50
    v_lshlrev_b32 v50, 16, v24
    v_lshlrev_b32 v7, 16, v7
    v_add_f32 v7, v7, v50
    v_cvt_pk_bf16_f32 v24, v7, v7
    v_lshlrev_b32 v7, 16, v24
    v_cvt_pk_bf16_f32 v24, v51, v51
    v_lshlrev_b32 v51, 16, v24
    v_lshlrev_b32 v17, 16, v17
    v_add_f32 v17, v17, v51
    v_cvt_pk_bf16_f32 v24, v17, v17
    v_lshlrev_b32 v17, 16, v24
    v_cvt_pk_bf16_f32 v24, v40, v40
    v_lshlrev_b32 v40, 16, v24
    v_lshlrev_b32 v8, 16, v8
    v_add_f32 v8, v8, v40
    v_cvt_pk_bf16_f32 v24, v8, v8
    v_lshlrev_b32 v8, 16, v24
    v_cvt_pk_bf16_f32 v24, v42, v42
    v_lshlrev_b32 v42, 16, v24
    v_lshlrev_b32 v18, 16, v18
    v_add_f32 v18, v18, v42
    v_cvt_pk_bf16_f32 v24, v18, v18
    v_lshlrev_b32 v18, 16, v24
    v_cvt_pk_bf16_f32 v24, v29, v29
    v_lshlrev_b32 v29, 16, v24
    v_lshlrev_b32 v9, 16, v9
    v_add_f32 v9, v9, v29
    v_cvt_pk_bf16_f32 v24, v9, v9
    v_lshlrev_b32 v9, 16, v24
    v_cvt_pk_bf16_f32 v24, v31, v31
    v_lshlrev_b32 v31, 16, v24
    v_lshlrev_b32 v19, 16, v19
    v_add_f32 v19, v19, v31
    v_cvt_pk_bf16_f32 v24, v19, v19
    v_lshlrev_b32 v19, 16, v24
    v_cvt_pk_bf16_f32 v24, v28, v28
    v_lshlrev_b32 v28, 16, v24
    v_lshlrev_b32 v10, 16, v10
    v_add_f32 v10, v10, v28
    v_cvt_pk_bf16_f32 v24, v10, v10
    v_lshlrev_b32 v10, 16, v24
    v_cvt_pk_bf16_f32 v24, v30, v30
    v_lshlrev_b32 v30, 16, v24
    v_lshlrev_b32 v20, 16, v20
    v_add_f32 v20, v20, v30
    v_cvt_pk_bf16_f32 v24, v20, v20
    v_lshlrev_b32 v20, 16, v24
    v_cvt_pk_bf16_f32 v24, v36, v36
    v_lshlrev_b32 v36, 16, v24
    v_lshlrev_b32 v11, 16, v11
    v_add_f32 v11, v11, v36
    v_cvt_pk_bf16_f32 v24, v11, v11
    v_lshlrev_b32 v11, 16, v24
    v_cvt_pk_bf16_f32 v24, v37, v37
    v_lshlrev_b32 v37, 16, v24
    v_lshlrev_b32 v21, 16, v21
    v_add_f32 v21, v21, v37
    v_cvt_pk_bf16_f32 v24, v21, v21
    v_lshlrev_b32 v21, 16, v24
    v_cvt_pk_bf16_f32 v24, v38, v38
    v_lshlrev_b32 v38, 16, v24
    v_lshlrev_b32 v12, 16, v12
    v_add_f32 v12, v12, v38
    v_cvt_pk_bf16_f32 v24, v12, v12
    v_lshlrev_b32 v12, 16, v24
    v_cvt_pk_bf16_f32 v24, v39, v39
    v_lshlrev_b32 v39, 16, v24
    v_lshlrev_b32 v22, 16, v22
    v_add_f32 v22, v22, v39
    v_cvt_pk_bf16_f32 v24, v22, v22
    v_lshlrev_b32 v22, 16, v24
    v_cvt_pk_bf16_f32 v24, v32, v32
    v_lshlrev_b32 v32, 16, v24
    v_lshlrev_b32 v13, 16, v13
    v_add_f32 v13, v13, v32
    v_cvt_pk_bf16_f32 v24, v13, v13
    v_lshlrev_b32 v13, 16, v24
    v_cvt_pk_bf16_f32 v24, v33, v33
    v_lshlrev_b32 v33, 16, v24
    v_lshlrev_b32 v23, 16, v23
    v_add_f32 v23, v23, v33
    v_cvt_pk_bf16_f32 v24, v23, v23
    v_lshlrev_b32 v23, 16, v24
    v_lshrrev_b32 v24, 16, v4
    buffer_store_short v24, v3, s[32:35], s21 offen offset:0
    v_lshrrev_b32 v24, 16, v14
    buffer_store_short v24, v3, s[32:35], s21 offen offset:1280
    v_lshrrev_b32 v24, 16, v5
    buffer_store_short v24, v3, s[32:35], s21 offen offset:128
    v_lshrrev_b32 v24, 16, v15
    buffer_store_short v24, v3, s[32:35], s21 offen offset:1408
    v_lshrrev_b32 v24, 16, v6
    buffer_store_short v24, v3, s[32:35], s21 offen offset:256
    v_lshrrev_b32 v24, 16, v16
    buffer_store_short v24, v3, s[32:35], s21 offen offset:1536
    v_lshrrev_b32 v24, 16, v7
    buffer_store_short v24, v3, s[32:35], s21 offen offset:384
    v_lshrrev_b32 v24, 16, v17
    buffer_store_short v24, v3, s[32:35], s21 offen offset:1664
    v_lshrrev_b32 v24, 16, v8
    buffer_store_short v24, v3, s[32:35], s21 offen offset:512
    v_lshrrev_b32 v24, 16, v18
    buffer_store_short v24, v3, s[32:35], s21 offen offset:1792
    v_lshrrev_b32 v24, 16, v9
    buffer_store_short v24, v3, s[32:35], s21 offen offset:640
    v_lshrrev_b32 v24, 16, v19
    buffer_store_short v24, v3, s[32:35], s21 offen offset:1920
    v_lshrrev_b32 v24, 16, v10
    buffer_store_short v24, v3, s[32:35], s21 offen offset:768
    v_lshrrev_b32 v24, 16, v20
    buffer_store_short v24, v3, s[32:35], s21 offen offset:2048
    v_lshrrev_b32 v24, 16, v11
    buffer_store_short v24, v3, s[32:35], s21 offen offset:896
    v_lshrrev_b32 v24, 16, v21
    buffer_store_short v24, v3, s[32:35], s21 offen offset:2176
    v_lshrrev_b32 v24, 16, v12
    buffer_store_short v24, v3, s[32:35], s21 offen offset:1024
    v_lshrrev_b32 v24, 16, v22
    buffer_store_short v24, v3, s[32:35], s21 offen offset:2304
    v_lshrrev_b32 v24, 16, v13
    buffer_store_short v24, v3, s[32:35], s21 offen offset:1152
    v_lshrrev_b32 v24, 16, v23
    buffer_store_short v24, v3, s[32:35], s21 offen offset:2432
    v_add_f32 v25, v4, v5
    v_add_f32 v25, v25, v6
    v_add_f32 v25, v25, v7
    v_add_f32 v25, v25, v8
    v_add_f32 v25, v25, v9
    v_add_f32 v25, v25, v10
    v_add_f32 v25, v25, v11
    v_add_f32 v25, v25, v12
    v_add_f32 v25, v25, v13
    v_add_f32 v26, v14, v15
    v_add_f32 v26, v26, v16
    v_add_f32 v26, v26, v17
    v_add_f32 v26, v26, v18
    v_add_f32 v26, v26, v19
    v_add_f32 v26, v26, v20
    v_add_f32 v26, v26, v21
    v_add_f32 v26, v26, v22
    v_add_f32 v26, v26, v23
    v_add_f32_dpp v25, v25, v25 quad_perm:[1,0,3,2] row_mask:0xf bank_mask:0xf
    s_nop 0
    v_add_f32_dpp v26, v26, v26 quad_perm:[1,0,3,2] row_mask:0xf bank_mask:0xf
    v_add_f32_dpp v25, v25, v25 quad_perm:[2,3,0,1] row_mask:0xf bank_mask:0xf
    s_nop 0
    v_add_f32_dpp v26, v26, v26 quad_perm:[2,3,0,1] row_mask:0xf bank_mask:0xf
    v_add_f32_dpp v25, v25, v25 row_ror:4 row_mask:0xf bank_mask:0xf
    s_nop 0
    v_add_f32_dpp v26, v26, v26 row_ror:4 row_mask:0xf bank_mask:0xf
    v_add_f32_dpp v25, v25, v25 row_ror:8 row_mask:0xf bank_mask:0xf
    s_nop 0
    v_add_f32_dpp v26, v26, v26 row_ror:8 row_mask:0xf bank_mask:0xf
    v_mov_b32 v27, v25
    v_mov_b32 v28, v26
    s_nop 0
    v_permlane16_swap_b32 v27, v25
    v_permlane16_swap_b32 v28, v26
    v_add_f32 v25, v25, v27
    v_add_f32 v26, v26, v28
    v_mov_b32 v27, v25
    v_mov_b32 v28, v26
    s_nop 0
    v_permlane32_swap_b32 v27, v25
    v_permlane32_swap_b32 v28, v26
    v_add_f32 v25, v25, v27
    v_add_f32 v26, v26, v28
    v_mul_f32 v25, 0x3acccccd, v25
    v_sub_f32 v31, v4, v25
    v_mul_f32 v29, v31, v31
    v_sub_f32 v31, v5, v25
    v_fmac_f32 v29, v31, v31
    v_sub_f32 v31, v6, v25
    v_fmac_f32 v29, v31, v31
    v_sub_f32 v31, v7, v25
    v_fmac_f32 v29, v31, v31
    v_sub_f32 v31, v8, v25
    v_fmac_f32 v29, v31, v31
    v_sub_f32 v31, v9, v25
    v_fmac_f32 v29, v31, v31
    v_sub_f32 v31, v10, v25
    v_fmac_f32 v29, v31, v31
    v_sub_f32 v31, v11, v25
    v_fmac_f32 v29, v31, v31
    v_sub_f32 v31, v12, v25
    v_fmac_f32 v29, v31, v31
    v_sub_f32 v31, v13, v25
    v_fmac_f32 v29, v31, v31
    v_mul_f32 v26, 0x3acccccd, v26
    v_sub_f32 v31, v14, v26
    v_mul_f32 v30, v31, v31
    v_sub_f32 v31, v15, v26
    v_fmac_f32 v30, v31, v31
    v_sub_f32 v31, v16, v26
    v_fmac_f32 v30, v31, v31
    v_sub_f32 v31, v17, v26
    v_fmac_f32 v30, v31, v31
    v_sub_f32 v31, v18, v26
    v_fmac_f32 v30, v31, v31
    v_sub_f32 v31, v19, v26
    v_fmac_f32 v30, v31, v31
    v_sub_f32 v31, v20, v26
    v_fmac_f32 v30, v31, v31
    v_sub_f32 v31, v21, v26
    v_fmac_f32 v30, v31, v31
    v_sub_f32 v31, v22, v26
    v_fmac_f32 v30, v31, v31
    v_sub_f32 v31, v23, v26
    v_fmac_f32 v30, v31, v31
    v_add_f32_dpp v29, v29, v29 quad_perm:[1,0,3,2] row_mask:0xf bank_mask:0xf
    s_nop 0
    v_add_f32_dpp v30, v30, v30 quad_perm:[1,0,3,2] row_mask:0xf bank_mask:0xf
    v_add_f32_dpp v29, v29, v29 quad_perm:[2,3,0,1] row_mask:0xf bank_mask:0xf
    s_nop 0
    v_add_f32_dpp v30, v30, v30 quad_perm:[2,3,0,1] row_mask:0xf bank_mask:0xf
    v_add_f32_dpp v29, v29, v29 row_ror:4 row_mask:0xf bank_mask:0xf
    s_nop 0
    v_add_f32_dpp v30, v30, v30 row_ror:4 row_mask:0xf bank_mask:0xf
    v_add_f32_dpp v29, v29, v29 row_ror:8 row_mask:0xf bank_mask:0xf
    s_nop 0
    v_add_f32_dpp v30, v30, v30 row_ror:8 row_mask:0xf bank_mask:0xf
    v_mov_b32 v27, v29
    v_mov_b32 v28, v30
    s_nop 0
    v_permlane16_swap_b32 v27, v29
    v_permlane16_swap_b32 v28, v30
    v_add_f32 v29, v29, v27
    v_add_f32 v30, v30, v28
    v_mov_b32 v27, v29
    v_mov_b32 v28, v30
    s_nop 0
    v_permlane32_swap_b32 v27, v29
    v_permlane32_swap_b32 v28, v30
    v_add_f32 v29, v29, v27
    v_add_f32 v30, v30, v28
    v_mul_f32 v29, 0x3acccccd, v29
    v_cvt_pk_bf16_f32 v31, v29, v29
    v_lshlrev_b32 v29, 16, v31
    v_add_f32 v29, 0x3727c5ac, v29
    v_cvt_pk_bf16_f32 v31, v29, v29
    v_lshlrev_b32 v29, 16, v31
    v_sqrt_f32 v29, v29
    s_nop 0
    v_cvt_pk_bf16_f32 v31, v29, v29
    v_lshlrev_b32 v29, 16, v31
    v_rcp_f32 v29, v29
    v_cvt_pk_bf16_f32 v31, v25, v25
    v_lshlrev_b32 v25, 16, v31
    v_sub_f32 v4, v4, v25
    v_cvt_pk_bf16_f32 v31, v4, v4
    v_lshlrev_b32 v4, 16, v31
    v_mul_f32 v4, v4, v29
    v_cvt_pk_bf16_f32 v31, v4, v4
    v_lshlrev_b32 v4, 16, v31
    v_sub_f32 v5, v5, v25
    v_cvt_pk_bf16_f32 v31, v5, v5
    v_lshlrev_b32 v5, 16, v31
    v_mul_f32 v5, v5, v29
    v_cvt_pk_bf16_f32 v31, v5, v5
    v_lshlrev_b32 v5, 16, v31
    v_sub_f32 v6, v6, v25
    v_cvt_pk_bf16_f32 v31, v6, v6
    v_lshlrev_b32 v6, 16, v31
    v_mul_f32 v6, v6, v29
    v_cvt_pk_bf16_f32 v31, v6, v6
    v_lshlrev_b32 v6, 16, v31
    v_sub_f32 v7, v7, v25
    v_cvt_pk_bf16_f32 v31, v7, v7
    v_lshlrev_b32 v7, 16, v31
    v_mul_f32 v7, v7, v29
    v_cvt_pk_bf16_f32 v31, v7, v7
    v_lshlrev_b32 v7, 16, v31
    v_sub_f32 v8, v8, v25
    v_cvt_pk_bf16_f32 v31, v8, v8
    v_lshlrev_b32 v8, 16, v31
    v_mul_f32 v8, v8, v29
    v_cvt_pk_bf16_f32 v31, v8, v8
    v_lshlrev_b32 v8, 16, v31
    v_sub_f32 v9, v9, v25
    v_cvt_pk_bf16_f32 v31, v9, v9
    v_lshlrev_b32 v9, 16, v31
    v_mul_f32 v9, v9, v29
    v_cvt_pk_bf16_f32 v31, v9, v9
    v_lshlrev_b32 v9, 16, v31
    v_sub_f32 v10, v10, v25
    v_cvt_pk_bf16_f32 v31, v10, v10
    v_lshlrev_b32 v10, 16, v31
    v_mul_f32 v10, v10, v29
    v_cvt_pk_bf16_f32 v31, v10, v10
    v_lshlrev_b32 v10, 16, v31
    v_sub_f32 v11, v11, v25
    v_cvt_pk_bf16_f32 v31, v11, v11
    v_lshlrev_b32 v11, 16, v31
    v_mul_f32 v11, v11, v29
    v_cvt_pk_bf16_f32 v31, v11, v11
    v_lshlrev_b32 v11, 16, v31
    v_sub_f32 v12, v12, v25
    v_cvt_pk_bf16_f32 v31, v12, v12
    v_lshlrev_b32 v12, 16, v31
    v_mul_f32 v12, v12, v29
    v_cvt_pk_bf16_f32 v31, v12, v12
    v_lshlrev_b32 v12, 16, v31
    v_sub_f32 v13, v13, v25
    v_cvt_pk_bf16_f32 v31, v13, v13
    v_lshlrev_b32 v13, 16, v31
    v_mul_f32 v13, v13, v29
    v_cvt_pk_bf16_f32 v31, v13, v13
    v_lshlrev_b32 v13, 16, v31
    v_mul_f32 v30, 0x3acccccd, v30
    v_cvt_pk_bf16_f32 v31, v30, v30
    v_lshlrev_b32 v30, 16, v31
    v_add_f32 v30, 0x3727c5ac, v30
    v_cvt_pk_bf16_f32 v31, v30, v30
    v_lshlrev_b32 v30, 16, v31
    v_sqrt_f32 v30, v30
    s_nop 0
    v_cvt_pk_bf16_f32 v31, v30, v30
    v_lshlrev_b32 v30, 16, v31
    v_rcp_f32 v30, v30
    v_cvt_pk_bf16_f32 v31, v26, v26
    v_lshlrev_b32 v26, 16, v31
    v_sub_f32 v14, v14, v26
    v_cvt_pk_bf16_f32 v31, v14, v14
    v_lshlrev_b32 v14, 16, v31
    v_mul_f32 v14, v14, v30
    v_cvt_pk_bf16_f32 v31, v14, v14
    v_lshlrev_b32 v14, 16, v31
    v_sub_f32 v15, v15, v26
    v_cvt_pk_bf16_f32 v31, v15, v15
    v_lshlrev_b32 v15, 16, v31
    v_mul_f32 v15, v15, v30
    v_cvt_pk_bf16_f32 v31, v15, v15
    v_lshlrev_b32 v15, 16, v31
    v_sub_f32 v16, v16, v26
    v_cvt_pk_bf16_f32 v31, v16, v16
    v_lshlrev_b32 v16, 16, v31
    v_mul_f32 v16, v16, v30
    v_cvt_pk_bf16_f32 v31, v16, v16
    v_lshlrev_b32 v16, 16, v31
    v_sub_f32 v17, v17, v26
    v_cvt_pk_bf16_f32 v31, v17, v17
    v_lshlrev_b32 v17, 16, v31
    v_mul_f32 v17, v17, v30
    v_cvt_pk_bf16_f32 v31, v17, v17
    v_lshlrev_b32 v17, 16, v31
    v_sub_f32 v18, v18, v26
    v_cvt_pk_bf16_f32 v31, v18, v18
    v_lshlrev_b32 v18, 16, v31
    v_mul_f32 v18, v18, v30
    v_cvt_pk_bf16_f32 v31, v18, v18
    v_lshlrev_b32 v18, 16, v31
    v_sub_f32 v19, v19, v26
    v_cvt_pk_bf16_f32 v31, v19, v19
    v_lshlrev_b32 v19, 16, v31
    v_mul_f32 v19, v19, v30
    v_cvt_pk_bf16_f32 v31, v19, v19
    v_lshlrev_b32 v19, 16, v31
    v_sub_f32 v20, v20, v26
    v_cvt_pk_bf16_f32 v31, v20, v20
    v_lshlrev_b32 v20, 16, v31
    v_mul_f32 v20, v20, v30
    v_cvt_pk_bf16_f32 v31, v20, v20
    v_lshlrev_b32 v20, 16, v31
    v_sub_f32 v21, v21, v26
    v_cvt_pk_bf16_f32 v31, v21, v21
    v_lshlrev_b32 v21, 16, v31
    v_mul_f32 v21, v21, v30
    v_cvt_pk_bf16_f32 v31, v21, v21
    v_lshlrev_b32 v21, 16, v31
    v_sub_f32 v22, v22, v26
    v_cvt_pk_bf16_f32 v31, v22, v22
    v_lshlrev_b32 v22, 16, v31
    v_mul_f32 v22, v22, v30
    v_cvt_pk_bf16_f32 v31, v22, v22
    v_lshlrev_b32 v22, 16, v31
    v_sub_f32 v23, v23, v26
    v_cvt_pk_bf16_f32 v31, v23, v23
    v_lshlrev_b32 v23, 16, v31
    v_mul_f32 v23, v23, v30
    v_cvt_pk_bf16_f32 v31, v23, v23
    v_lshlrev_b32 v23, 16, v31
    v_lshrrev_b32 v24, 16, v4
    buffer_store_short v24, v3, s[36:39], s21 offen offset:0
    v_lshrrev_b32 v24, 16, v14
    buffer_store_short v24, v3, s[36:39], s21 offen offset:1280
    v_lshrrev_b32 v24, 16, v5
    buffer_store_short v24, v3, s[36:39], s21 offen offset:128
    v_lshrrev_b32 v24, 16, v15
    buffer_store_short v24, v3, s[36:39], s21 offen offset:1408
    v_lshrrev_b32 v24, 16, v6
    buffer_store_short v24, v3, s[36:39], s21 offen offset:256
    v_lshrrev_b32 v24, 16, v16
    buffer_store_short v24, v3, s[36:39], s21 offen offset:1536
    v_lshrrev_b32 v24, 16, v7
    buffer_store_short v24, v3, s[36:39], s21 offen offset:384
    v_lshrrev_b32 v24, 16, v17
    buffer_store_short v24, v3, s[36:39], s21 offen offset:1664
    v_lshrrev_b32 v24, 16, v8
    buffer_store_short v24, v3, s[36:39], s21 offen offset:512
    v_lshrrev_b32 v24, 16, v18
    buffer_store_short v24, v3, s[36:39], s21 offen offset:1792
    v_lshrrev_b32 v24, 16, v9
    buffer_store_short v24, v3, s[36:39], s21 offen offset:640
    v_lshrrev_b32 v24, 16, v19
    buffer_store_short v24, v3, s[36:39], s21 offen offset:1920
    v_lshrrev_b32 v24, 16, v10
    buffer_store_short v24, v3, s[36:39], s21 offen offset:768
    v_lshrrev_b32 v24, 16, v20
    buffer_store_short v24, v3, s[36:39], s21 offen offset:2048
    v_lshrrev_b32 v24, 16, v11
    buffer_store_short v24, v3, s[36:39], s21 offen offset:896
    v_lshrrev_b32 v24, 16, v21
    buffer_store_short v24, v3, s[36:39], s21 offen offset:2176
    v_lshrrev_b32 v24, 16, v12
    buffer_store_short v24, v3, s[36:39], s21 offen offset:1024
    v_lshrrev_b32 v24, 16, v22
    buffer_store_short v24, v3, s[36:39], s21 offen offset:2304
    v_lshrrev_b32 v24, 16, v13
    buffer_store_short v24, v3, s[36:39], s21 offen offset:1152
    v_lshrrev_b32 v24, 16, v23
    buffer_store_short v24, v3, s[36:39], s21 offen offset:2432
k3b_kernel_end:
    s_endpgm
.globl k4b_kernel
.p2align 8
.type k4b_kernel,@function
k4b_kernel:
    s_cmp_ge_u32 s2, 256
    s_cbranch_scc1 k4b_kernel_end
    s_and_b32 s47, s2, 7
    s_lshr_b32 s48, s2, 3
    s_and_b32 s40, s48, 7
    s_lshr_b32 s41, s48, 3
    s_lshl_b32 s41, s41, 3
    s_add_u32 s41, s41, s47
    s_cmp_ge_u32 s41, 27
    s_cbranch_scc1 k4b_kernel_end
    s_load_dwordx2 s[6:7], s[0:1], 72
    s_load_dwordx4 s[16:19], s[0:1], 32
    v_lshrrev_b32 v1, 6, v0
    s_nop 0
    v_readfirstlane_b32 s20, v1
    v_and_b32 v2, 63, v0
    s_waitcnt lgkmcnt(0)
    s_mov_b32 s4, s6
    s_mov_b32 s5, s7
    s_add_u32 s4, s4, 0xc00000
    s_addc_u32 s5, s5, 0
    s_mov_b32 s8, s4
    s_and_b32 s9, s5, 0xffff
    s_mov_b32 s10, 0x280000
    s_mov_b32 s11, 0x00020000
    s_mov_b32 s12, s16
    s_and_b32 s13, s17, 0xffff
    s_mov_b32 s14, 0x21c000
    s_mov_b32 s15, 0x00020000
    s_mov_b32 s24, s18
    s_and_b32 s25, s19, 0xffff
    s_mov_b32 s26, 0x21c000
    s_mov_b32 s27, 0x00020000
    s_mov_b32 s4, s6
    s_mov_b32 s5, s7
    s_add_u32 s4, s4, 0x1000000
    s_addc_u32 s5, s5, 0
    s_mov_b32 s28, s4
    s_and_b32 s29, s5, 0xffff
    s_mov_b32 s30, 0x6c0000
    s_mov_b32 s31, 0x00020000
    v_lshrrev_b32 v3, 2, v2
    v_and_b32 v5, 3, v2
    s_mul_i32 s21, s20, 32
    s_lshl_b32 s22, s40, 8
    s_add_u32 s21, s21, s22
    v_add_u32 v7, 0, v3
    v_lshrrev_b32 v6, 3, v7
    v_and_b32 v6, 1, v6
    v_lshlrev_b32 v6, 1, v6
    v_xor_b32 v6, v6, v5
    v_lshlrev_b32 v6, 4, v6
    v_add_u32 v7, s21, v7
    v_mul_u32_u24 v7, 1280, v7
    v_add_u32 v10, v6, v7
    v_add_u32 v7, 16, v3
    v_lshrrev_b32 v6, 3, v7
    v_and_b32 v6, 1, v6
    v_lshlrev_b32 v6, 1, v6
    v_xor_b32 v6, v6, v5
    v_lshlrev_b32 v6, 4, v6
    v_add_u32 v7, s21, v7
    v_mul_u32_u24 v7, 1280, v7
    v_add_u32 v11, v6, v7
    v_lshrrev_b32 v3, 3, v2
    v_and_b32 v5, 7, v2
    s_and_b32 s21, s20, 3
    s_lshl_b32 s21, s21, 3
    s_mul_i32 s22, s41, 128
    v_add_u32 v7, s21, v3
    v_lshrrev_b32 v6, 1, v7
    v_and_b32 v6, 1, v6
    v_lshrrev_b32 v8, 3, v7
    v_and_b32 v8, 1, v8
    v_lshlrev_b32 v8, 1, v8
    v_or_b32 v6, v6, v8
    v_lshlrev_b32 v6, 1, v6
    v_xor_b32 v6, v6, v5
    v_lshlrev_b32 v6, 4, v6
    v_mul_u32_u24 v7, 3456, v7
    v_add_u32 v7, v7, v6
    v_add_u32 v14, s22, v7
    v_and_b32 v3, 15, v2
    v_lshrrev_b32 v4, 4, v2
    s_lshr_b32 s21, s20, 1
    s_mul_i32 s21, s21, 4096
    v_lshrrev_b32 v7, 3, v3
    v_lshlrev_b32 v7, 1, v7
    v_xor_b32 v6, v4, v7
    v_lshlrev_b32 v6, 4, v6
    v_lshlrev_b32 v7, 6, v3
    v_add_u32 v6, v6, v7
    v_add_u32 v16, s21, v6
    s_and_b32 s21, s20, 1
    v_lshrrev_b32 v5, 3, v3
    v_and_b32 v6, 1, v4
    v_lshlrev_b32 v6, 1, v6
    v_or_b32 v5, v5, v6
    v_lshlrev_b32 v5, 1, v5
    v_and_b32 v6, 3, v3
    v_lshrrev_b32 v6, 1, v6
    s_lshl_b32 s22, s21, 2
    v_add_u32 v6, s22, v6
    v_lshlrev_b32 v7, 3, v4
    v_lshrrev_b32 v8, 2, v3
    v_add_u32 v7, v7, v8
    v_lshlrev_b32 v7, 7, v7
    v_and_b32 v8, 1, v3
    v_lshlrev_b32 v8, 3, v8
    v_add_u32 v7, v7, v8
    v_add_u32 v7, 16384, v7
    v_add_u32 v8, 0, v6
    v_xor_b32 v8, v8, v5
    v_lshlrev_b32 v8, 4, v8
    v_add_u32 v18, v8, v7
    v_add_u32 v8, 2, v6
    v_xor_b32 v8, v8, v5
    v_lshlrev_b32 v8, 4, v8
    v_add_u32 v19, v8, v7
    v_add_u32 v15, 49152, v16
    v_add_u32 v12, 49152, v18
    v_add_u32 v13, 49152, v19
    v_mov_b32 v64, 0
    v_mov_b32 v65, 0
    v_mov_b32 v66, 0
    v_mov_b32 v67, 0
    v_mov_b32 v68, 0
    v_mov_b32 v69, 0
    v_mov_b32 v70, 0
    v_mov_b32 v71, 0
    v_mov_b32 v72, 0
    v_mov_b32 v73, 0
    v_mov_b32 v74, 0
    v_mov_b32 v75, 0
    v_mov_b32 v76, 0
    v_mov_b32 v77, 0
    v_mov_b32 v78, 0
    v_mov_b32 v79, 0
    v_mov_b32 v80, 0
    v_mov_b32 v81, 0
    v_mov_b32 v82, 0
    v_mov_b32 v83, 0
    v_mov_b32 v84, 0
    v_mov_b32 v85, 0
    v_mov_b32 v86, 0
    v_mov_b32 v87, 0
    v_mov_b32 v88, 0
    v_mov_b32 v89, 0
    v_mov_b32 v90, 0
    v_mov_b32 v91, 0
    v_mov_b32 v92, 0
    v_mov_b32 v93, 0
    v_mov_b32 v94, 0
    v_mov_b32 v95, 0
    v_mov_b32 v96, 0
    v_mov_b32 v97, 0
    v_mov_b32 v98, 0
    v_mov_b32 v99, 0
    v_mov_b32 v100, 0
    v_mov_b32 v101, 0
    v_mov_b32 v102, 0
    v_mov_b32 v103, 0
    v_mov_b32 v104, 0
    v_mov_b32 v105, 0
    v_mov_b32 v106, 0
    v_mov_b32 v107, 0
    v_mov_b32 v108, 0
    v_mov_b32 v109, 0
    v_mov_b32 v110, 0
    v_mov_b32 v111, 0
    v_mov_b32 v112, 0
    v_mov_b32 v113, 0
    v_mov_b32 v114, 0
    v_mov_b32 v115, 0
    v_mov_b32 v116, 0
    v_mov_b32 v117, 0
    v_mov_b32 v118, 0
    v_mov_b32 v119, 0
    v_mov_b32 v120, 0
    v_mov_b32 v121, 0
    v_mov_b32 v122, 0
    v_mov_b32 v123, 0
    v_mov_b32 v124, 0
    v_mov_b32 v125, 0
    v_mov_b32 v126, 0
    v_mov_b32 v127, 0
    s_mul_i32 s42, s20, 2048
    s_lshl_b32 s43, s20, 10
    s_cmp_ge_u32 s20, 4
    s_cselect_b32 s52, s24, s12
    s_cselect_b32 s53, s25, s13
    s_cselect_b32 s54, s26, s14
    s_cselect_b32 s55, s27, s15
    s_mov_b32 s44, 0
    s_mov_b32 s45, 0
    s_add_u32 m0, s42, 0
    s_nop 0
    buffer_load_dwordx4 v10, s[8:11], s44 offen lds
    s_add_u32 m0, s42, 1024
    s_nop 0
    buffer_load_dwordx4 v11, s[8:11], s44 offen lds
    s_add_u32 m0, s43, 16384
    s_nop 0
    buffer_load_dwordx4 v14, s[52:55], s45 offen lds
    s_add_u32 s44, s44, 64
    s_add_u32 s45, s45, 110592
    s_add_u32 m0, s42, 24576
    s_nop 0
    buffer_load_dwordx4 v10, s[8:11], s44 offen lds
    s_add_u32 m0, s42, 25600
    s_nop 0
    buffer_load_dwordx4 v11, s[8:11], s44 offen lds
    s_add_u32 m0, s43, 40960
    s_nop 0
    buffer_load_dwordx4 v14, s[52:55], s45 offen lds
    s_add_u32 s44, s44, 64
    s_add_u32 s45, s45, 110592
    s_add_u32 m0, s42, 49152
    s_nop 0
    buffer_load_dwordx4 v10, s[8:11], s44 offen lds
    s_add_u32 m0, s42, 50176
    s_nop 0
    buffer_load_dwordx4 v11, s[8:11], s44 offen lds
    s_add_u32 m0, s43, 65536
    s_nop 0
    buffer_load_dwordx4 v14, s[52:55], s45 offen lds
    s_add_u32 s44, s44, 64
    s_add_u32 s45, s45, 110592
    s_waitcnt vmcnt(6)
    s_barrier
    s_add_u32 m0, s42, 73728
    s_nop 0
    buffer_load_dwordx4 v10, s[8:11], s44 offen lds
    s_add_u32 m0, s42, 74752
    s_nop 0
    buffer_load_dwordx4 v11, s[8:11], s44 offen lds
    s_add_u32 m0, s43, 90112
    s_nop 0
    buffer_load_dwordx4 v14, s[52:55], s45 offen lds
    s_add_u32 s44, s44, 64
    s_add_u32 s45, s45, 110592
    ds_read_b128 v[20:23], v16 offset:0
    ds_read_b128 v[24:27], v16 offset:1024
    ds_read_b128 v[28:31], v16 offset:2048
    ds_read_b128 v[32:35], v16 offset:3072
    ds_read_b64_tr_b16 v[192:193], v18 offset:0
    ds_read_b64_tr_b16 v[194:195], v18 offset:512
    ds_read_b64_tr_b16 v[196:197], v19 offset:0
    ds_read_b64_tr_b16 v[198:199], v19 offset:512
    ds_read_b64_tr_b16 v[200:201], v18 offset:4096
    ds_read_b64_tr_b16 v[202:203], v18 offset:4608
    ds_read_b64_tr_b16 v[204:205], v19 offset:4096
    ds_read_b64_tr_b16 v[206:207], v19 offset:4608
    s_waitcnt lgkmcnt(0)
    s_waitcnt vmcnt(6)
    s_barrier
    s_add_u32 m0, s42, 0
    s_nop 0
    buffer_load_dwordx4 v10, s[8:11], s44 offen lds
    s_add_u32 m0, s42, 1024
    s_nop 0
    buffer_load_dwordx4 v11, s[8:11], s44 offen lds
    s_add_u32 m0, s43, 16384
    s_nop 0
    buffer_load_dwordx4 v14, s[52:55], s45 offen lds
    s_add_u32 s44, s44, 64
    s_add_u32 s45, s45, 110592
    ds_read_b128 v[36:39], v16 offset:24576
    ds_read_b128 v[40:43], v16 offset:25600
    ds_read_b128 v[44:47], v16 offset:26624
    ds_read_b128 v[48:51], v16 offset:27648
    ds_read_b64_tr_b16 v[208:209], v18 offset:24576
    ds_read_b64_tr_b16 v[210:211], v18 offset:25088
    ds_read_b64_tr_b16 v[212:213], v19 offset:24576
    ds_read_b64_tr_b16 v[214:215], v19 offset:25088
    ds_read_b64_tr_b16 v[216:217], v18 offset:28672
    ds_read_b64_tr_b16 v[218:219], v18 offset:29184
    ds_read_b64_tr_b16 v[220:221], v19 offset:28672
    ds_read_b64_tr_b16 v[222:223], v19 offset:29184
    v_mfma_f32_16x16x32_bf16 v[64:67], v[192:195], v[20:23], v[64:67]
    v_mfma_f32_16x16x32_bf16 v[68:71], v[192:195], v[24:27], v[68:71]
    v_mfma_f32_16x16x32_bf16 v[72:75], v[192:195], v[28:31], v[72:75]
    v_mfma_f32_16x16x32_bf16 v[76:79], v[192:195], v[32:35], v[76:79]
    v_mfma_f32_16x16x32_bf16 v[80:83], v[196:199], v[20:23], v[80:83]
    v_mfma_f32_16x16x32_bf16 v[84:87], v[196:199], v[24:27], v[84:87]
    v_mfma_f32_16x16x32_bf16 v[88:91], v[196:199], v[28:31], v[88:91]
    v_mfma_f32_16x16x32_bf16 v[92:95], v[196:199], v[32:35], v[92:95]
    v_mfma_f32_16x16x32_bf16 v[96:99], v[200:203], v[20:23], v[96:99]
    v_mfma_f32_16x16x32_bf16 v[100:103], v[200:203], v[24:27], v[100:103]
    v_mfma_f32_16x16x32_bf16 v[104:107], v[200:203], v[28:31], v[104:107]
    v_mfma_f32_16x16x32_bf16 v[108:111], v[200:203], v[32:35], v[108:111]
    v_mfma_f32_16x16x32_bf16 v[112:115], v[204:207], v[20:23], v[112:115]
    v_mfma_f32_16x16x32_bf16 v[116:119], v[204:207], v[24:27], v[116:119]
    v_mfma_f32_16x16x32_bf16 v[120:123], v[204:207], v[28:31], v[120:123]
    v_mfma_f32_16x16x32_bf16 v[124:127], v[204:207], v[32:35], v[124:127]
    s_waitcnt lgkmcnt(0)
    s_waitcnt vmcnt(6)
    s_barrier
    s_add_u32 m0, s42, 24576
    s_nop 0
    buffer_load_dwordx4 v10, s[8:11], s44 offen lds
    s_add_u32 m0, s42, 25600
    s_nop 0
    buffer_load_dwordx4 v11, s[8:11], s44 offen lds
    s_add_u32 m0, s43, 40960
    s_nop 0
    buffer_load_dwordx4 v14, s[52:55], s45 offen lds
    s_add_u32 s44, s44, 64
    s_add_u32 s45, s45, 110592
    ds_read_b128 v[20:23], v15 offset:0
    ds_read_b128 v[24:27], v15 offset:1024
    ds_read_b128 v[28:31], v15 offset:2048
    ds_read_b128 v[32:35], v15 offset:3072
    ds_read_b64_tr_b16 v[192:193], v12 offset:0
    ds_read_b64_tr_b16 v[194:195], v12 offset:512
    ds_read_b64_tr_b16 v[196:197], v13 offset:0
    ds_read_b64_tr_b16 v[198:199], v13 offset:512
    ds_read_b64_tr_b16 v[200:201], v12 offset:4096
    ds_read_b64_tr_b16 v[202:203], v12 offset:4608
    ds_read_b64_tr_b16 v[204:205], v13 offset:4096
    ds_read_b64_tr_b16 v[206:207], v13 offset:4608
    v_mfma_f32_16x16x32_bf16 v[64:67], v[208:211], v[36:39], v[64:67]
    v_mfma_f32_16x16x32_bf16 v[68:71], v[208:211], v[40:43], v[68:71]
    v_mfma_f32_16x16x32_bf16 v[72:75], v[208:211], v[44:47], v[72:75]
    v_mfma_f32_16x16x32_bf16 v[76:79], v[208:211], v[48:51], v[76:79]
    v_mfma_f32_16x16x32_bf16 v[80:83], v[212:215], v[36:39], v[80:83]
    v_mfma_f32_16x16x32_bf16 v[84:87], v[212:215], v[40:43], v[84:87]
    v_mfma_f32_16x16x32_bf16 v[88:91], v[212:215], v[44:47], v[88:91]
    v_mfma_f32_16x16x32_bf16 v[92:95], v[212:215], v[48:51], v[92:95]
    v_mfma_f32_16x16x32_bf16 v[96:99], v[216:219], v[36:39], v[96:99]
    v_mfma_f32_16x16x32_bf16 v[100:103], v[216:219], v[40:43], v[100:103]
    v_mfma_f32_16x16x32_bf16 v[104:107], v[216:219], v[44:47], v[104:107]
    v_mfma_f32_16x16x32_bf16 v[108:111], v[216:219], v[48:51], v[108:111]
    v_mfma_f32_16x16x32_bf16 v[112:115], v[220:223], v[36:39], v[112:115]
    v_mfma_f32_16x16x32_bf16 v[116:119], v[220:223], v[40:43], v[116:119]
    v_mfma_f32_16x16x32_bf16 v[120:123], v[220:223], v[44:47], v[120:123]
    v_mfma_f32_16x16x32_bf16 v[124:127], v[220:223], v[48:51], v[124:127]
    s_waitcnt lgkmcnt(0)
    s_waitcnt vmcnt(6)
    s_barrier
    s_add_u32 m0, s42, 49152
    s_nop 0
    buffer_load_dwordx4 v10, s[8:11], s44 offen lds
    s_add_u32 m0, s42, 50176
    s_nop 0
    buffer_load_dwordx4 v11, s[8:11], s44 offen lds
    s_add_u32 m0, s43, 65536
    s_nop 0
    buffer_load_dwordx4 v14, s[52:55], s45 offen lds
    s_add_u32 s44, s44, 64
    s_add_u32 s45, s45, 110592
    ds_read_b128 v[36:39], v15 offset:24576
    ds_read_b128 v[40:43], v15 offset:25600
    ds_read_b128 v[44:47], v15 offset:26624
    ds_read_b128 v[48:51], v15 offset:27648
    ds_read_b64_tr_b16 v[208:209], v12 offset:24576
    ds_read_b64_tr_b16 v[210:211], v12 offset:25088
    ds_read_b64_tr_b16 v[212:213], v13 offset:24576
    ds_read_b64_tr_b16 v[214:215], v13 offset:25088
    ds_read_b64_tr_b16 v[216:217], v12 offset:28672
    ds_read_b64_tr_b16 v[218:219], v12 offset:29184
    ds_read_b64_tr_b16 v[220:221], v13 offset:28672
    ds_read_b64_tr_b16 v[222:223], v13 offset:29184
    v_mfma_f32_16x16x32_bf16 v[64:67], v[192:195], v[20:23], v[64:67]
    v_mfma_f32_16x16x32_bf16 v[68:71], v[192:195], v[24:27], v[68:71]
    v_mfma_f32_16x16x32_bf16 v[72:75], v[192:195], v[28:31], v[72:75]
    v_mfma_f32_16x16x32_bf16 v[76:79], v[192:195], v[32:35], v[76:79]
    v_mfma_f32_16x16x32_bf16 v[80:83], v[196:199], v[20:23], v[80:83]
    v_mfma_f32_16x16x32_bf16 v[84:87], v[196:199], v[24:27], v[84:87]
    v_mfma_f32_16x16x32_bf16 v[88:91], v[196:199], v[28:31], v[88:91]
    v_mfma_f32_16x16x32_bf16 v[92:95], v[196:199], v[32:35], v[92:95]
    v_mfma_f32_16x16x32_bf16 v[96:99], v[200:203], v[20:23], v[96:99]
    v_mfma_f32_16x16x32_bf16 v[100:103], v[200:203], v[24:27], v[100:103]
    v_mfma_f32_16x16x32_bf16 v[104:107], v[200:203], v[28:31], v[104:107]
    v_mfma_f32_16x16x32_bf16 v[108:111], v[200:203], v[32:35], v[108:111]
    v_mfma_f32_16x16x32_bf16 v[112:115], v[204:207], v[20:23], v[112:115]
    v_mfma_f32_16x16x32_bf16 v[116:119], v[204:207], v[24:27], v[116:119]
    v_mfma_f32_16x16x32_bf16 v[120:123], v[204:207], v[28:31], v[120:123]
    v_mfma_f32_16x16x32_bf16 v[124:127], v[204:207], v[32:35], v[124:127]
    s_waitcnt lgkmcnt(0)
    s_mov_b32 s46, 1
k4b_kernel_loop:
    s_waitcnt vmcnt(6)
    s_barrier
    s_add_u32 m0, s42, 73728
    s_nop 0
    buffer_load_dwordx4 v10, s[8:11], s44 offen lds
    s_add_u32 m0, s42, 74752
    s_nop 0
    buffer_load_dwordx4 v11, s[8:11], s44 offen lds
    s_add_u32 m0, s43, 90112
    s_nop 0
    buffer_load_dwordx4 v14, s[52:55], s45 offen lds
    s_add_u32 s44, s44, 64
    s_add_u32 s45, s45, 110592
    ds_read_b128 v[20:23], v16 offset:0
    ds_read_b128 v[24:27], v16 offset:1024
    ds_read_b128 v[28:31], v16 offset:2048
    ds_read_b128 v[32:35], v16 offset:3072
    ds_read_b64_tr_b16 v[192:193], v18 offset:0
    ds_read_b64_tr_b16 v[194:195], v18 offset:512
    ds_read_b64_tr_b16 v[196:197], v19 offset:0
    ds_read_b64_tr_b16 v[198:199], v19 offset:512
    ds_read_b64_tr_b16 v[200:201], v18 offset:4096
    ds_read_b64_tr_b16 v[202:203], v18 offset:4608
    ds_read_b64_tr_b16 v[204:205], v19 offset:4096
    ds_read_b64_tr_b16 v[206:207], v19 offset:4608
    v_mfma_f32_16x16x32_bf16 v[64:67], v[208:211], v[36:39], v[64:67]
    v_mfma_f32_16x16x32_bf16 v[68:71], v[208:211], v[40:43], v[68:71]
    v_mfma_f32_16x16x32_bf16 v[72:75], v[208:211], v[44:47], v[72:75]
    v_mfma_f32_16x16x32_bf16 v[76:79], v[208:211], v[48:51], v[76:79]
    v_mfma_f32_16x16x32_bf16 v[80:83], v[212:215], v[36:39], v[80:83]
    v_mfma_f32_16x16x32_bf16 v[84:87], v[212:215], v[40:43], v[84:87]
    v_mfma_f32_16x16x32_bf16 v[88:91], v[212:215], v[44:47], v[88:91]
    v_mfma_f32_16x16x32_bf16 v[92:95], v[212:215], v[48:51], v[92:95]
    v_mfma_f32_16x16x32_bf16 v[96:99], v[216:219], v[36:39], v[96:99]
    v_mfma_f32_16x16x32_bf16 v[100:103], v[216:219], v[40:43], v[100:103]
    v_mfma_f32_16x16x32_bf16 v[104:107], v[216:219], v[44:47], v[104:107]
    v_mfma_f32_16x16x32_bf16 v[108:111], v[216:219], v[48:51], v[108:111]
    v_mfma_f32_16x16x32_bf16 v[112:115], v[220:223], v[36:39], v[112:115]
    v_mfma_f32_16x16x32_bf16 v[116:119], v[220:223], v[40:43], v[116:119]
    v_mfma_f32_16x16x32_bf16 v[120:123], v[220:223], v[44:47], v[120:123]
    v_mfma_f32_16x16x32_bf16 v[124:127], v[220:223], v[48:51], v[124:127]
    s_waitcnt lgkmcnt(0)
    s_waitcnt vmcnt(6)
    s_barrier
    s_add_u32 m0, s42, 0
    s_nop 0
    buffer_load_dwordx4 v10, s[8:11], s44 offen lds
    s_add_u32 m0, s42, 1024
    s_nop 0
    buffer_load_dwordx4 v11, s[8:11], s44 offen lds
    s_add_u32 m0, s43, 16384
    s_nop 0
    buffer_load_dwordx4 v14, s[52:55], s45 offen lds
    s_add_u32 s44, s44, 64
    s_add_u32 s45, s45, 110592
    ds_read_b128 v[36:39], v16 offset:24576
    ds_read_b128 v[40:43], v16 offset:25600
    ds_read_b128 v[44:47], v16 offset:26624
    ds_read_b128 v[48:51], v16 offset:27648
    ds_read_b64_tr_b16 v[208:209], v18 offset:24576
    ds_read_b64_tr_b16 v[210:211], v18 offset:25088
    ds_read_b64_tr_b16 v[212:213], v19 offset:24576
    ds_read_b64_tr_b16 v[214:215], v19 offset:25088
    ds_read_b64_tr_b16 v[216:217], v18 offset:28672
    ds_read_b64_tr_b16 v[218:219], v18 offset:29184
    ds_read_b64_tr_b16 v[220:221], v19 offset:28672
    ds_read_b64_tr_b16 v[222:223], v19 offset:29184
    v_mfma_f32_16x16x32_bf16 v[64:67], v[192:195], v[20:23], v[64:67]
    v_mfma_f32_16x16x32_bf16 v[68:71], v[192:195], v[24:27], v[68:71]
    v_mfma_f32_16x16x32_bf16 v[72:75], v[192:195], v[28:31], v[72:75]
    v_mfma_f32_16x16x32_bf16 v[76:79], v[192:195], v[32:35], v[76:79]
    v_mfma_f32_16x16x32_bf16 v[80:83], v[196:199], v[20:23], v[80:83]
    v_mfma_f32_16x16x32_bf16 v[84:87], v[196:199], v[24:27], v[84:87]
    v_mfma_f32_16x16x32_bf16 v[88:91], v[196:199], v[28:31], v[88:91]
    v_mfma_f32_16x16x32_bf16 v[92:95], v[196:199], v[32:35], v[92:95]
    v_mfma_f32_16x16x32_bf16 v[96:99], v[200:203], v[20:23], v[96:99]
    v_mfma_f32_16x16x32_bf16 v[100:103], v[200:203], v[24:27], v[100:103]
    v_mfma_f32_16x16x32_bf16 v[104:107], v[200:203], v[28:31], v[104:107]
    v_mfma_f32_16x16x32_bf16 v[108:111], v[200:203], v[32:35], v[108:111]
    v_mfma_f32_16x16x32_bf16 v[112:115], v[204:207], v[20:23], v[112:115]
    v_mfma_f32_16x16x32_bf16 v[116:119], v[204:207], v[24:27], v[116:119]
    v_mfma_f32_16x16x32_bf16 v[120:123], v[204:207], v[28:31], v[120:123]
    v_mfma_f32_16x16x32_bf16 v[124:127], v[204:207], v[32:35], v[124:127]
    s_waitcnt lgkmcnt(0)
    s_waitcnt vmcnt(6)
    s_barrier
    s_add_u32 m0, s42, 24576
    s_nop 0
    buffer_load_dwordx4 v10, s[8:11], s44 offen lds
    s_add_u32 m0, s42, 25600
    s_nop 0
    buffer_load_dwordx4 v11, s[8:11], s44 offen lds
    s_add_u32 m0, s43, 40960
    s_nop 0
    buffer_load_dwordx4 v14, s[52:55], s45 offen lds
    s_add_u32 s44, s44, 64
    s_add_u32 s45, s45, 110592
    ds_read_b128 v[20:23], v15 offset:0
    ds_read_b128 v[24:27], v15 offset:1024
    ds_read_b128 v[28:31], v15 offset:2048
    ds_read_b128 v[32:35], v15 offset:3072
    ds_read_b64_tr_b16 v[192:193], v12 offset:0
    ds_read_b64_tr_b16 v[194:195], v12 offset:512
    ds_read_b64_tr_b16 v[196:197], v13 offset:0
    ds_read_b64_tr_b16 v[198:199], v13 offset:512
    ds_read_b64_tr_b16 v[200:201], v12 offset:4096
    ds_read_b64_tr_b16 v[202:203], v12 offset:4608
    ds_read_b64_tr_b16 v[204:205], v13 offset:4096
    ds_read_b64_tr_b16 v[206:207], v13 offset:4608
    v_mfma_f32_16x16x32_bf16 v[64:67], v[208:211], v[36:39], v[64:67]
    v_mfma_f32_16x16x32_bf16 v[68:71], v[208:211], v[40:43], v[68:71]
    v_mfma_f32_16x16x32_bf16 v[72:75], v[208:211], v[44:47], v[72:75]
    v_mfma_f32_16x16x32_bf16 v[76:79], v[208:211], v[48:51], v[76:79]
    v_mfma_f32_16x16x32_bf16 v[80:83], v[212:215], v[36:39], v[80:83]
    v_mfma_f32_16x16x32_bf16 v[84:87], v[212:215], v[40:43], v[84:87]
    v_mfma_f32_16x16x32_bf16 v[88:91], v[212:215], v[44:47], v[88:91]
    v_mfma_f32_16x16x32_bf16 v[92:95], v[212:215], v[48:51], v[92:95]
    v_mfma_f32_16x16x32_bf16 v[96:99], v[216:219], v[36:39], v[96:99]
    v_mfma_f32_16x16x32_bf16 v[100:103], v[216:219], v[40:43], v[100:103]
    v_mfma_f32_16x16x32_bf16 v[104:107], v[216:219], v[44:47], v[104:107]
    v_mfma_f32_16x16x32_bf16 v[108:111], v[216:219], v[48:51], v[108:111]
    v_mfma_f32_16x16x32_bf16 v[112:115], v[220:223], v[36:39], v[112:115]
    v_mfma_f32_16x16x32_bf16 v[116:119], v[220:223], v[40:43], v[116:119]
    v_mfma_f32_16x16x32_bf16 v[120:123], v[220:223], v[44:47], v[120:123]
    v_mfma_f32_16x16x32_bf16 v[124:127], v[220:223], v[48:51], v[124:127]
    s_waitcnt lgkmcnt(0)
    s_waitcnt vmcnt(6)
    s_barrier
    s_add_u32 m0, s42, 49152
    s_nop 0
    buffer_load_dwordx4 v10, s[8:11], s44 offen lds
    s_add_u32 m0, s42, 50176
    s_nop 0
    buffer_load_dwordx4 v11, s[8:11], s44 offen lds
    s_add_u32 m0, s43, 65536
    s_nop 0
    buffer_load_dwordx4 v14, s[52:55], s45 offen lds
    s_add_u32 s44, s44, 64
    s_add_u32 s45, s45, 110592
    ds_read_b128 v[36:39], v15 offset:24576
    ds_read_b128 v[40:43], v15 offset:25600
    ds_read_b128 v[44:47], v15 offset:26624
    ds_read_b128 v[48:51], v15 offset:27648
    ds_read_b64_tr_b16 v[208:209], v12 offset:24576
    ds_read_b64_tr_b16 v[210:211], v12 offset:25088
    ds_read_b64_tr_b16 v[212:213], v13 offset:24576
    ds_read_b64_tr_b16 v[214:215], v13 offset:25088
    ds_read_b64_tr_b16 v[216:217], v12 offset:28672
    ds_read_b64_tr_b16 v[218:219], v12 offset:29184
    ds_read_b64_tr_b16 v[220:221], v13 offset:28672
    ds_read_b64_tr_b16 v[222:223], v13 offset:29184
    v_mfma_f32_16x16x32_bf16 v[64:67], v[192:195], v[20:23], v[64:67]
    v_mfma_f32_16x16x32_bf16 v[68:71], v[192:195], v[24:27], v[68:71]
    v_mfma_f32_16x16x32_bf16 v[72:75], v[192:195], v[28:31], v[72:75]
    v_mfma_f32_16x16x32_bf16 v[76:79], v[192:195], v[32:35], v[76:79]
    v_mfma_f32_16x16x32_bf16 v[80:83], v[196:199], v[20:23], v[80:83]
    v_mfma_f32_16x16x32_bf16 v[84:87], v[196:199], v[24:27], v[84:87]
    v_mfma_f32_16x16x32_bf16 v[88:91], v[196:199], v[28:31], v[88:91]
    v_mfma_f32_16x16x32_bf16 v[92:95], v[196:199], v[32:35], v[92:95]
    v_mfma_f32_16x16x32_bf16 v[96:99], v[200:203], v[20:23], v[96:99]
    v_mfma_f32_16x16x32_bf16 v[100:103], v[200:203], v[24:27], v[100:103]
    v_mfma_f32_16x16x32_bf16 v[104:107], v[200:203], v[28:31], v[104:107]
    v_mfma_f32_16x16x32_bf16 v[108:111], v[200:203], v[32:35], v[108:111]
    v_mfma_f32_16x16x32_bf16 v[112:115], v[204:207], v[20:23], v[112:115]
    v_mfma_f32_16x16x32_bf16 v[116:119], v[204:207], v[24:27], v[116:119]
    v_mfma_f32_16x16x32_bf16 v[120:123], v[204:207], v[28:31], v[120:123]
    v_mfma_f32_16x16x32_bf16 v[124:127], v[204:207], v[32:35], v[124:127]
    s_waitcnt lgkmcnt(0)
    s_add_u32 s46, s46, 1
    s_cmp_lt_u32 s46, 4
    s_cbranch_scc1 k4b_kernel_loop
    s_waitcnt vmcnt(6)
    s_barrier
    s_add_u32 m0, s42, 73728
    s_nop 0
    buffer_load_dwordx4 v10, s[8:11], s44 offen lds
    s_add_u32 m0, s42, 74752
    s_nop 0
    buffer_load_dwordx4 v11, s[8:11], s44 offen lds
    s_add_u32 m0, s43, 90112
    s_nop 0
    buffer_load_dwordx4 v14, s[52:55], s45 offen lds
    s_add_u32 s44, s44, 64
    s_add_u32 s45, s45, 110592
    ds_read_b128 v[20:23], v16 offset:0
    ds_read_b128 v[24:27], v16 offset:1024
    ds_read_b128 v[28:31], v16 offset:2048
    ds_read_b128 v[32:35], v16 offset:3072
    ds_read_b64_tr_b16 v[192:193], v18 offset:0
    ds_read_b64_tr_b16 v[194:195], v18 offset:512
    ds_read_b64_tr_b16 v[196:197], v19 offset:0
    ds_read_b64_tr_b16 v[198:199], v19 offset:512
    ds_read_b64_tr_b16 v[200:201], v18 offset:4096
    ds_read_b64_tr_b16 v[202:203], v18 offset:4608
    ds_read_b64_tr_b16 v[204:205], v19 offset:4096
    ds_read_b64_tr_b16 v[206:207], v19 offset:4608
    v_mfma_f32_16x16x32_bf16 v[64:67], v[208:211], v[36:39], v[64:67]
    v_mfma_f32_16x16x32_bf16 v[68:71], v[208:211], v[40:43], v[68:71]
    v_mfma_f32_16x16x32_bf16 v[72:75], v[208:211], v[44:47], v[72:75]
    v_mfma_f32_16x16x32_bf16 v[76:79], v[208:211], v[48:51], v[76:79]
    v_mfma_f32_16x16x32_bf16 v[80:83], v[212:215], v[36:39], v[80:83]
    v_mfma_f32_16x16x32_bf16 v[84:87], v[212:215], v[40:43], v[84:87]
    v_mfma_f32_16x16x32_bf16 v[88:91], v[212:215], v[44:47], v[88:91]
    v_mfma_f32_16x16x32_bf16 v[92:95], v[212:215], v[48:51], v[92:95]
    v_mfma_f32_16x16x32_bf16 v[96:99], v[216:219], v[36:39], v[96:99]
    v_mfma_f32_16x16x32_bf16 v[100:103], v[216:219], v[40:43], v[100:103]
    v_mfma_f32_16x16x32_bf16 v[104:107], v[216:219], v[44:47], v[104:107]
    v_mfma_f32_16x16x32_bf16 v[108:111], v[216:219], v[48:51], v[108:111]
    v_mfma_f32_16x16x32_bf16 v[112:115], v[220:223], v[36:39], v[112:115]
    v_mfma_f32_16x16x32_bf16 v[116:119], v[220:223], v[40:43], v[116:119]
    v_mfma_f32_16x16x32_bf16 v[120:123], v[220:223], v[44:47], v[120:123]
    v_mfma_f32_16x16x32_bf16 v[124:127], v[220:223], v[48:51], v[124:127]
    s_waitcnt lgkmcnt(0)
    s_waitcnt vmcnt(6)
    s_barrier
    ds_read_b128 v[36:39], v16 offset:24576
    ds_read_b128 v[40:43], v16 offset:25600
    ds_read_b128 v[44:47], v16 offset:26624
    ds_read_b128 v[48:51], v16 offset:27648
    ds_read_b64_tr_b16 v[208:209], v18 offset:24576
    ds_read_b64_tr_b16 v[210:211], v18 offset:25088
    ds_read_b64_tr_b16 v[212:213], v19 offset:24576
    ds_read_b64_tr_b16 v[214:215], v19 offset:25088
    ds_read_b64_tr_b16 v[216:217], v18 offset:28672
    ds_read_b64_tr_b16 v[218:219], v18 offset:29184
    ds_read_b64_tr_b16 v[220:221], v19 offset:28672
    ds_read_b64_tr_b16 v[222:223], v19 offset:29184
    v_mfma_f32_16x16x32_bf16 v[64:67], v[192:195], v[20:23], v[64:67]
    v_mfma_f32_16x16x32_bf16 v[68:71], v[192:195], v[24:27], v[68:71]
    v_mfma_f32_16x16x32_bf16 v[72:75], v[192:195], v[28:31], v[72:75]
    v_mfma_f32_16x16x32_bf16 v[76:79], v[192:195], v[32:35], v[76:79]
    v_mfma_f32_16x16x32_bf16 v[80:83], v[196:199], v[20:23], v[80:83]
    v_mfma_f32_16x16x32_bf16 v[84:87], v[196:199], v[24:27], v[84:87]
    v_mfma_f32_16x16x32_bf16 v[88:91], v[196:199], v[28:31], v[88:91]
    v_mfma_f32_16x16x32_bf16 v[92:95], v[196:199], v[32:35], v[92:95]
    v_mfma_f32_16x16x32_bf16 v[96:99], v[200:203], v[20:23], v[96:99]
    v_mfma_f32_16x16x32_bf16 v[100:103], v[200:203], v[24:27], v[100:103]
    v_mfma_f32_16x16x32_bf16 v[104:107], v[200:203], v[28:31], v[104:107]
    v_mfma_f32_16x16x32_bf16 v[108:111], v[200:203], v[32:35], v[108:111]
    v_mfma_f32_16x16x32_bf16 v[112:115], v[204:207], v[20:23], v[112:115]
    v_mfma_f32_16x16x32_bf16 v[116:119], v[204:207], v[24:27], v[116:119]
    v_mfma_f32_16x16x32_bf16 v[120:123], v[204:207], v[28:31], v[120:123]
    v_mfma_f32_16x16x32_bf16 v[124:127], v[204:207], v[32:35], v[124:127]
    s_waitcnt lgkmcnt(0)
    s_waitcnt vmcnt(3)
    s_barrier
    ds_read_b128 v[20:23], v15 offset:0
    ds_read_b128 v[24:27], v15 offset:1024
    ds_read_b128 v[28:31], v15 offset:2048
    ds_read_b128 v[32:35], v15 offset:3072
    ds_read_b64_tr_b16 v[192:193], v12 offset:0
    ds_read_b64_tr_b16 v[194:195], v12 offset:512
    ds_read_b64_tr_b16 v[196:197], v13 offset:0
    ds_read_b64_tr_b16 v[198:199], v13 offset:512
    ds_read_b64_tr_b16 v[200:201], v12 offset:4096
    ds_read_b64_tr_b16 v[202:203], v12 offset:4608
    ds_read_b64_tr_b16 v[204:205], v13 offset:4096
    ds_read_b64_tr_b16 v[206:207], v13 offset:4608
    v_mfma_f32_16x16x32_bf16 v[64:67], v[208:211], v[36:39], v[64:67]
    v_mfma_f32_16x16x32_bf16 v[68:71], v[208:211], v[40:43], v[68:71]
    v_mfma_f32_16x16x32_bf16 v[72:75], v[208:211], v[44:47], v[72:75]
    v_mfma_f32_16x16x32_bf16 v[76:79], v[208:211], v[48:51], v[76:79]
    v_mfma_f32_16x16x32_bf16 v[80:83], v[212:215], v[36:39], v[80:83]
    v_mfma_f32_16x16x32_bf16 v[84:87], v[212:215], v[40:43], v[84:87]
    v_mfma_f32_16x16x32_bf16 v[88:91], v[212:215], v[44:47], v[88:91]
    v_mfma_f32_16x16x32_bf16 v[92:95], v[212:215], v[48:51], v[92:95]
    v_mfma_f32_16x16x32_bf16 v[96:99], v[216:219], v[36:39], v[96:99]
    v_mfma_f32_16x16x32_bf16 v[100:103], v[216:219], v[40:43], v[100:103]
    v_mfma_f32_16x16x32_bf16 v[104:107], v[216:219], v[44:47], v[104:107]
    v_mfma_f32_16x16x32_bf16 v[108:111], v[216:219], v[48:51], v[108:111]
    v_mfma_f32_16x16x32_bf16 v[112:115], v[220:223], v[36:39], v[112:115]
    v_mfma_f32_16x16x32_bf16 v[116:119], v[220:223], v[40:43], v[116:119]
    v_mfma_f32_16x16x32_bf16 v[120:123], v[220:223], v[44:47], v[120:123]
    v_mfma_f32_16x16x32_bf16 v[124:127], v[220:223], v[48:51], v[124:127]
    s_waitcnt lgkmcnt(0)
    s_waitcnt vmcnt(0)
    s_barrier
    ds_read_b128 v[36:39], v15 offset:24576
    ds_read_b128 v[40:43], v15 offset:25600
    ds_read_b128 v[44:47], v15 offset:26624
    ds_read_b128 v[48:51], v15 offset:27648
    ds_read_b64_tr_b16 v[208:209], v12 offset:24576
    ds_read_b64_tr_b16 v[210:211], v12 offset:25088
    ds_read_b64_tr_b16 v[212:213], v13 offset:24576
    ds_read_b64_tr_b16 v[214:215], v13 offset:25088
    ds_read_b64_tr_b16 v[216:217], v12 offset:28672
    ds_read_b64_tr_b16 v[218:219], v12 offset:29184
    ds_read_b64_tr_b16 v[220:221], v13 offset:28672
    ds_read_b64_tr_b16 v[222:223], v13 offset:29184
    v_mfma_f32_16x16x32_bf16 v[64:67], v[192:195], v[20:23], v[64:67]
    v_mfma_f32_16x16x32_bf16 v[68:71], v[192:195], v[24:27], v[68:71]
    v_mfma_f32_16x16x32_bf16 v[72:75], v[192:195], v[28:31], v[72:75]
    v_mfma_f32_16x16x32_bf16 v[76:79], v[192:195], v[32:35], v[76:79]
    v_mfma_f32_16x16x32_bf16 v[80:83], v[196:199], v[20:23], v[80:83]
    v_mfma_f32_16x16x32_bf16 v[84:87], v[196:199], v[24:27], v[84:87]
    v_mfma_f32_16x16x32_bf16 v[88:91], v[196:199], v[28:31], v[88:91]
    v_mfma_f32_16x16x32_bf16 v[92:95], v[196:199], v[32:35], v[92:95]
    v_mfma_f32_16x16x32_bf16 v[96:99], v[200:203], v[20:23], v[96:99]
    v_mfma_f32_16x16x32_bf16 v[100:103], v[200:203], v[24:27], v[100:103]
    v_mfma_f32_16x16x32_bf16 v[104:107], v[200:203], v[28:31], v[104:107]
    v_mfma_f32_16x16x32_bf16 v[108:111], v[200:203], v[32:35], v[108:111]
    v_mfma_f32_16x16x32_bf16 v[112:115], v[204:207], v[20:23], v[112:115]
    v_mfma_f32_16x16x32_bf16 v[116:119], v[204:207], v[24:27], v[116:119]
    v_mfma_f32_16x16x32_bf16 v[120:123], v[204:207], v[28:31], v[120:123]
    v_mfma_f32_16x16x32_bf16 v[124:127], v[204:207], v[32:35], v[124:127]
    s_waitcnt lgkmcnt(0)
    v_mfma_f32_16x16x32_bf16 v[64:67], v[208:211], v[36:39], v[64:67]
    v_mfma_f32_16x16x32_bf16 v[68:71], v[208:211], v[40:43], v[68:71]
    v_mfma_f32_16x16x32_bf16 v[72:75], v[208:211], v[44:47], v[72:75]
    v_mfma_f32_16x16x32_bf16 v[76:79], v[208:211], v[48:51], v[76:79]
    v_mfma_f32_16x16x32_bf16 v[80:83], v[212:215], v[36:39], v[80:83]
    v_mfma_f32_16x16x32_bf16 v[84:87], v[212:215], v[40:43], v[84:87]
    v_mfma_f32_16x16x32_bf16 v[88:91], v[212:215], v[44:47], v[88:91]
    v_mfma_f32_16x16x32_bf16 v[92:95], v[212:215], v[48:51], v[92:95]
    v_mfma_f32_16x16x32_bf16 v[96:99], v[216:219], v[36:39], v[96:99]
    v_mfma_f32_16x16x32_bf16 v[100:103], v[216:219], v[40:43], v[100:103]
    v_mfma_f32_16x16x32_bf16 v[104:107], v[216:219], v[44:47], v[104:107]
    v_mfma_f32_16x16x32_bf16 v[108:111], v[216:219], v[48:51], v[108:111]
    v_mfma_f32_16x16x32_bf16 v[112:115], v[220:223], v[36:39], v[112:115]
    v_mfma_f32_16x16x32_bf16 v[116:119], v[220:223], v[40:43], v[116:119]
    v_mfma_f32_16x16x32_bf16 v[120:123], v[220:223], v[44:47], v[120:123]
    v_mfma_f32_16x16x32_bf16 v[124:127], v[220:223], v[48:51], v[124:127]
    s_nop 9
    s_lshr_b32 s21, s20, 1
    s_mul_i32 s21, s21, 64
    s_lshl_b32 s22, s40, 8
    s_add_u32 s21, s21, s22
    v_add_u32 v5, s21, v3
    v_mul_u32_u24 v5, 3456, v5
    s_and_b32 s21, s20, 1
    s_lshl_b32 s21, s21, 6
    s_mul_i32 s22, s41, 128
    s_add_u32 s21, s21, s22
    v_lshlrev_b32 v6, 3, v4
    v_add_u32 v5, v5, v6
    v_add_u32 v5, s21, v5
    v_cvt_pk_bf16_f32 v7, v64, v64
    v_lshlrev_b32 v64, 16, v7
    v_cvt_pk_bf16_f32 v7, v96, v96
    v_lshlrev_b32 v96, 16, v7
    v_mul_f32 v8, 0xbfb8aa3b, v64
    v_exp_f32 v8, v8
    s_nop 0
    v_add_f32 v8, 1.0, v8
    v_rcp_f32 v8, v8
    s_nop 0
    v_mul_f32 v64, v64, v8
    v_cvt_pk_bf16_f32 v7, v64, v64
    v_lshlrev_b32 v64, 16, v7
    v_mul_f32 v64, v64, v96
    v_cvt_pk_bf16_f32 v7, v65, v65
    v_lshlrev_b32 v65, 16, v7
    v_cvt_pk_bf16_f32 v7, v97, v97
    v_lshlrev_b32 v97, 16, v7
    v_mul_f32 v8, 0xbfb8aa3b, v65
    v_exp_f32 v8, v8
    s_nop 0
    v_add_f32 v8, 1.0, v8
    v_rcp_f32 v8, v8
    s_nop 0
    v_mul_f32 v65, v65, v8
    v_cvt_pk_bf16_f32 v7, v65, v65
    v_lshlrev_b32 v65, 16, v7
    v_mul_f32 v65, v65, v97
    v_cvt_pk_bf16_f32 v7, v66, v66
    v_lshlrev_b32 v66, 16, v7
    v_cvt_pk_bf16_f32 v7, v98, v98
    v_lshlrev_b32 v98, 16, v7
    v_mul_f32 v8, 0xbfb8aa3b, v66
    v_exp_f32 v8, v8
    s_nop 0
    v_add_f32 v8, 1.0, v8
    v_rcp_f32 v8, v8
    s_nop 0
    v_mul_f32 v66, v66, v8
    v_cvt_pk_bf16_f32 v7, v66, v66
    v_lshlrev_b32 v66, 16, v7
    v_mul_f32 v66, v66, v98
    v_cvt_pk_bf16_f32 v7, v67, v67
    v_lshlrev_b32 v67, 16, v7
    v_cvt_pk_bf16_f32 v7, v99, v99
    v_lshlrev_b32 v99, 16, v7
    v_mul_f32 v8, 0xbfb8aa3b, v67
    v_exp_f32 v8, v8
    s_nop 0
    v_add_f32 v8, 1.0, v8
    v_rcp_f32 v8, v8
    s_nop 0
    v_mul_f32 v67, v67, v8
    v_cvt_pk_bf16_f32 v7, v67, v67
    v_lshlrev_b32 v67, 16, v7
    v_mul_f32 v67, v67, v99
    v_cvt_pk_bf16_f32 v64, v64, v65
    v_cvt_pk_bf16_f32 v65, v66, v67
    v_add_u32 v6, 0, v5
    buffer_store_dwordx2 v[64:65], v6, s[28:31], 0 offen
    v_cvt_pk_bf16_f32 v7, v68, v68
    v_lshlrev_b32 v68, 16, v7
    v_cvt_pk_bf16_f32 v7, v100, v100
    v_lshlrev_b32 v100, 16, v7
    v_mul_f32 v8, 0xbfb8aa3b, v68
    v_exp_f32 v8, v8
    s_nop 0
    v_add_f32 v8, 1.0, v8
    v_rcp_f32 v8, v8
    s_nop 0
    v_mul_f32 v68, v68, v8
    v_cvt_pk_bf16_f32 v7, v68, v68
    v_lshlrev_b32 v68, 16, v7
    v_mul_f32 v68, v68, v100
    v_cvt_pk_bf16_f32 v7, v69, v69
    v_lshlrev_b32 v69, 16, v7
    v_cvt_pk_bf16_f32 v7, v101, v101
    v_lshlrev_b32 v101, 16, v7
    v_mul_f32 v8, 0xbfb8aa3b, v69
    v_exp_f32 v8, v8
    s_nop 0
    v_add_f32 v8, 1.0, v8
    v_rcp_f32 v8, v8
    s_nop 0
    v_mul_f32 v69, v69, v8
    v_cvt_pk_bf16_f32 v7, v69, v69
    v_lshlrev_b32 v69, 16, v7
    v_mul_f32 v69, v69, v101
    v_cvt_pk_bf16_f32 v7, v70, v70
    v_lshlrev_b32 v70, 16, v7
    v_cvt_pk_bf16_f32 v7, v102, v102
    v_lshlrev_b32 v102, 16, v7
    v_mul_f32 v8, 0xbfb8aa3b, v70
    v_exp_f32 v8, v8
    s_nop 0
    v_add_f32 v8, 1.0, v8
    v_rcp_f32 v8, v8
    s_nop 0
    v_mul_f32 v70, v70, v8
    v_cvt_pk_bf16_f32 v7, v70, v70
    v_lshlrev_b32 v70, 16, v7
    v_mul_f32 v70, v70, v102
    v_cvt_pk_bf16_f32 v7, v71, v71
    v_lshlrev_b32 v71, 16, v7
    v_cvt_pk_bf16_f32 v7, v103, v103
    v_lshlrev_b32 v103, 16, v7
    v_mul_f32 v8, 0xbfb8aa3b, v71
    v_exp_f32 v8, v8
    s_nop 0
    v_add_f32 v8, 1.0, v8
    v_rcp_f32 v8, v8
    s_nop 0
    v_mul_f32 v71, v71, v8
    v_cvt_pk_bf16_f32 v7, v71, v71
    v_lshlrev_b32 v71, 16, v7
    v_mul_f32 v71, v71, v103
    v_cvt_pk_bf16_f32 v68, v68, v69
    v_cvt_pk_bf16_f32 v69, v70, v71
    v_add_u32 v6, 55296, v5
    buffer_store_dwordx2 v[68:69], v6, s[28:31], 0 offen
    v_cvt_pk_bf16_f32 v7, v72, v72
    v_lshlrev_b32 v72, 16, v7
    v_cvt_pk_bf16_f32 v7, v104, v104
    v_lshlrev_b32 v104, 16, v7
    v_mul_f32 v8, 0xbfb8aa3b, v72
    v_exp_f32 v8, v8
    s_nop 0
    v_add_f32 v8, 1.0, v8
    v_rcp_f32 v8, v8
    s_nop 0
    v_mul_f32 v72, v72, v8
    v_cvt_pk_bf16_f32 v7, v72, v72
    v_lshlrev_b32 v72, 16, v7
    v_mul_f32 v72, v72, v104
    v_cvt_pk_bf16_f32 v7, v73, v73
    v_lshlrev_b32 v73, 16, v7
    v_cvt_pk_bf16_f32 v7, v105, v105
    v_lshlrev_b32 v105, 16, v7
    v_mul_f32 v8, 0xbfb8aa3b, v73
    v_exp_f32 v8, v8
    s_nop 0
    v_add_f32 v8, 1.0, v8
    v_rcp_f32 v8, v8
    s_nop 0
    v_mul_f32 v73, v73, v8
    v_cvt_pk_bf16_f32 v7, v73, v73
    v_lshlrev_b32 v73, 16, v7
    v_mul_f32 v73, v73, v105
    v_cvt_pk_bf16_f32 v7, v74, v74
    v_lshlrev_b32 v74, 16, v7
    v_cvt_pk_bf16_f32 v7, v106, v106
    v_lshlrev_b32 v106, 16, v7
    v_mul_f32 v8, 0xbfb8aa3b, v74
    v_exp_f32 v8, v8
    s_nop 0
    v_add_f32 v8, 1.0, v8
    v_rcp_f32 v8, v8
    s_nop 0
    v_mul_f32 v74, v74, v8
    v_cvt_pk_bf16_f32 v7, v74, v74
    v_lshlrev_b32 v74, 16, v7
    v_mul_f32 v74, v74, v106
    v_cvt_pk_bf16_f32 v7, v75, v75
    v_lshlrev_b32 v75, 16, v7
    v_cvt_pk_bf16_f32 v7, v107, v107
    v_lshlrev_b32 v107, 16, v7
    v_mul_f32 v8, 0xbfb8aa3b, v75
    v_exp_f32 v8, v8
    s_nop 0
    v_add_f32 v8, 1.0, v8
    v_rcp_f32 v8, v8
    s_nop 0
    v_mul_f32 v75, v75, v8
    v_cvt_pk_bf16_f32 v7, v75, v75
    v_lshlrev_b32 v75, 16, v7
    v_mul_f32 v75, v75, v107
    v_cvt_pk_bf16_f32 v72, v72, v73
    v_cvt_pk_bf16_f32 v73, v74, v75
    v_add_u32 v6, 110592, v5
    buffer_store_dwordx2 v[72:73], v6, s[28:31], 0 offen
    v_cvt_pk_bf16_f32 v7, v76, v76
    v_lshlrev_b32 v76, 16, v7
    v_cvt_pk_bf16_f32 v7, v108, v108
    v_lshlrev_b32 v108, 16, v7
    v_mul_f32 v8, 0xbfb8aa3b, v76
    v_exp_f32 v8, v8
    s_nop 0
    v_add_f32 v8, 1.0, v8
    v_rcp_f32 v8, v8
    s_nop 0
    v_mul_f32 v76, v76, v8
    v_cvt_pk_bf16_f32 v7, v76, v76
    v_lshlrev_b32 v76, 16, v7
    v_mul_f32 v76, v76, v108
    v_cvt_pk_bf16_f32 v7, v77, v77
    v_lshlrev_b32 v77, 16, v7
    v_cvt_pk_bf16_f32 v7, v109, v109
    v_lshlrev_b32 v109, 16, v7
    v_mul_f32 v8, 0xbfb8aa3b, v77
    v_exp_f32 v8, v8
    s_nop 0
    v_add_f32 v8, 1.0, v8
    v_rcp_f32 v8, v8
    s_nop 0
    v_mul_f32 v77, v77, v8
    v_cvt_pk_bf16_f32 v7, v77, v77
    v_lshlrev_b32 v77, 16, v7
    v_mul_f32 v77, v77, v109
    v_cvt_pk_bf16_f32 v7, v78, v78
    v_lshlrev_b32 v78, 16, v7
    v_cvt_pk_bf16_f32 v7, v110, v110
    v_lshlrev_b32 v110, 16, v7
    v_mul_f32 v8, 0xbfb8aa3b, v78
    v_exp_f32 v8, v8
    s_nop 0
    v_add_f32 v8, 1.0, v8
    v_rcp_f32 v8, v8
    s_nop 0
    v_mul_f32 v78, v78, v8
    v_cvt_pk_bf16_f32 v7, v78, v78
    v_lshlrev_b32 v78, 16, v7
    v_mul_f32 v78, v78, v110
    v_cvt_pk_bf16_f32 v7, v79, v79
    v_lshlrev_b32 v79, 16, v7
    v_cvt_pk_bf16_f32 v7, v111, v111
    v_lshlrev_b32 v111, 16, v7
    v_mul_f32 v8, 0xbfb8aa3b, v79
    v_exp_f32 v8, v8
    s_nop 0
    v_add_f32 v8, 1.0, v8
    v_rcp_f32 v8, v8
    s_nop 0
    v_mul_f32 v79, v79, v8
    v_cvt_pk_bf16_f32 v7, v79, v79
    v_lshlrev_b32 v79, 16, v7
    v_mul_f32 v79, v79, v111
    v_cvt_pk_bf16_f32 v76, v76, v77
    v_cvt_pk_bf16_f32 v77, v78, v79
    v_add_u32 v6, 165888, v5
    buffer_store_dwordx2 v[76:77], v6, s[28:31], 0 offen
    v_cvt_pk_bf16_f32 v7, v80, v80
    v_lshlrev_b32 v80, 16, v7
    v_cvt_pk_bf16_f32 v7, v112, v112
    v_lshlrev_b32 v112, 16, v7
    v_mul_f32 v8, 0xbfb8aa3b, v80
    v_exp_f32 v8, v8
    s_nop 0
    v_add_f32 v8, 1.0, v8
    v_rcp_f32 v8, v8
    s_nop 0
    v_mul_f32 v80, v80, v8
    v_cvt_pk_bf16_f32 v7, v80, v80
    v_lshlrev_b32 v80, 16, v7
    v_mul_f32 v80, v80, v112
    v_cvt_pk_bf16_f32 v7, v81, v81
    v_lshlrev_b32 v81, 16, v7
    v_cvt_pk_bf16_f32 v7, v113, v113
    v_lshlrev_b32 v113, 16, v7
    v_mul_f32 v8, 0xbfb8aa3b, v81
    v_exp_f32 v8, v8
    s_nop 0
    v_add_f32 v8, 1.0, v8
    v_rcp_f32 v8, v8
    s_nop 0
    v_mul_f32 v81, v81, v8
    v_cvt_pk_bf16_f32 v7, v81, v81
    v_lshlrev_b32 v81, 16, v7
    v_mul_f32 v81, v81, v113
    v_cvt_pk_bf16_f32 v7, v82, v82
    v_lshlrev_b32 v82, 16, v7
    v_cvt_pk_bf16_f32 v7, v114, v114
    v_lshlrev_b32 v114, 16, v7
    v_mul_f32 v8, 0xbfb8aa3b, v82
    v_exp_f32 v8, v8
    s_nop 0
    v_add_f32 v8, 1.0, v8
    v_rcp_f32 v8, v8
    s_nop 0
    v_mul_f32 v82, v82, v8
    v_cvt_pk_bf16_f32 v7, v82, v82
    v_lshlrev_b32 v82, 16, v7
    v_mul_f32 v82, v82, v114
    v_cvt_pk_bf16_f32 v7, v83, v83
    v_lshlrev_b32 v83, 16, v7
    v_cvt_pk_bf16_f32 v7, v115, v115
    v_lshlrev_b32 v115, 16, v7
    v_mul_f32 v8, 0xbfb8aa3b, v83
    v_exp_f32 v8, v8
    s_nop 0
    v_add_f32 v8, 1.0, v8
    v_rcp_f32 v8, v8
    s_nop 0
    v_mul_f32 v83, v83, v8
    v_cvt_pk_bf16_f32 v7, v83, v83
    v_lshlrev_b32 v83, 16, v7
    v_mul_f32 v83, v83, v115
    v_cvt_pk_bf16_f32 v80, v80, v81
    v_cvt_pk_bf16_f32 v81, v82, v83
    v_add_u32 v6, 32, v5
    buffer_store_dwordx2 v[80:81], v6, s[28:31], 0 offen
    v_cvt_pk_bf16_f32 v7, v84, v84
    v_lshlrev_b32 v84, 16, v7
    v_cvt_pk_bf16_f32 v7, v116, v116
    v_lshlrev_b32 v116, 16, v7
    v_mul_f32 v8, 0xbfb8aa3b, v84
    v_exp_f32 v8, v8
    s_nop 0
    v_add_f32 v8, 1.0, v8
    v_rcp_f32 v8, v8
    s_nop 0
    v_mul_f32 v84, v84, v8
    v_cvt_pk_bf16_f32 v7, v84, v84
    v_lshlrev_b32 v84, 16, v7
    v_mul_f32 v84, v84, v116
    v_cvt_pk_bf16_f32 v7, v85, v85
    v_lshlrev_b32 v85, 16, v7
    v_cvt_pk_bf16_f32 v7, v117, v117
    v_lshlrev_b32 v117, 16, v7
    v_mul_f32 v8, 0xbfb8aa3b, v85
    v_exp_f32 v8, v8
    s_nop 0
    v_add_f32 v8, 1.0, v8
    v_rcp_f32 v8, v8
    s_nop 0
    v_mul_f32 v85, v85, v8
    v_cvt_pk_bf16_f32 v7, v85, v85
    v_lshlrev_b32 v85, 16, v7
    v_mul_f32 v85, v85, v117
    v_cvt_pk_bf16_f32 v7, v86, v86
    v_lshlrev_b32 v86, 16, v7
    v_cvt_pk_bf16_f32 v7, v118, v118
    v_lshlrev_b32 v118, 16, v7
    v_mul_f32 v8, 0xbfb8aa3b, v86
    v_exp_f32 v8, v8
    s_nop 0
    v_add_f32 v8, 1.0, v8
    v_rcp_f32 v8, v8
    s_nop 0
    v_mul_f32 v86, v86, v8
    v_cvt_pk_bf16_f32 v7, v86, v86
    v_lshlrev_b32 v86, 16, v7
    v_mul_f32 v86, v86, v118
    v_cvt_pk_bf16_f32 v7, v87, v87
    v_lshlrev_b32 v87, 16, v7
    v_cvt_pk_bf16_f32 v7, v119, v119
    v_lshlrev_b32 v119, 16, v7
    v_mul_f32 v8, 0xbfb8aa3b, v87
    v_exp_f32 v8, v8
    s_nop 0
    v_add_f32 v8, 1.0, v8
    v_rcp_f32 v8, v8
    s_nop 0
    v_mul_f32 v87, v87, v8
    v_cvt_pk_bf16_f32 v7, v87, v87
    v_lshlrev_b32 v87, 16, v7
    v_mul_f32 v87, v87, v119
    v_cvt_pk_bf16_f32 v84, v84, v85
    v_cvt_pk_bf16_f32 v85, v86, v87
    v_add_u32 v6, 55328, v5
    buffer_store_dwordx2 v[84:85], v6, s[28:31], 0 offen
    v_cvt_pk_bf16_f32 v7, v88, v88
    v_lshlrev_b32 v88, 16, v7
    v_cvt_pk_bf16_f32 v7, v120, v120
    v_lshlrev_b32 v120, 16, v7
    v_mul_f32 v8, 0xbfb8aa3b, v88
    v_exp_f32 v8, v8
    s_nop 0
    v_add_f32 v8, 1.0, v8
    v_rcp_f32 v8, v8
    s_nop 0
    v_mul_f32 v88, v88, v8
    v_cvt_pk_bf16_f32 v7, v88, v88
    v_lshlrev_b32 v88, 16, v7
    v_mul_f32 v88, v88, v120
    v_cvt_pk_bf16_f32 v7, v89, v89
    v_lshlrev_b32 v89, 16, v7
    v_cvt_pk_bf16_f32 v7, v121, v121
    v_lshlrev_b32 v121, 16, v7
    v_mul_f32 v8, 0xbfb8aa3b, v89
    v_exp_f32 v8, v8
    s_nop 0
    v_add_f32 v8, 1.0, v8
    v_rcp_f32 v8, v8
    s_nop 0
    v_mul_f32 v89, v89, v8
    v_cvt_pk_bf16_f32 v7, v89, v89
    v_lshlrev_b32 v89, 16, v7
    v_mul_f32 v89, v89, v121
    v_cvt_pk_bf16_f32 v7, v90, v90
    v_lshlrev_b32 v90, 16, v7
    v_cvt_pk_bf16_f32 v7, v122, v122
    v_lshlrev_b32 v122, 16, v7
    v_mul_f32 v8, 0xbfb8aa3b, v90
    v_exp_f32 v8, v8
    s_nop 0
    v_add_f32 v8, 1.0, v8
    v_rcp_f32 v8, v8
    s_nop 0
    v_mul_f32 v90, v90, v8
    v_cvt_pk_bf16_f32 v7, v90, v90
    v_lshlrev_b32 v90, 16, v7
    v_mul_f32 v90, v90, v122
    v_cvt_pk_bf16_f32 v7, v91, v91
    v_lshlrev_b32 v91, 16, v7
    v_cvt_pk_bf16_f32 v7, v123, v123
    v_lshlrev_b32 v123, 16, v7
    v_mul_f32 v8, 0xbfb8aa3b, v91
    v_exp_f32 v8, v8
    s_nop 0
    v_add_f32 v8, 1.0, v8
    v_rcp_f32 v8, v8
    s_nop 0
    v_mul_f32 v91, v91, v8
    v_cvt_pk_bf16_f32 v7, v91, v91
    v_lshlrev_b32 v91, 16, v7
    v_mul_f32 v91, v91, v123
    v_cvt_pk_bf16_f32 v88, v88, v89
    v_cvt_pk_bf16_f32 v89, v90, v91
    v_add_u32 v6, 110624, v5
    buffer_store_dwordx2 v[88:89], v6, s[28:31], 0 offen
    v_cvt_pk_bf16_f32 v7, v92, v92
    v_lshlrev_b32 v92, 16, v7
    v_cvt_pk_bf16_f32 v7, v124, v124
    v_lshlrev_b32 v124, 16, v7
    v_mul_f32 v8, 0xbfb8aa3b, v92
    v_exp_f32 v8, v8
    s_nop 0
    v_add_f32 v8, 1.0, v8
    v_rcp_f32 v8, v8
    s_nop 0
    v_mul_f32 v92, v92, v8
    v_cvt_pk_bf16_f32 v7, v92, v92
    v_lshlrev_b32 v92, 16, v7
    v_mul_f32 v92, v92, v124
    v_cvt_pk_bf16_f32 v7, v93, v93
    v_lshlrev_b32 v93, 16, v7
    v_cvt_pk_bf16_f32 v7, v125, v125
    v_lshlrev_b32 v125, 16, v7
    v_mul_f32 v8, 0xbfb8aa3b, v93
    v_exp_f32 v8, v8
    s_nop 0
    v_add_f32 v8, 1.0, v8
    v_rcp_f32 v8, v8
    s_nop 0
    v_mul_f32 v93, v93, v8
    v_cvt_pk_bf16_f32 v7, v93, v93
    v_lshlrev_b32 v93, 16, v7
    v_mul_f32 v93, v93, v125
    v_cvt_pk_bf16_f32 v7, v94, v94
    v_lshlrev_b32 v94, 16, v7
    v_cvt_pk_bf16_f32 v7, v126, v126
    v_lshlrev_b32 v126, 16, v7
    v_mul_f32 v8, 0xbfb8aa3b, v94
    v_exp_f32 v8, v8
    s_nop 0
    v_add_f32 v8, 1.0, v8
    v_rcp_f32 v8, v8
    s_nop 0
    v_mul_f32 v94, v94, v8
    v_cvt_pk_bf16_f32 v7, v94, v94
    v_lshlrev_b32 v94, 16, v7
    v_mul_f32 v94, v94, v126
    v_cvt_pk_bf16_f32 v7, v95, v95
    v_lshlrev_b32 v95, 16, v7
    v_cvt_pk_bf16_f32 v7, v127, v127
    v_lshlrev_b32 v127, 16, v7
    v_mul_f32 v8, 0xbfb8aa3b, v95
    v_exp_f32 v8, v8
    s_nop 0
    v_add_f32 v8, 1.0, v8
    v_rcp_f32 v8, v8
    s_nop 0
    v_mul_f32 v95, v95, v8
    v_cvt_pk_bf16_f32 v7, v95, v95
    v_lshlrev_b32 v95, 16, v7
    v_mul_f32 v95, v95, v127
    v_cvt_pk_bf16_f32 v92, v92, v93
    v_cvt_pk_bf16_f32 v93, v94, v95
    v_add_u32 v6, 165920, v5
    buffer_store_dwordx2 v[92:93], v6, s[28:31], 0 offen
k4b_kernel_end:
    s_endpgm
.globl k5b_kernel
.p2align 8
.type k5b_kernel,@function
k5b_kernel:
    s_cmp_ge_u32 s2, 320
    s_cbranch_scc1 k5b_kernel_end
    s_and_b32 s47, s2, 7
    s_lshr_b32 s48, s2, 3
    s_mul_i32 s40, s48, 6554
    s_lshr_b32 s40, s40, 16
    s_mul_i32 s41, s40, 10
    s_sub_u32 s41, s48, s41
    s_lshl_b32 s40, s40, 3
    s_add_u32 s40, s40, s47
    s_load_dwordx2 s[6:7], s[0:1], 72
    s_load_dwordx2 s[16:17], s[0:1], 48
    s_load_dwordx2 s[18:19], s[0:1], 56
    v_lshrrev_b32 v1, 6, v0
    s_nop 0
    v_readfirstlane_b32 s20, v1
    v_and_b32 v2, 63, v0
    s_waitcnt lgkmcnt(0)
    s_mov_b32 s4, s6
    s_mov_b32 s5, s7
    s_add_u32 s4, s4, 0x1000000
    s_addc_u32 s5, s5, 0
    s_mov_b32 s8, s4
    s_and_b32 s9, s5, 0xffff
    s_mov_b32 s10, 0x6c0000
    s_mov_b32 s11, 0x00020000
    s_mov_b32 s12, s16
    s_and_b32 s13, s17, 0xffff
    s_mov_b32 s14, 0x21c000
    s_mov_b32 s15, 0x00020000
    s_mov_b32 s28, s18
    s_and_b32 s29, s19, 0xffff
    s_mov_b32 s30, 0x280000
    s_mov_b32 s31, 0x00020000
    s_mov_b32 s4, s6
    s_mov_b32 s5, s7
    s_add_u32 s4, s4, 0x800000
    s_addc_u32 s5, s5, 0
    s_mov_b32 s24, s4
    s_and_b32 s25, s5, 0xffff
    s_mov_b32 s26, 0x280000
    s_mov_b32 s27, 0x00020000
    v_lshrrev_b32 v3, 2, v2
    v_and_b32 v5, 3, v2
    s_mul_i32 s21, s20, 16
    s_lshl_b32 s22, s40, 6
    s_add_u32 s21, s21, s22
    v_add_u32 v7, 0, v3
    v_lshrrev_b32 v6, 3, v7
    v_and_b32 v6, 1, v6
    v_lshlrev_b32 v6, 1, v6
    v_xor_b32 v6, v6, v5
    v_lshlrev_b32 v6, 4, v6
    v_add_u32 v7, s21, v7
    v_mul_u32_u24 v7, 3456, v7
    v_add_u32 v10, v6, v7
    v_lshrrev_b32 v3, 3, v2
    v_and_b32 v5, 7, v2
    s_and_b32 s21, s20, 3
    s_lshl_b32 s21, s21, 3
    s_mul_i32 s22, s41, 128
    v_add_u32 v7, s21, v3
    v_lshrrev_b32 v6, 1, v7
    v_and_b32 v6, 1, v6
    v_lshrrev_b32 v8, 3, v7
    v_and_b32 v8, 1, v8
    v_lshlrev_b32 v8, 1, v8
    v_or_b32 v6, v6, v8
    v_lshlrev_b32 v6, 1, v6
    v_xor_b32 v6, v6, v5
    v_lshlrev_b32 v6, 4, v6
    v_mul_u32_u24 v7, 1280, v7
    v_add_u32 v7, v7, v6
    v_add_u32 v14, s22, v7
    v_and_b32 v3, 15, v2
    v_lshrrev_b32 v4, 4, v2
    s_lshr_b32 s21, s20, 1
    s_mul_i32 s21, s21, 2048
    v_lshrrev_b32 v7, 3, v3
    v_lshlrev_b32 v7, 1, v7
    v_xor_b32 v6, v4, v7
    v_lshlrev_b32 v6, 4, v6
    v_lshlrev_b32 v7, 6, v3
    v_add_u32 v6, v6, v7
    v_add_u32 v16, s21, v6
    s_and_b32 s21, s20, 1
    v_lshrrev_b32 v5, 3, v3
    v_and_b32 v6, 1, v4
    v_lshlrev_b32 v6, 1, v6
    v_or_b32 v5, v5, v6
    v_lshlrev_b32 v5, 1, v5
    v_and_b32 v6, 3, v3
    v_lshrrev_b32 v6, 1, v6
    s_lshl_b32 s22, s21, 2
    v_add_u32 v6, s22, v6
    v_lshlrev_b32 v7, 3, v4
    v_lshrrev_b32 v8, 2, v3
    v_add_u32 v7, v7, v8
    v_lshlrev_b32 v7, 7, v7
    v_and_b32 v8, 1, v3
    v_lshlrev_b32 v8, 3, v8
    v_add_u32 v7, v7, v8
    v_add_u32 v7, 4096, v7
    v_add_u32 v8, 0, v6
    v_xor_b32 v8, v8, v5
    v_lshlrev_b32 v8, 4, v8
    v_add_u32 v18, v8, v7
    v_add_u32 v8, 2, v6
    v_xor_b32 v8, v8, v5
    v_lshlrev_b32 v8, 4, v8
    v_add_u32 v19, v8, v7
    v_add_u32 v15, 16384, v16
    v_add_u32 v12, 16384, v18
    v_add_u32 v13, 16384, v19
    v_mov_b32 v64, 0
    v_mov_b32 v65, 0
    v_mov_b32 v66, 0
    v_mov_b32 v67, 0
    v_mov_b32 v68, 0
    v_mov_b32 v69, 0
    v_mov_b32 v70, 0
    v_mov_b32 v71, 0
    v_mov_b32 v72, 0
    v_mov_b32 v73, 0
    v_mov_b32 v74, 0
    v_mov_b32 v75, 0
    v_mov_b32 v76, 0
    v_mov_b32 v77, 0
    v_mov_b32 v78, 0
    v_mov_b32 v79, 0
    s_mul_i32 s42, s20, 1024
    s_lshl_b32 s43, s20, 10
    s_cmp_ge_u32 s20, 4
    s_cselect_b32 s52, s12, s12
    s_cselect_b32 s53, s13, s13
    s_cselect_b32 s54, s14, s14
    s_cselect_b32 s55, s15, s15
    s_mov_b32 s44, 0
    s_mov_b32 s45, 0
    s_add_u32 m0, s42, 0
    s_nop 0
    buffer_load_dwordx4 v10, s[8:11], s44 offen lds
    s_add_u32 m0, s43, 4096
    s_nop 0
    buffer_load_dwordx4 v14, s[52:55], s45 offen lds
    s_add_u32 s44, s44, 64
    s_add_u32 s45, s45, 40960
    s_add_u32 m0, s42, 8192
    s_nop 0
    buffer_load_dwordx4 v10, s[8:11], s44 offen lds
    s_add_u32 m0, s43, 12288
    s_nop 0
    buffer_load_dwordx4 v14, s[52:55], s45 offen lds
    s_add_u32 s44, s44, 64
    s_add_u32 s45, s45, 40960
    s_add_u32 m0, s42, 16384
    s_nop 0
    buffer_load_dwordx4 v10, s[8:11], s44 offen lds
    s_add_u32 m0, s43, 20480
    s_nop 0
    buffer_load_dwordx4 v14, s[52:55], s45 offen lds
    s_add_u32 s44, s44, 64
    s_add_u32 s45, s45, 40960
    s_waitcnt vmcnt(4)
    s_barrier
    s_add_u32 m0, s42, 24576
    s_nop 0
    buffer_load_dwordx4 v10, s[8:11], s44 offen lds
    s_add_u32 m0, s43, 28672
    s_nop 0
    buffer_load_dwordx4 v14, s[52:55], s45 offen lds
    s_add_u32 s44, s44, 64
    s_add_u32 s45, s45, 40960
    ds_read_b128 v[20:23], v16 offset:0
    ds_read_b128 v[24:27], v16 offset:1024
    ds_read_b64_tr_b16 v[192:193], v18 offset:0
    ds_read_b64_tr_b16 v[194:195], v18 offset:512
    ds_read_b64_tr_b16 v[196:197], v19 offset:0
    ds_read_b64_tr_b16 v[198:199], v19 offset:512
    s_waitcnt lgkmcnt(0)
    s_waitcnt vmcnt(4)
    s_barrier
    s_add_u32 m0, s42, 0
    s_nop 0
    buffer_load_dwordx4 v10, s[8:11], s44 offen lds
    s_add_u32 m0, s43, 4096
    s_nop 0
    buffer_load_dwordx4 v14, s[52:55], s45 offen lds
    s_add_u32 s44, s44, 64
    s_add_u32 s45, s45, 40960
    ds_read_b128 v[36:39], v16 offset:8192
    ds_read_b128 v[40:43], v16 offset:9216
    ds_read_b64_tr_b16 v[208:209], v18 offset:8192
    ds_read_b64_tr_b16 v[210:211], v18 offset:8704
    ds_read_b64_tr_b16 v[212:213], v19 offset:8192
    ds_read_b64_tr_b16 v[214:215], v19 offset:8704
    v_mfma_f32_16x16x32_bf16 v[64:67], v[192:195], v[20:23], v[64:67]
    v_mfma_f32_16x16x32_bf16 v[68:71], v[192:195], v[24:27], v[68:71]
    v_mfma_f32_16x16x32_bf16 v[72:75], v[196:199], v[20:23], v[72:75]
    v_mfma_f32_16x16x32_bf16 v[76:79], v[196:199], v[24:27], v[76:79]
    s_waitcnt lgkmcnt(0)
    s_waitcnt vmcnt(4)
    s_barrier
    s_add_u32 m0, s42, 8192
    s_nop 0
    buffer_load_dwordx4 v10, s[8:11], s44 offen lds
    s_add_u32 m0, s43, 12288
    s_nop 0
    buffer_load_dwordx4 v14, s[52:55], s45 offen lds
    s_add_u32 s44, s44, 64
    s_add_u32 s45, s45, 40960
    ds_read_b128 v[20:23], v15 offset:0
    ds_read_b128 v[24:27], v15 offset:1024
    ds_read_b64_tr_b16 v[192:193], v12 offset:0
    ds_read_b64_tr_b16 v[194:195], v12 offset:512
    ds_read_b64_tr_b16 v[196:197], v13 offset:0
    ds_read_b64_tr_b16 v[198:199], v13 offset:512
    v_mfma_f32_16x16x32_bf16 v[64:67], v[208:211], v[36:39], v[64:67]
    v_mfma_f32_16x16x32_bf16 v[68:71], v[208:211], v[40:43], v[68:71]
    v_mfma_f32_16x16x32_bf16 v[72:75], v[212:215], v[36:39], v[72:75]
    v_mfma_f32_16x16x32_bf16 v[76:79], v[212:215], v[40:43], v[76:79]
    s_waitcnt lgkmcnt(0)
    s_waitcnt vmcnt(4)
    s_barrier
    s_add_u32 m0, s42, 16384
    s_nop 0
    buffer_load_dwordx4 v10, s[8:11], s44 offen lds
    s_add_u32 m0, s43, 20480
    s_nop 0
    buffer_load_dwordx4 v14, s[52:55], s45 offen lds
    s_add_u32 s44, s44, 64
    s_add_u32 s45, s45, 40960
    ds_read_b128 v[36:39], v15 offset:8192
    ds_read_b128 v[40:43], v15 offset:9216
    ds_read_b64_tr_b16 v[208:209], v12 offset:8192
    ds_read_b64_tr_b16 v[210:211], v12 offset:8704
    ds_read_b64_tr_b16 v[212:213], v13 offset:8192
    ds_read_b64_tr_b16 v[214:215], v13 offset:8704
    v_mfma_f32_16x16x32_bf16 v[64:67], v[192:195], v[20:23], v[64:67]
    v_mfma_f32_16x16x32_bf16 v[68:71], v[192:195], v[24:27], v[68:71]
    v_mfma_f32_16x16x32_bf16 v[72:75], v[196:199], v[20:23], v[72:75]
    v_mfma_f32_16x16x32_bf16 v[76:79], v[196:199], v[24:27], v[76:79]
    s_waitcnt lgkmcnt(0)
    s_mov_b32 s46, 1
k5b_kernel_loop:
    s_waitcnt vmcnt(4)
    s_barrier
    s_add_u32 m0, s42, 24576
    s_nop 0
    buffer_load_dwordx4 v10, s[8:11], s44 offen lds
    s_add_u32 m0, s43, 28672
    s_nop 0
    buffer_load_dwordx4 v14, s[52:55], s45 offen lds
    s_add_u32 s44, s44, 64
    s_add_u32 s45, s45, 40960
    ds_read_b128 v[20:23], v16 offset:0
    ds_read_b128 v[24:27], v16 offset:1024
    ds_read_b64_tr_b16 v[192:193], v18 offset:0
    ds_read_b64_tr_b16 v[194:195], v18 offset:512
    ds_read_b64_tr_b16 v[196:197], v19 offset:0
    ds_read_b64_tr_b16 v[198:199], v19 offset:512
    v_mfma_f32_16x16x32_bf16 v[64:67], v[208:211], v[36:39], v[64:67]
    v_mfma_f32_16x16x32_bf16 v[68:71], v[208:211], v[40:43], v[68:71]
    v_mfma_f32_16x16x32_bf16 v[72:75], v[212:215], v[36:39], v[72:75]
    v_mfma_f32_16x16x32_bf16 v[76:79], v[212:215], v[40:43], v[76:79]
    s_waitcnt lgkmcnt(0)
    s_waitcnt vmcnt(4)
    s_barrier
    s_add_u32 m0, s42, 0
    s_nop 0
    buffer_load_dwordx4 v10, s[8:11], s44 offen lds
    s_add_u32 m0, s43, 4096
    s_nop 0
    buffer_load_dwordx4 v14, s[52:55], s45 offen lds
    s_add_u32 s44, s44, 64
    s_add_u32 s45, s45, 40960
    ds_read_b128 v[36:39], v16 offset:8192
    ds_read_b128 v[40:43], v16 offset:9216
    ds_read_b64_tr_b16 v[208:209], v18 offset:8192
    ds_read_b64_tr_b16 v[210:211], v18 offset:8704
    ds_read_b64_tr_b16 v[212:213], v19 offset:8192
    ds_read_b64_tr_b16 v[214:215], v19 offset:8704
    v_mfma_f32_16x16x32_bf16 v[64:67], v[192:195], v[20:23], v[64:67]
    v_mfma_f32_16x16x32_bf16 v[68:71], v[192:195], v[24:27], v[68:71]
    v_mfma_f32_16x16x32_bf16 v[72:75], v[196:199], v[20:23], v[72:75]
    v_mfma_f32_16x16x32_bf16 v[76:79], v[196:199], v[24:27], v[76:79]
    s_waitcnt lgkmcnt(0)
    s_waitcnt vmcnt(4)
    s_barrier
    s_add_u32 m0, s42, 8192
    s_nop 0
    buffer_load_dwordx4 v10, s[8:11], s44 offen lds
    s_add_u32 m0, s43, 12288
    s_nop 0
    buffer_load_dwordx4 v14, s[52:55], s45 offen lds
    s_add_u32 s44, s44, 64
    s_add_u32 s45, s45, 40960
    ds_read_b128 v[20:23], v15 offset:0
    ds_read_b128 v[24:27], v15 offset:1024
    ds_read_b64_tr_b16 v[192:193], v12 offset:0
    ds_read_b64_tr_b16 v[194:195], v12 offset:512
    ds_read_b64_tr_b16 v[196:197], v13 offset:0
    ds_read_b64_tr_b16 v[198:199], v13 offset:512
    v_mfma_f32_16x16x32_bf16 v[64:67], v[208:211], v[36:39], v[64:67]
    v_mfma_f32_16x16x32_bf16 v[68:71], v[208:211], v[40:43], v[68:71]
    v_mfma_f32_16x16x32_bf16 v[72:75], v[212:215], v[36:39], v[72:75]
    v_mfma_f32_16x16x32_bf16 v[76:79], v[212:215], v[40:43], v[76:79]
    s_waitcnt lgkmcnt(0)
    s_waitcnt vmcnt(4)
    s_barrier
    s_add_u32 m0, s42, 16384
    s_nop 0
    buffer_load_dwordx4 v10, s[8:11], s44 offen lds
    s_add_u32 m0, s43, 20480
    s_nop 0
    buffer_load_dwordx4 v14, s[52:55], s45 offen lds
    s_add_u32 s44, s44, 64
    s_add_u32 s45, s45, 40960
    ds_read_b128 v[36:39], v15 offset:8192
    ds_read_b128 v[40:43], v15 offset:9216
    ds_read_b64_tr_b16 v[208:209], v12 offset:8192
    ds_read_b64_tr_b16 v[210:211], v12 offset:8704
    ds_read_b64_tr_b16 v[212:213], v13 offset:8192
    ds_read_b64_tr_b16 v[214:215], v13 offset:8704
    v_mfma_f32_16x16x32_bf16 v[64:67], v[192:195], v[20:23], v[64:67]
    v_mfma_f32_16x16x32_bf16 v[68:71], v[192:195], v[24:27], v[68:71]
    v_mfma_f32_16x16x32_bf16 v[72:75], v[196:199], v[20:23], v[72:75]
    v_mfma_f32_16x16x32_bf16 v[76:79], v[196:199], v[24:27], v[76:79]
    s_waitcnt lgkmcnt(0)
    s_add_u32 s46, s46, 1
    s_cmp_lt_u32 s46, 12
    s_cbranch_scc1 k5b_kernel_loop
    s_waitcnt vmcnt(4)
    s_barrier
    s_add_u32 m0, s42, 24576
    s_nop 0
    buffer_load_dwordx4 v10, s[8:11], s44 offen lds
    s_add_u32 m0, s43, 28672
    s_nop 0
    buffer_load_dwordx4 v14, s[52:55], s45 offen lds
    s_add_u32 s44, s44, 64
    s_add_u32 s45, s45, 40960
    ds_read_b128 v[20:23], v16 offset:0
    ds_read_b128 v[24:27], v16 offset:1024
    ds_read_b64_tr_b16 v[192:193], v18 offset:0
    ds_read_b64_tr_b16 v[194:195], v18 offset:512
    ds_read_b64_tr_b16 v[196:197], v19 offset:0
    ds_read_b64_tr_b16 v[198:199], v19 offset:512
    v_mfma_f32_16x16x32_bf16 v[64:67], v[208:211], v[36:39], v[64:67]
    v_mfma_f32_16x16x32_bf16 v[68:71], v[208:211], v[40:43], v[68:71]
    v_mfma_f32_16x16x32_bf16 v[72:75], v[212:215], v[36:39], v[72:75]
    v_mfma_f32_16x16x32_bf16 v[76:79], v[212:215], v[40:43], v[76:79]
    s_waitcnt lgkmcnt(0)
    s_waitcnt vmcnt(4)
    s_barrier
    s_add_u32 m0, s42, 0
    s_nop 0
    buffer_load_dwordx4 v10, s[8:11], s44 offen lds
    s_add_u32 m0, s43, 4096
    s_nop 0
    buffer_load_dwordx4 v14, s[52:55], s45 offen lds
    s_add_u32 s44, s44, 64
    s_add_u32 s45, s45, 40960
    ds_read_b128 v[36:39], v16 offset:8192
    ds_read_b128 v[40:43], v16 offset:9216
    ds_read_b64_tr_b16 v[208:209], v18 offset:8192
    ds_read_b64_tr_b16 v[210:211], v18 offset:8704
    ds_read_b64_tr_b16 v[212:213], v19 offset:8192
    ds_read_b64_tr_b16 v[214:215], v19 offset:8704
    v_mfma_f32_16x16x32_bf16 v[64:67], v[192:195], v[20:23], v[64:67]
    v_mfma_f32_16x16x32_bf16 v[68:71], v[192:195], v[24:27], v[68:71]
    v_mfma_f32_16x16x32_bf16 v[72:75], v[196:199], v[20:23], v[72:75]
    v_mfma_f32_16x16x32_bf16 v[76:79], v[196:199], v[24:27], v[76:79]
    s_waitcnt lgkmcnt(0)
    s_waitcnt vmcnt(4)
    s_barrier
    s_add_u32 m0, s42, 8192
    s_nop 0
    buffer_load_dwordx4 v10, s[8:11], s44 offen lds
    s_add_u32 m0, s43, 12288
    s_nop 0
    buffer_load_dwordx4 v14, s[52:55], s45 offen lds
    s_add_u32 s44, s44, 64
    s_add_u32 s45, s45, 40960
    ds_read_b128 v[20:23], v15 offset:0
    ds_read_b128 v[24:27], v15 offset:1024
    ds_read_b64_tr_b16 v[192:193], v12 offset:0
    ds_read_b64_tr_b16 v[194:195], v12 offset:512
    ds_read_b64_tr_b16 v[196:197], v13 offset:0
    ds_read_b64_tr_b16 v[198:199], v13 offset:512
    v_mfma_f32_16x16x32_bf16 v[64:67], v[208:211], v[36:39], v[64:67]
    v_mfma_f32_16x16x32_bf16 v[68:71], v[208:211], v[40:43], v[68:71]
    v_mfma_f32_16x16x32_bf16 v[72:75], v[212:215], v[36:39], v[72:75]
    v_mfma_f32_16x16x32_bf16 v[76:79], v[212:215], v[40:43], v[76:79]
    s_waitcnt lgkmcnt(0)
    s_waitcnt vmcnt(4)
    s_barrier
    ds_read_b128 v[36:39], v15 offset:8192
    ds_read_b128 v[40:43], v15 offset:9216
    ds_read_b64_tr_b16 v[208:209], v12 offset:8192
    ds_read_b64_tr_b16 v[210:211], v12 offset:8704
    ds_read_b64_tr_b16 v[212:213], v13 offset:8192
    ds_read_b64_tr_b16 v[214:215], v13 offset:8704
    v_mfma_f32_16x16x32_bf16 v[64:67], v[192:195], v[20:23], v[64:67]
    v_mfma_f32_16x16x32_bf16 v[68:71], v[192:195], v[24:27], v[68:71]
    v_mfma_f32_16x16x32_bf16 v[72:75], v[196:199], v[20:23], v[72:75]
    v_mfma_f32_16x16x32_bf16 v[76:79], v[196:199], v[24:27], v[76:79]
    s_waitcnt lgkmcnt(0)
    s_waitcnt vmcnt(2)
    s_barrier
    ds_read_b128 v[20:23], v16 offset:0
    ds_read_b128 v[24:27], v16 offset:1024
    ds_read_b64_tr_b16 v[192:193], v18 offset:0
    ds_read_b64_tr_b16 v[194:195], v18 offset:512
    ds_read_b64_tr_b16 v[196:197], v19 offset:0
    ds_read_b64_tr_b16 v[198:199], v19 offset:512
    v_mfma_f32_16x16x32_bf16 v[64:67], v[208:211], v[36:39], v[64:67]
    v_mfma_f32_16x16x32_bf16 v[68:71], v[208:211], v[40:43], v[68:71]
    v_mfma_f32_16x16x32_bf16 v[72:75], v[212:215], v[36:39], v[72:75]
    v_mfma_f32_16x16x32_bf16 v[76:79], v[212:215], v[40:43], v[76:79]
    s_waitcnt lgkmcnt(0)
    s_waitcnt vmcnt(0)
    s_barrier
    ds_read_b128 v[36:39], v16 offset:8192
    ds_read_b128 v[40:43], v16 offset:9216
    ds_read_b64_tr_b16 v[208:209], v18 offset:8192
    ds_read_b64_tr_b16 v[210:211], v18 offset:8704
    ds_read_b64_tr_b16 v[212:213], v19 offset:8192
    ds_read_b64_tr_b16 v[214:215], v19 offset:8704
    v_mfma_f32_16x16x32_bf16 v[64:67], v[192:195], v[20:23], v[64:67]
    v_mfma_f32_16x16x32_bf16 v[68:71], v[192:195], v[24:27], v[68:71]
    v_mfma_f32_16x16x32_bf16 v[72:75], v[196:199], v[20:23], v[72:75]
    v_mfma_f32_16x16x32_bf16 v[76:79], v[196:199], v[24:27], v[76:79]
    s_waitcnt lgkmcnt(0)
    v_mfma_f32_16x16x32_bf16 v[64:67], v[208:211], v[36:39], v[64:67]
    v_mfma_f32_16x16x32_bf16 v[68:71], v[208:211], v[40:43], v[68:71]
    v_mfma_f32_16x16x32_bf16 v[72:75], v[212:215], v[36:39], v[72:75]
    v_mfma_f32_16x16x32_bf16 v[76:79], v[212:215], v[40:43], v[76:79]
    s_nop 9
    s_lshr_b32 s21, s20, 1
    s_mul_i32 s21, s21, 32
    s_lshl_b32 s22, s40, 6
    s_add_u32 s21, s21, s22
    v_add_u32 v5, s21, v3
    v_mul_u32_u24 v5, 1280, v5
    s_and_b32 s21, s20, 1
    s_lshl_b32 s21, s21, 6
    s_mul_i32 s22, s41, 128
    s_add_u32 s21, s21, s22
    v_lshlrev_b32 v6, 3, v4
    v_add_u32 v5, v5, v6
    v_add_u32 v5, s21, v5
    v_add_u32 v6, 0, v5
    buffer_load_dwordx2 v[20:21], v6, s[24:27], 0 offen
    v_add_u32 v6, 20480, v5
    buffer_load_dwordx2 v[22:23], v6, s[24:27], 0 offen
    v_add_u32 v6, 32, v5
    buffer_load_dwordx2 v[24:25], v6, s[24:27], 0 offen
    v_add_u32 v6, 20512, v5
    buffer_load_dwordx2 v[26:27], v6, s[24:27], 0 offen
    s_waitcnt vmcnt(0)
    v_cvt_pk_bf16_f32 v7, v64, v64
    v_lshlrev_b32 v64, 16, v7
    v_lshlrev_b32 v8, 16, v20
    v_add_f32 v64, v64, v8
    v_cvt_pk_bf16_f32 v7, v65, v65
    v_lshlrev_b32 v65, 16, v7
    v_and_b32 v8, 0xffff0000, v20
    v_add_f32 v65, v65, v8
    v_cvt_pk_bf16_f32 v7, v66, v66
    v_lshlrev_b32 v66, 16, v7
    v_lshlrev_b32 v8, 16, v21
    v_add_f32 v66, v66, v8
    v_cvt_pk_bf16_f32 v7, v67, v67
    v_lshlrev_b32 v67, 16, v7
    v_and_b32 v8, 0xffff0000, v21
    v_add_f32 v67, v67, v8
    v_cvt_pk_bf16_f32 v64, v64, v65
    v_cvt_pk_bf16_f32 v65, v66, v67
    v_add_u32 v6, 0, v5
    buffer_store_dwordx2 v[64:65], v6, s[28:31], 0 offen
    v_cvt_pk_bf16_f32 v7, v68, v68
    v_lshlrev_b32 v68, 16, v7
    v_lshlrev_b32 v8, 16, v22
    v_add_f32 v68, v68, v8
    v_cvt_pk_bf16_f32 v7, v69, v69
    v_lshlrev_b32 v69, 16, v7
    v_and_b32 v8, 0xffff0000, v22
    v_add_f32 v69, v69, v8
    v_cvt_pk_bf16_f32 v7, v70, v70
    v_lshlrev_b32 v70, 16, v7
    v_lshlrev_b32 v8, 16, v23
    v_add_f32 v70, v70, v8
    v_cvt_pk_bf16_f32 v7, v71, v71
    v_lshlrev_b32 v71, 16, v7
    v_and_b32 v8, 0xffff0000, v23
    v_add_f32 v71, v71, v8
    v_cvt_pk_bf16_f32 v68, v68, v69
    v_cvt_pk_bf16_f32 v69, v70, v71
    v_add_u32 v6, 20480, v5
    buffer_store_dwordx2 v[68:69], v6, s[28:31], 0 offen
    v_cvt_pk_bf16_f32 v7, v72, v72
    v_lshlrev_b32 v72, 16, v7
    v_lshlrev_b32 v8, 16, v24
    v_add_f32 v72, v72, v8
    v_cvt_pk_bf16_f32 v7, v73, v73
    v_lshlrev_b32 v73, 16, v7
    v_and_b32 v8, 0xffff0000, v24
    v_add_f32 v73, v73, v8
    v_cvt_pk_bf16_f32 v7, v74, v74
    v_lshlrev_b32 v74, 16, v7
    v_lshlrev_b32 v8, 16, v25
    v_add_f32 v74, v74, v8
    v_cvt_pk_bf16_f32 v7, v75, v75
    v_lshlrev_b32 v75, 16, v7
    v_and_b32 v8, 0xffff0000, v25
    v_add_f32 v75, v75, v8
    v_cvt_pk_bf16_f32 v72, v72, v73
    v_cvt_pk_bf16_f32 v73, v74, v75
    v_add_u32 v6, 32, v5
    buffer_store_dwordx2 v[72:73], v6, s[28:31], 0 offen
    v_cvt_pk_bf16_f32 v7, v76, v76
    v_lshlrev_b32 v76, 16, v7
    v_lshlrev_b32 v8, 16, v26
    v_add_f32 v76, v76, v8
    v_cvt_pk_bf16_f32 v7, v77, v77
    v_lshlrev_b32 v77, 16, v7
    v_and_b32 v8, 0xffff0000, v26
    v_add_f32 v77, v77, v8
    v_cvt_pk_bf16_f32 v7, v78, v78
    v_lshlrev_b32 v78, 16, v7
    v_lshlrev_b32 v8, 16, v27
    v_add_f32 v78, v78, v8
    v_cvt_pk_bf16_f32 v7, v79, v79
    v_lshlrev_b32 v79, 16, v7
    v_and_b32 v8, 0xffff0000, v27
    v_add_f32 v79, v79, v8
    v_cvt_pk_bf16_f32 v76, v76, v77
    v_cvt_pk_bf16_f32 v77, v78, v79
    v_add_u32 v6, 20512, v5
    buffer_store_dwordx2 v[76:77], v6, s[28:31], 0 offen
k5b_kernel_end:
    s_endpgm
.section .rodata,"a"
.p2align 6
.amdhsa_kernel k1a_kernel
  .amdhsa_next_free_vgpr 40
  .amdhsa_next_free_sgpr 23
  .amdhsa_accum_offset 40
  .amdhsa_group_segment_fixed_size 0
  .amdhsa_kernarg_size 80
  .amdhsa_user_sgpr_count 2
  .amdhsa_user_sgpr_kernarg_segment_ptr 1
  .amdhsa_system_sgpr_workgroup_id_x 1
.end_amdhsa_kernel
.p2align 6
.amdhsa_kernel k2a_kernel
  .amdhsa_next_free_vgpr 48
  .amdhsa_next_free_sgpr 48
  .amdhsa_accum_offset 48
  .amdhsa_group_segment_fixed_size 0
  .amdhsa_kernarg_size 80
  .amdhsa_user_sgpr_count 2
  .amdhsa_user_sgpr_kernarg_segment_ptr 1
  .amdhsa_system_sgpr_workgroup_id_x 1
.end_amdhsa_kernel
.p2align 6
.amdhsa_kernel k3a_kernel
  .amdhsa_next_free_vgpr 60
  .amdhsa_next_free_sgpr 40
  .amdhsa_accum_offset 60
  .amdhsa_group_segment_fixed_size 0
  .amdhsa_kernarg_size 80
  .amdhsa_user_sgpr_count 2
  .amdhsa_user_sgpr_kernarg_segment_ptr 1
  .amdhsa_system_sgpr_workgroup_id_x 1
.end_amdhsa_kernel
.p2align 6
.amdhsa_kernel k4a_kernel
  .amdhsa_next_free_vgpr 224
  .amdhsa_next_free_sgpr 56
  .amdhsa_accum_offset 224
  .amdhsa_group_segment_fixed_size 0
  .amdhsa_kernarg_size 80
  .amdhsa_user_sgpr_count 2
  .amdhsa_user_sgpr_kernarg_segment_ptr 1
  .amdhsa_system_sgpr_workgroup_id_x 1
.end_amdhsa_kernel
.p2align 6
.amdhsa_kernel k5a_kernel
  .amdhsa_next_free_vgpr 216
  .amdhsa_next_free_sgpr 56
  .amdhsa_accum_offset 216
  .amdhsa_group_segment_fixed_size 0
  .amdhsa_kernarg_size 80
  .amdhsa_user_sgpr_count 2
  .amdhsa_user_sgpr_kernarg_segment_ptr 1
  .amdhsa_system_sgpr_workgroup_id_x 1
.end_amdhsa_kernel
.p2align 6
.amdhsa_kernel k1b_kernel
  .amdhsa_next_free_vgpr 40
  .amdhsa_next_free_sgpr 23
  .amdhsa_accum_offset 40
  .amdhsa_group_segment_fixed_size 0
  .amdhsa_kernarg_size 80
  .amdhsa_user_sgpr_count 2
  .amdhsa_user_sgpr_kernarg_segment_ptr 1
  .amdhsa_system_sgpr_workgroup_id_x 1
.end_amdhsa_kernel
.p2align 6
.amdhsa_kernel k2b_kernel
  .amdhsa_next_free_vgpr 48
  .amdhsa_next_free_sgpr 48
  .amdhsa_accum_offset 48
  .amdhsa_group_segment_fixed_size 0
  .amdhsa_kernarg_size 80
  .amdhsa_user_sgpr_count 2
  .amdhsa_user_sgpr_kernarg_segment_ptr 1
  .amdhsa_system_sgpr_workgroup_id_x 1
.end_amdhsa_kernel
.p2align 6
.amdhsa_kernel k3b_kernel
  .amdhsa_next_free_vgpr 60
  .amdhsa_next_free_sgpr 40
  .amdhsa_accum_offset 60
  .amdhsa_group_segment_fixed_size 0
  .amdhsa_kernarg_size 80
  .amdhsa_user_sgpr_count 2
  .amdhsa_user_sgpr_kernarg_segment_ptr 1
  .amdhsa_system_sgpr_workgroup_id_x 1
.end_amdhsa_kernel
.p2align 6
.amdhsa_kernel k4b_kernel
  .amdhsa_next_free_vgpr 224
  .amdhsa_next_free_sgpr 56
  .amdhsa_accum_offset 224
  .amdhsa_group_segment_fixed_size 0
  .amdhsa_kernarg_size 80
  .amdhsa_user_sgpr_count 2
  .amdhsa_user_sgpr_kernarg_segment_ptr 1
  .amdhsa_system_sgpr_workgroup_id_x 1
.end_amdhsa_kernel
.p2align 6
.amdhsa_kernel k5b_kernel
  .amdhsa_next_free_vgpr 216
  .amdhsa_next_free_sgpr 56
  .amdhsa_accum_offset 216
  .amdhsa_group_segment_fixed_size 0
  .amdhsa_kernarg_size 80
  .amdhsa_user_sgpr_count 2
  .amdhsa_user_sgpr_kernarg_segment_ptr 1
  .amdhsa_system_sgpr_workgroup_id_x 1
.end_amdhsa_kernel
```
